```python
import torch

def _softmax(x, axis=-1):
    return torch.softmax(x, dim=axis)
def _gelu(x):
    return torch.nn.functional.gelu(x, approximate="tanh")
def _silu(x):
    return torch.nn.functional.silu(x)
def _sigmoid(x):
    return torch.sigmoid(x)
def _layernorm(x, axis=-1, eps=1e-5):
    m = x.mean(dim=axis, keepdim=True)
    v = x.var(dim=axis, keepdim=True, unbiased=False)
    return (x - m) / torch.sqrt(v + eps)
def _scatter_add(tgt, idx, src, axis=0):
    return tgt.clone().index_add_(axis, idx, src)
def _segment_sum(src, seg, n):
    out = torch.zeros((n,) + src.shape[1:], dtype=src.dtype)
    return out.index_add_(0, seg, src)
def _pad(x, pw):
    flat = tuple(v for pair in reversed(pw) for v in pair)
    return torch.nn.functional.pad(x, flat)

kernel_name = 'interleave_layers__linear_attn_block__glu_gated_swiglu__prompt'

def setup_inputs():

    _w = (lambda a: (lambda t: t.to(torch.bfloat16) if t.is_floating_point() else t)(torch.as_tensor(a)))
    def _A_setup():
        B, S, D = 1, 2048, 448
        return {
            "x": _w((lambda *s: torch.randn(*s, dtype=torch.bfloat16) * 0.05)(B, S, D)),
            "wqkv": _w((lambda *s: torch.randn(*s, dtype=torch.bfloat16) * 0.05)(D, 3 * D)),
            "wo": _w((lambda *s: torch.randn(*s, dtype=torch.bfloat16) * 0.05)(D, D)),
        }
    _A_in = _A_setup()

    def _B_setup():
        B, S, D, F = 1, 2048, 448, 1792
        return {
            "x": _w((lambda *s: torch.randn(*s, dtype=torch.bfloat16) * 0.05)(B, S, D)),
            "w1": _w((lambda *s: torch.randn(*s, dtype=torch.bfloat16) * 0.4)(D, F) * (2.0 / D) ** 0.5),
            "w3": _w((lambda *s: torch.randn(*s, dtype=torch.bfloat16) * 0.4)(D, F) * (2.0 / D) ** 0.5),
            "w2": _w((lambda *s: torch.randn(*s, dtype=torch.bfloat16) * 0.4)(F, D) * (2.0 / F) ** 0.5),
        }
    _B_in = _B_setup()

    return {
        "A_x": _A_in["x"],
        "A_wqkv": _A_in["wqkv"],
        "A_wo": _A_in["wo"],
        "B_x": _B_in["x"],
        "B_w1": _B_in["w1"],
        "B_w3": _B_in["w3"],
        "B_w2": _B_in["w2"],
    }

def reference(A_x, A_wqkv, A_wo, B_x, B_w1, B_w3, B_w2):
    def _A_ref(x, wqkv, wo):
        B, S, D = x.shape
        H = 16; Dh = D // H
        qkv = (lambda x, *d: x.permute(*d))((x @ wqkv).reshape(B, S, 3, H, Dh), 2, 0, 3, 1, 4)
        q, k, v = qkv[0], qkv[1], qkv[2]
        phi = lambda t: torch.where(t > 0, t + 1, torch.exp(t)) + 1e-6
        pq, pk = phi(q), phi(k)
        kv = torch.einsum("bhsd,bhse->bhde", pk, v)
        z = torch.einsum("bhsd->bhd", pk)
        num = torch.einsum("bhqd,bhde->bhqe", pq, kv)
        den = torch.einsum("bhqd,bhd->bhq", pq, z)[..., None] + 1e-6
        o = num / den
        return (lambda x, *d: x.permute(*d))(o, 0, 2, 1, 3).reshape(B, S, D) @ wo

    def _B_ref(x, w1, w3, w2):
        gate = torch.einsum("bsd,df->bsf", x, w1)
        up = torch.einsum("bsd,df->bsf", x, w3)
        h = _silu(gate) * up
        out = torch.einsum("bsf,fd->bsd", h, w2)
        return out

    x = A_x
    x = x + _A_ref(_layernorm(x, axis=-1), A_wqkv, A_wo)
    x = x + _B_ref(_layernorm(x, axis=-1), B_w1, B_w3, B_w2)
    x = x + _A_ref(_layernorm(x, axis=-1), A_wqkv, A_wo)
    x = x + _B_ref(_layernorm(x, axis=-1), B_w1, B_w3, B_w2)
    return x
```

```asm
; @launch grid=(256,1,1) block=(256,1,1) lds=163840
.amdgcn_target "amdgcn-amd-amdhsa--gfx950"
.text
.globl interleave_layers__linear_attn_block__glu_gated_swiglu__prompt_kernel
.p2align 8
.type interleave_layers__linear_attn_block__glu_gated_swiglu__prompt_kernel,@function
interleave_layers__linear_attn_block__glu_gated_swiglu__prompt_kernel:
M_start:
  s_cmp_ge_u32 s2, 256
  s_cbranch_scc1 M_end
  s_load_dwordx8 s[24:31], s[0:1], 0
  s_load_dwordx8 s[32:39], s[0:1], 32
  s_load_dwordx4 s[40:43], s[0:1], 64
  s_getpc_b64 s[64:65]
M_pc:
  s_sub_u32 s64, s64, M_pc-M_start
  s_subb_u32 s65, s65, 0
  s_mov_b32 s66, M_last-M_start
  s_mov_b32 s67, 0x00020000
  s_lshr_b32 s17, s2, 3
  s_lshl_b32 s58, s17, 12
  v_lshl_add_u32 v10, v0, 4, s58
  buffer_load_dwordx4 v[6:9], v10, s[64:67], 0 offen
  s_mov_b32 s96, s64
  s_mov_b32 s97, s65
  s_mov_b32 s98, s66
  s_mov_b32 s99, 0x00020000
  s_and_b32 s45, s2, 7
  s_and_b32 s18, s17, 15
  v_lshrrev_b32 v10, 6, v0
  v_and_b32 v11, 63, v0
  v_readfirstlane_b32 s16, v10
  s_cmp_ge_u32 s2, 216
  s_cselect_b32 s76, 896, 896
  s_cmp_lt_u32 s2, 160
  s_cselect_b32 s76, 3584, s76
  s_cmp_lt_u32 s2, 48
  s_cselect_b32 s76, 2688, s76
  v_lshrrev_b32 v204, 3, v11
  v_mul_lo_u32 v204, v204, s76
  v_and_b32 v10, 7, v11
  v_lshl_add_u32 v204, v10, 4, v204
  s_cmp_ge_u32 s2, 216
  s_mov_b32 s3, 160
  s_cselect_b32 s3, 216, s3
  s_cmp_lt_u32 s2, 160
  s_cselect_b32 s3, 48, s3
  s_cmp_lt_u32 s2, 48
  s_cselect_b32 s3, 0, s3
  s_sub_u32 s44, s2, s3
  s_cmp_ge_u32 s2, 216
  s_cselect_b32 s3, 1, 3
  s_cmp_lt_u32 s2, 160
  s_cselect_b32 s3, 2, s3
  s_cmp_lt_u32 s2, 48
  s_cselect_b32 s3, 2, s3
  s_lshr_b32 s47, s44, s3
  s_lshl_b32 s4, s47, s3
  s_sub_u32 s46, s44, s4
  s_mul_i32 s57, s47, 11
  s_lshr_b32 s57, s57, 5
  s_mul_i32 s56, s57, 3
  s_sub_u32 s56, s47, s56
  s_add_u32 s3, s56, 1
  s_cmp_eq_u32 s56, 2
  s_cselect_b32 s3, 0, s3
  s_mul_i32 s3, s3, 896
  s_mul_i32 s4, s57, 224
  s_add_u32 s3, s3, s4
  s_lshl_b32 s4, s47, 7
  s_cmp_ge_u32 s2, 216
  s_cselect_b32 s80, s4, s4
  s_cmp_lt_u32 s2, 160
  s_cselect_b32 s80, s4, s80
  s_cmp_lt_u32 s2, 48
  s_cselect_b32 s80, s3, s80
  s_cmp_ge_u32 s2, 216
  s_cselect_b32 s3, 200704, 200704
  s_cmp_lt_u32 s2, 160
  s_cselect_b32 s3, 401408, s3
  s_cmp_lt_u32 s2, 48
  s_cselect_b32 s3, 301056, s3
  s_mul_i32 s3, s3, s46
  s_add_u32 s80, s80, s3
  s_cmp_ge_u32 s2, 216
  s_cselect_b32 s81, 100352, 100352
  s_cmp_lt_u32 s2, 160
  s_cselect_b32 s81, 0, s81
  s_cmp_lt_u32 s2, 48
  s_cselect_b32 s81, 128, s81
  s_add_u32 s81, s81, s80
  s_lshl_b32 s77, s76, 3
  s_cmp_ge_u32 s2, 216
  s_mov_b32 s62, 1605632
  s_cselect_b32 s62, 401408, s62
  s_cmp_lt_u32 s2, 160
  s_cselect_b32 s62, 1605632, s62
  s_cmp_lt_u32 s2, 48
  s_cselect_b32 s62, 1204224, s62
  s_cmp_ge_u32 s2, 230
  s_cselect_b32 s62, 0, s62
  s_mov_b32 s63, 0x00020000
  s_cmp_ge_u32 s16, 2
  s_cselect_b32 s80, s81, s80
  s_cselect_b32 s5, 2, 0
  s_and_b32 s3, s16, 1
  s_mul_i32 s4, s3, s77
  s_mul_i32 s4, s4, 7
  s_add_u32 s80, s80, s4
  s_mul_i32 s83, s16, 7168
  s_add_u32 s83, s83, 131072
  s_cmp_lg_u32 s5, 0
  s_waitcnt lgkmcnt(0)
  s_cselect_b32 s3, s34, s32
  s_cselect_b32 s4, s35, s33
  s_cmp_ge_u32 s2, 216
  s_cselect_b32 s60, s28, s36
  s_cmp_lt_u32 s2, 160
  s_cselect_b32 s60, s3, s60
  s_cmp_lt_u32 s2, 48
  s_cselect_b32 s60, s26, s60
  s_cmp_ge_u32 s2, 216
  s_cselect_b32 s61, s29, s37
  s_cmp_lt_u32 s2, 160
  s_cselect_b32 s61, s4, s61
  s_cmp_lt_u32 s2, 48
  s_cselect_b32 s61, s27, s61
  s_mov_b32 s8, s42
  s_mov_b32 s9, s43
  s_mov_b32 s10, 268435456
  s_mov_b32 s11, 0x00020000
  s_cmp_eq_u32 s2, 255
  s_cselect_b32 s3, 0, 1073741824
  v_lshl_add_u32 v194, v0, 4, s3
  v_mov_b32 v184, 0
  v_mov_b32 v185, 0
  v_mov_b32 v186, 0
  v_mov_b32 v187, 0
  s_cbranch_scc0 J_noz
  s_mov_b32 s3, 20185088
  buffer_store_dwordx4 v[184:187], v194, s[8:11], s3 offen sc1
  s_mov_b32 s3, 20189184
  buffer_store_dwordx4 v[184:187], v194, s[8:11], s3 offen sc1
  s_mov_b32 s3, 20201472
  buffer_store_dwordx4 v[184:187], v194, s[8:11], s3 offen sc1
J_noz:
  s_add_u32 m0, s83, 0
  s_nop 0
  buffer_load_dwordx4 v204, s[60:63], s80 offen lds
  s_add_u32 s80, s80, s77
  s_add_u32 m0, s83, 1024
  s_nop 0
  buffer_load_dwordx4 v204, s[60:63], s80 offen lds
  s_add_u32 s80, s80, s77
  s_add_u32 m0, s83, 2048
  s_nop 0
  buffer_load_dwordx4 v204, s[60:63], s80 offen lds
  s_add_u32 s80, s80, s77
  s_add_u32 m0, s83, 3072
  s_nop 0
  buffer_load_dwordx4 v204, s[60:63], s80 offen lds
  s_add_u32 s80, s80, s77
  s_add_u32 m0, s83, 4096
  s_nop 0
  buffer_load_dwordx4 v204, s[60:63], s80 offen lds
  s_add_u32 s80, s80, s77
  s_add_u32 m0, s83, 5120
  s_nop 0
  buffer_load_dwordx4 v204, s[60:63], s80 offen lds
  s_add_u32 s80, s80, s77
  s_add_u32 m0, s83, 6144
  s_nop 0
  buffer_load_dwordx4 v204, s[60:63], s80 offen lds
  s_mov_b32 s68, s24
  s_mov_b32 s69, s25
  s_mov_b32 s72, s40
  s_mov_b32 s73, s41
  s_mov_b32 s12, s38
  s_mov_b32 s13, s39
  s_mov_b32 s70, 1835008
  s_mov_b32 s71, 0x00020000
  s_mov_b32 s74, 256
  s_mov_b32 s75, 0x00020000
  s_lshr_b32 s3, s17, 4
  s_lshl_b32 s3, s3, 2
  s_lshl_b32 s7, s45, 3
  s_add_u32 s4, s3, s7
  s_add_u32 s4, s4, s16
  s_mul_i32 s24, s4, 28672
  s_mul_i32 s78, s16, 28672
  v_lshrrev_b32 v200, 3, v11
  v_lshrrev_b32 v201, 4, v11
  v_xor_b32 v10, v10, v201
  v_mul_u32_u24 v198, 896, v200
  v_xor_b32 v201, 4, v10
  v_lshl_add_u32 v199, v201, 4, v198
  v_lshl_add_u32 v198, v10, 4, v198
  s_and_b32 s81, s18, 3
  s_lshl_b32 s81, s81, 1
  s_mov_b32 s80, s81
  s_lshl_b32 s64, s80, 7
  s_add_u32 s64, s64, s24
  s_lshl_b32 s65, s80, 12
  s_add_u32 s65, s65, s78
  s_add_u32 m0, s65, 0
  s_add_u32 s83, s64, 0
  buffer_load_dwordx4 v198, s[68:71], s83 offen lds
  v_and_b32 v200, 31, v11
  v_lshrrev_b32 v201, 5, v11
  v_lshlrev_b32 v1, 4, v11
  v_lshlrev_b32 v2, 2, v11
  v_lshlrev_b32 v10, 20, v200
  v_min_u32 v10, 19922944, v10
  s_mov_b32 s58, 1048448
  s_lshl_b32 s3, s57, 2
  s_add_u32 s3, s3, s16
  s_mul_i32 s3, s3, 3
  s_add_u32 s3, s3, s56
  s_mul_i32 s3, s3, 29696
  s_lshl_b32 s5, s47, 2
  s_add_u32 s5, s5, s16
  s_mul_i32 s5, s5, 29696
  s_add_u32 s5, s5, 2097152
  s_cmp_ge_u32 s2, 216
  s_cselect_b32 s79, 0, 0
  s_cmp_lt_u32 s2, 160
  s_cselect_b32 s79, s5, s79
  s_cmp_lt_u32 s2, 48
  s_cselect_b32 s79, s3, s79
  s_mul_i32 s6, s46, 7168
  s_add_u32 s82, s79, s6
  s_lshl_b32 s3, s47, 1
  s_and_b32 s5, s16, 1
  s_add_u32 m0, s65, 1024
  s_add_u32 s83, s64, 7168
  buffer_load_dwordx4 v199, s[68:71], s83 offen lds
  s_add_u32 s3, s3, s5
  s_lshl_b32 s5, s46, 1
  s_lshr_b32 s6, s16, 1
  s_add_u32 s5, s5, s6
  s_mul_i32 s6, s3, 114688
  s_mul_i32 s58, s5, 7168
  s_add_u32 s6, s6, s58
  s_add_u32 s6, s6, 5505024
  s_lshl_b32 s3, s3, 15
  s_lshl_b32 s5, s5, 13
  s_add_u32 s3, s3, s5
  s_add_u32 s3, s3, 1572864
  s_mov_b32 s5, s82
  s_cmp_ge_u32 s2, 216
  s_cselect_b32 s82, s3, s6
  s_cmp_lt_u32 s2, 160
  s_cselect_b32 s82, s5, s82
  s_cmp_lt_u32 s2, 48
  s_cselect_b32 s82, s5, s82
  s_cmp_ge_u32 s2, 230
  s_cselect_b32 s3, 1073741824, 0
  s_cselect_b32 s82, 0, s82
  v_add_u32 v195, s3, v1
  s_cmp_ge_u32 s2, 216
  s_cselect_b32 s3, 0, 1073741824
  s_cmp_lt_u32 s2, 160
  s_cselect_b32 s3, 1073741824, s3
  s_cmp_lt_u32 s2, 48
  s_cselect_b32 s3, 1073741824, s3
  v_or_b32 v196, s3, v195
  s_cmp_ge_u32 s2, 216
  s_cselect_b32 s3, 1073741824, 1073741824
  s_cmp_lt_u32 s2, 160
  s_cselect_b32 s3, 0, s3
  s_add_u32 m0, s65, 2048
  s_add_u32 s83, s64, 14336
  buffer_load_dwordx4 v198, s[68:71], s83 offen lds
  s_cmp_lt_u32 s2, 48
  s_cselect_b32 s3, 0, s3
  v_lshlrev_b32 v197, 30, v201
  v_or3_b32 v197, s3, v197, v1
  s_lshr_b32 s3, s46, 1
  s_lshl_b32 s3, s3, 9
  s_and_b32 s5, s46, 1
  s_lshl_b32 s5, s5, 3
  s_add_u32 s3, s3, s5
  s_add_u32 s79, s79, s3
  s_add_u32 s79, s79, 28672
  s_cmp_ge_u32 s2, 216
  s_cselect_b32 s3, 32, 32
  s_cmp_lt_u32 s2, 160
  s_cselect_b32 s3, 32, s3
  s_cmp_lt_u32 s2, 48
  s_cselect_b32 s3, 28, s3
  v_cmp_gt_u32 s[54:55], s3, v200
  s_nop 1
  v_cndmask_b32 v202, 0, -1, s[54:55]
  s_cmp_ge_u32 s2, 216
  s_cselect_b32 s3, 1, 2
  s_cmp_lt_u32 s2, 160
  s_cselect_b32 s3, 2, s3
  s_cmp_lt_u32 s2, 48
  s_cselect_b32 s3, 2, s3
  v_cmp_gt_u32 s[54:55], s3, v201
  s_nop 1
  v_cndmask_b32 v203, 0, v202, s[54:55]
  s_mul_i32 s3, s16, 56
  s_lshl_b32 s5, s16, 5
  s_lshl_b32 s6, s16, 6
  s_cmp_ge_u32 s2, 216
  s_cselect_b32 s81, s6, s6
  s_add_u32 m0, s65, 3072
  s_add_u32 s83, s64, 21504
  buffer_load_dwordx4 v199, s[68:71], s83 offen lds
  s_cmp_lt_u32 s2, 160
  s_cselect_b32 s81, s5, s81
  s_cmp_lt_u32 s2, 48
  s_cselect_b32 s81, s3, s81
  s_cmp_ge_u32 s2, 216
  s_cselect_b32 s3, 32, 32
  s_cmp_lt_u32 s2, 160
  s_cselect_b32 s3, 128, s3
  s_cmp_lt_u32 s2, 48
  s_cselect_b32 s3, 32, s3
  v_bfe_u32 v10, v11, 4, 1
  v_mul_lo_u32 v205, v10, s3
  v_and_b32 v10, 3, v11
  v_lshl_add_u32 v205, v10, 3, v205
  v_add_u32 v205, s81, v205
  v_lshrrev_b32 v10, 7, v205
  v_and_b32 v205, 127, v205
  v_mul_u32_u24 v10, 14336, v10
  v_add_u32 v205, v205, v10
  v_bfe_u32 v10, v11, 2, 2
  v_lshl_add_u32 v10, v201, 2, v10
  v_lshl_add_u32 v205, v10, 7, v205
  v_add_u32 v205, 131072, v205
  s_cmp_ge_u32 s2, 216
  s_mov_b32 s77, 4096
  s_cselect_b32 s77, 3584, s77
  s_cmp_lt_u32 s2, 160
  s_cselect_b32 s77, 4096, s77
  s_cmp_lt_u32 s2, 48
  s_cselect_b32 s77, 4096, s77
  s_mov_b32 s22, 1065369472
  v_mov_b32 v206, 0
  s_mov_b32 s57, s7
  v_mov_b32 v193, 1
  v_lshl_or_b32 v194, v0, 8, v194
  v_add_u32 v12, 0x10000, v1
  v_add_u32 v13, 0x20000, v1
  s_mul_i32 s56, s17, 37
  s_lshr_b32 s56, s56, 8
  s_mul_i32 s58, s56, 7
  s_sub_u32 s6, s17, s58
  s_lshl_b32 s6, s6, 1
  s_and_b32 s58, s16, 1
  s_add_u32 s6, s6, s58
  s_min_u32 s56, s56, 3
  s_lshl_b32 s56, s56, 1
  s_add_u32 s56, s56, s57
  s_lshr_b32 s58, s16, 1
  s_add_u32 s5, s56, s58
  s_lshl_b32 s20, s16, 3
  s_min_u32 s20, s20, 21
  s_lshl_b32 s20, s20, 10
  s_mul_i32 s21, s16, 15
  s_min_u32 s21, s21, 43
  s_lshl_b32 s21, s21, 10
  s_mov_b32 s23, 0x3f317218
  s_mov_b64 vcc, 0
  s_mov_b32 s48, 0x0fffffff
  s_mov_b32 s49, 0x0fffffff
  s_mov_b32 s50, 0x10000000
  s_mov_b32 s51, 0x10000000
  s_mov_b32 s52, -1
  s_mov_b32 s53, 0
  s_mov_b32 s14, 1835008
  s_mov_b32 s15, 0x00020000
  v_mov_b32 v14, 0x358637bd
  v_mov_b32 v15, 1065369472
  v_bfe_u32 v3, v11, 2, 1
  v_mul_u32_u24 v3, 14336, v3
  v_and_b32 v10, 3, v11
  v_lshl_add_u32 v3, v10, 2, v3
  v_lshlrev_b32 v4, 4, v201
  s_lshl_b32 s58, s16, 8
  s_add_u32 s58, s58, 67584
  v_add_u32 v4, s58, v4
  v_add_u32 v5, s58, v2
  v_lshlrev_b32 v0, 2, v200
  s_mul_i32 s47, s5, 28672
  s_mul_i32 s59, s6, 64
  s_add_u32 s47, s47, s59
  s_mul_i32 s33, s5, 28672
  s_mul_i32 s59, s6, 2048
  s_add_u32 s33, s33, s59
  s_add_u32 s33, s33, 7340032
  s_mul_i32 s25, s4, 14336
  s_add_u32 s25, s25, 18874368
  s_mul_i32 s40, s18, 89088
  s_mul_i32 s41, s18, 207872
  s_add_u32 s41, s41, 2097152
  s_mul_i32 s26, s4, 32768
  s_mul_i32 s59, s18, 2048
  s_add_u32 s26, s26, s59
  s_add_u32 s26, s26, 9437184
  s_mul_i32 s27, s18, 4096
  s_mul_i32 s59, s16, 1024
  s_add_u32 s27, s27, s59
  s_add_u32 s27, s27, 19922944
  s_mul_i32 s29, s45, 114688
  s_add_u32 s29, s29, 18887680
  s_mul_i32 s28, s45, 114688
  s_mul_i32 s59, s17, 4
  s_add_u32 s28, s28, s59
  s_add_u32 s28, s28, 18887680
  s_mul_i32 s30, s6, 32768
  s_mul_i32 s59, s16, 8192
  s_add_u32 s30, s30, s59
  s_add_u32 s30, s30, 1572864
  s_mul_i32 s31, s16, 16384
  s_add_u32 s31, s31, 19922944
  s_mul_i32 s32, s5, 32768
  s_mul_i32 s59, s16, 8192
  s_add_u32 s32, s32, s59
  s_add_u32 s32, s32, 9437184
  s_lshr_b32 s57, s6, 2
  s_and_b32 s58, s6, 3
  s_mul_i32 s34, s5, 14336
  s_mul_i32 s59, s57, 1024
  s_add_u32 s34, s34, s59
  s_mul_i32 s59, s58, 4
  s_add_u32 s34, s34, s59
  s_add_u32 s34, s34, 18874368
  s_mul_i32 s35, s4, 114688
  s_mul_i32 s59, s18, 7168
  s_add_u32 s35, s35, s59
  s_add_u32 s35, s35, 11534336
  s_mul_i32 s36, s4, 14336
  s_mul_i32 s59, s18, 4
  s_add_u32 s36, s36, s59
  s_add_u32 s36, s36, 18886656
  s_mul_i32 s37, s56, 14336
  s_mul_i32 s59, s16, 16
  s_add_u32 s37, s37, s59
  s_add_u32 s37, s37, 18886656
  s_mul_i32 s38, s5, 114688
  s_mul_i32 s59, s16, 28672
  s_add_u32 s38, s38, s59
  s_add_u32 s38, s38, 11534336
  s_xor_b32 s57, s5, 1
  s_mul_i32 s39, s57, 114688
  s_mul_i32 s59, s16, 28672
  s_add_u32 s39, s39, s59
  s_add_u32 s39, s39, 11534336
  s_mul_i32 s42, s6, 114688
  s_mul_i32 s59, s16, 28672
  s_add_u32 s42, s42, s59
  s_add_u32 s42, s42, 5505024
  s_xor_b32 s57, s6, 1
  s_mul_i32 s43, s57, 114688
  s_mul_i32 s59, s16, 28672
  s_add_u32 s43, s43, s59
  s_add_u32 s43, s43, 5505024
  s_getreg_b32 s44, hwreg(HW_REG_XCC_ID, 0, 4)
  s_mul_i32 s7, s4, 14336
  s_mul_i32 s59, s18, 1024
  s_add_u32 s7, s7, s59
  s_add_u32 s7, s7, 18874368
  s_mul_i32 s3, s4, 2048
  s_mul_i32 s59, s18, 1024
  s_add_u32 s3, s3, s59
  s_add_u32 s3, s3, 19908608
  s_cmp_ge_u32 s18, 14
  s_cselect_b32 s7, s3, s7
  buffer_store_dwordx4 v[184:187], v1, s[8:11], s7 offen sc1
  v_mul_u32_u24 v207, 896, v200
  v_lshl_add_u32 v207, v201, 4, v207
  s_or_b32 s44, s44, 0x80
  s_waitcnt vmcnt(5)
  s_barrier
  buffer_store_dword v193, v194, s[72:75], 0 offen sc1
  ds_read_b64_tr_b16 v[136:137], v205 offset:0
  ds_read_b64_tr_b16 v[138:139], v205 offset:1024
  ds_read_b64_tr_b16 v[140:141], v205 offset:2048
  ds_read_b64_tr_b16 v[142:143], v205 offset:3072
  v_add_u32 v205, s77, v205
  ds_read_b64_tr_b16 v[144:145], v205 offset:0
  ds_read_b64_tr_b16 v[146:147], v205 offset:1024
  ds_read_b64_tr_b16 v[148:149], v205 offset:2048
  ds_read_b64_tr_b16 v[150:151], v205 offset:3072
  v_add_u32 v205, s77, v205
  ds_read_b64_tr_b16 v[152:153], v205 offset:0
  ds_read_b64_tr_b16 v[154:155], v205 offset:1024
  ds_read_b64_tr_b16 v[156:157], v205 offset:2048
  ds_read_b64_tr_b16 v[158:159], v205 offset:3072
  v_add_u32 v205, s77, v205
  ds_read_b64_tr_b16 v[160:161], v205 offset:0
  ds_read_b64_tr_b16 v[162:163], v205 offset:1024
  ds_read_b64_tr_b16 v[164:165], v205 offset:2048
  ds_read_b64_tr_b16 v[166:167], v205 offset:3072
  s_add_u32 s58, s82, 4096
  s_waitcnt lgkmcnt(15)
  v_and_b32 v136, v136, v202
  v_and_b32 v137, v137, v202
  s_waitcnt lgkmcnt(14)
  v_and_b32 v138, v138, v202
  v_and_b32 v139, v139, v202
  buffer_store_dwordx4 v[136:139], v195, s[8:11], s82 offen offset:0 sc1
  s_waitcnt lgkmcnt(13)
  v_and_b32 v140, v140, v202
  v_and_b32 v141, v141, v202
  s_waitcnt lgkmcnt(12)
  v_and_b32 v142, v142, v203
  v_and_b32 v143, v143, v203
  buffer_store_dwordx4 v[140:143], v195, s[8:11], s82 offen offset:1024 sc1
  s_waitcnt lgkmcnt(11)
  v_and_b32 v144, v144, v202
  v_and_b32 v145, v145, v202
  s_waitcnt lgkmcnt(10)
  v_and_b32 v146, v146, v202
  v_and_b32 v147, v147, v202
  buffer_store_dwordx4 v[144:147], v195, s[8:11], s82 offen offset:2048 sc1
  s_waitcnt lgkmcnt(9)
  v_and_b32 v148, v148, v202
  v_and_b32 v149, v149, v202
  s_waitcnt lgkmcnt(8)
  v_and_b32 v150, v150, v203
  v_and_b32 v151, v151, v203
  buffer_store_dwordx4 v[148:151], v195, s[8:11], s82 offen offset:3072 sc1
  s_waitcnt lgkmcnt(7)
  v_and_b32 v152, v152, v202
  v_and_b32 v153, v153, v202
  s_waitcnt lgkmcnt(6)
  v_and_b32 v154, v154, v202
  v_and_b32 v155, v155, v202
  buffer_store_dwordx4 v[152:155], v195, s[8:11], s58 offen offset:0 sc1
  s_waitcnt lgkmcnt(5)
  v_and_b32 v156, v156, v202
  v_and_b32 v157, v157, v202
  s_waitcnt lgkmcnt(4)
  v_and_b32 v158, v158, v203
  v_and_b32 v159, v159, v203
  buffer_store_dwordx4 v[156:159], v195, s[8:11], s58 offen offset:1024 sc1
  s_waitcnt lgkmcnt(3)
  v_and_b32 v160, v160, v202
  v_and_b32 v161, v161, v202
  s_waitcnt lgkmcnt(2)
  v_and_b32 v162, v162, v202
  v_and_b32 v163, v163, v202
  buffer_store_dwordx4 v[160:163], v195, s[8:11], s58 offen offset:2048 sc1
  s_waitcnt lgkmcnt(1)
  v_and_b32 v164, v164, v202
  v_and_b32 v165, v165, v202
  s_waitcnt lgkmcnt(0)
  v_and_b32 v166, v166, v203
  v_and_b32 v167, v167, v203
  buffer_store_dwordx4 v[164:167], v196, s[8:11], s58 offen offset:3072 sc1
  v_dot2c_f32_bf16 v206, s22, v136
  v_dot2c_f32_bf16 v206, s22, v137
  v_dot2c_f32_bf16 v206, s22, v138
  v_dot2c_f32_bf16 v206, s22, v139
  v_dot2c_f32_bf16 v206, s22, v140
  v_dot2c_f32_bf16 v206, s22, v141
  v_dot2c_f32_bf16 v206, s22, v142
  v_dot2c_f32_bf16 v206, s22, v143
  v_dot2c_f32_bf16 v206, s22, v144
  v_dot2c_f32_bf16 v206, s22, v145
  v_dot2c_f32_bf16 v206, s22, v146
  v_dot2c_f32_bf16 v206, s22, v147
  v_dot2c_f32_bf16 v206, s22, v148
  v_dot2c_f32_bf16 v206, s22, v149
  v_dot2c_f32_bf16 v206, s22, v150
  v_dot2c_f32_bf16 v206, s22, v151
  v_dot2c_f32_bf16 v206, s22, v152
  v_dot2c_f32_bf16 v206, s22, v153
  v_dot2c_f32_bf16 v206, s22, v154
  v_dot2c_f32_bf16 v206, s22, v155
  v_dot2c_f32_bf16 v206, s22, v156
  v_dot2c_f32_bf16 v206, s22, v157
  v_dot2c_f32_bf16 v206, s22, v158
  v_dot2c_f32_bf16 v206, s22, v159
  v_dot2c_f32_bf16 v206, s22, v160
  v_dot2c_f32_bf16 v206, s22, v161
  v_dot2c_f32_bf16 v206, s22, v162
  v_dot2c_f32_bf16 v206, s22, v163
  s_nop 2
  v_mov_b32 v176, v206
  s_nop 1
  v_permlane32_swap_b32 v176, v206
  v_add_f32 v176, v176, v206
  v_cvt_pk_bf16_f32 v177, v176, v176
  v_and_b32 v178, 0xffff0000, v177
  v_sub_f32 v178, v176, v178
  v_cvt_pk_bf16_f32 v180, v176, v178
  v_and_b32 v181, 0xffff, v177
  buffer_store_dwordx2 v[180:181], v197, s[8:11], s79 offen sc1
  v_mov_b32 v194, 0
  buffer_load_dword v193, v194, s[72:75], 0 offen sc1
  s_add_u32 s80, s80, 1
  s_cmp_eq_u32 s80, 7
  s_cselect_b32 s80, 0, s80
  s_lshl_b32 s64, s80, 7
  s_add_u32 s64, s64, s24
  s_lshl_b32 s65, s80, 12
  s_add_u32 s65, s65, s78
  s_add_u32 m0, s65, 0
  s_add_u32 s83, s64, 0
  buffer_load_dwordx4 v198, s[68:71], s83 offen lds
  s_add_u32 m0, s65, 1024
  s_add_u32 s83, s64, 7168
  buffer_load_dwordx4 v199, s[68:71], s83 offen lds
  s_add_u32 m0, s65, 2048
  s_add_u32 s83, s64, 14336
  buffer_load_dwordx4 v198, s[68:71], s83 offen lds
  s_add_u32 m0, s65, 3072
  s_add_u32 s83, s64, 21504
  buffer_load_dwordx4 v199, s[68:71], s83 offen lds
  s_add_u32 s80, s80, 1
  s_cmp_eq_u32 s80, 7
  s_cselect_b32 s80, 0, s80
  s_lshl_b32 s64, s80, 7
  s_add_u32 s64, s64, s24
  s_lshl_b32 s65, s80, 12
  s_add_u32 s65, s65, s78
  s_add_u32 m0, s65, 0
  s_add_u32 s83, s64, 0
  buffer_load_dwordx4 v198, s[68:71], s83 offen lds
  s_add_u32 m0, s65, 1024
  s_add_u32 s83, s64, 7168
  buffer_load_dwordx4 v199, s[68:71], s83 offen lds
  s_add_u32 m0, s65, 2048
  s_add_u32 s83, s64, 14336
  buffer_load_dwordx4 v198, s[68:71], s83 offen lds
  s_add_u32 m0, s65, 3072
  s_add_u32 s83, s64, 21504
  buffer_load_dwordx4 v199, s[68:71], s83 offen lds
  v_mov_b32 v202, s44
  s_lshl_b32 s3, s2, 7
  s_add_u32 s3, s3, 20185088
  s_lshl_b32 s59, s17, 7
  s_lshl_b32 s58, s45, 2
  s_add_u32 s59, s59, s58
  s_add_u32 s59, s59, 20201472
  s_waitcnt vmcnt(8)
  s_barrier
  s_cmp_lg_u32 s16, 0
  s_cbranch_scc1 J_nopk
  v_cmp_ne_u32 s[54:55], 0, v193
  s_nop 0
  s_cmp_eq_u64 s[54:55], exec
  s_cbranch_scc1 J_rdy
  s_mov_b32 s46, 0
Lpoll_1:
  buffer_load_dword v193, v194, s[72:75], 0 offen sc1
  s_add_u32 s46, s46, 1
  s_waitcnt vmcnt(0)
  v_cmp_ne_u32 s[54:55], 0, v193
  s_cmp_gt_u32 s46, 300000
  s_cbranch_scc1 Lpd_2
  s_cmp_eq_u64 s[54:55], exec
  s_cbranch_scc0 Lpoll_1
Lpd_2:
J_rdy:
  s_mov_b64 exec, 1
  s_cmp_ge_u32 s2, 48
  s_cbranch_scc1 J_nopk2
  buffer_store_dword v202, v2, s[8:11], s3 offen sc1
J_nopk2:
  buffer_store_dword v202, v2, s[8:11], s59 offen sc1
  s_mov_b64 exec, -1
J_nopk:
  s_add_u32 s80, s80, 1
  s_cmp_eq_u32 s80, 7
  s_cselect_b32 s80, 0, s80
  s_lshl_b32 s64, s80, 7
  s_add_u32 s64, s64, s24
  s_lshl_b32 s65, s80, 12
  s_add_u32 s65, s65, s78
  s_add_u32 m0, s65, 0
  s_add_u32 s83, s64, 0
  buffer_load_dwordx4 v198, s[68:71], s83 offen lds
  s_add_u32 m0, s65, 1024
  s_add_u32 s83, s64, 7168
  buffer_load_dwordx4 v199, s[68:71], s83 offen lds
  s_add_u32 m0, s65, 2048
  s_add_u32 s83, s64, 14336
  buffer_load_dwordx4 v198, s[68:71], s83 offen lds
  s_add_u32 m0, s65, 3072
  s_add_u32 s83, s64, 21504
  buffer_load_dwordx4 v199, s[68:71], s83 offen lds
  s_add_u32 s80, s80, 1
  s_cmp_eq_u32 s80, 7
  s_cselect_b32 s80, 0, s80
  s_lshl_b32 s64, s80, 7
  s_add_u32 s64, s64, s24
  s_lshl_b32 s65, s80, 12
  s_add_u32 s65, s65, s78
  s_add_u32 m0, s65, 0
  s_add_u32 s83, s64, 0
  buffer_load_dwordx4 v198, s[68:71], s83 offen lds
  s_add_u32 m0, s65, 1024
  s_add_u32 s83, s64, 7168
  buffer_load_dwordx4 v199, s[68:71], s83 offen lds
  s_add_u32 m0, s65, 2048
  s_add_u32 s83, s64, 14336
  buffer_load_dwordx4 v198, s[68:71], s83 offen lds
  s_add_u32 m0, s65, 3072
  s_add_u32 s83, s64, 21504
  buffer_load_dwordx4 v199, s[68:71], s83 offen lds
  s_add_u32 s80, s80, 1
  s_cmp_eq_u32 s80, 7
  s_cselect_b32 s80, 0, s80
  s_lshl_b32 s64, s80, 7
  s_add_u32 s64, s64, s24
  s_lshl_b32 s65, s80, 12
  s_add_u32 s65, s65, s78
  s_add_u32 m0, s65, 0
  s_add_u32 s83, s64, 0
  buffer_load_dwordx4 v198, s[68:71], s83 offen lds
  s_add_u32 m0, s65, 1024
  s_add_u32 s83, s64, 7168
  buffer_load_dwordx4 v199, s[68:71], s83 offen lds
  s_add_u32 m0, s65, 2048
  s_add_u32 s83, s64, 14336
  buffer_load_dwordx4 v198, s[68:71], s83 offen lds
  s_add_u32 m0, s65, 3072
  s_add_u32 s83, s64, 21504
  buffer_load_dwordx4 v199, s[68:71], s83 offen lds
  s_add_u32 s80, s80, 1
  s_cmp_eq_u32 s80, 7
  s_cselect_b32 s80, 0, s80
  s_lshl_b32 s64, s80, 7
  s_add_u32 s64, s64, s24
  s_lshl_b32 s65, s80, 12
  s_add_u32 s65, s65, s78
  s_add_u32 m0, s65, 0
  s_add_u32 s83, s64, 0
  buffer_load_dwordx4 v198, s[68:71], s83 offen lds
  s_add_u32 m0, s65, 1024
  s_add_u32 s83, s64, 7168
  buffer_load_dwordx4 v199, s[68:71], s83 offen lds
  s_add_u32 m0, s65, 2048
  s_add_u32 s83, s64, 14336
  buffer_load_dwordx4 v198, s[68:71], s83 offen lds
  s_add_u32 m0, s65, 3072
  s_add_u32 s83, s64, 21504
  buffer_load_dwordx4 v199, s[68:71], s83 offen lds
  s_add_u32 s24, s24, 7340032
  v_lshrrev_b32 v10, 3, v200
  v_lshlrev_b32 v204, 10, v10
  v_and_b32 v10, 7, v200
  v_lshl_add_u32 v204, v10, 7, v204
  v_add_u32 v204, s78, v204
  v_bfe_u32 v10, v200, 1, 3
  v_xor_b32 v10, v10, v201
  v_xor_b32 v11, 0, v10
  v_lshl_add_u32 v188, v11, 4, v204
  v_xor_b32 v11, 2, v10
  v_lshl_add_u32 v189, v11, 4, v204
  v_xor_b32 v11, 4, v10
  v_lshl_add_u32 v190, v11, 4, v204
  v_xor_b32 v11, 6, v10
  v_lshl_add_u32 v191, v11, 4, v204
  v_mov_b32 v220, 0
  v_mov_b32 v221, 0
  s_waitcnt vmcnt(0)
  ds_read_b128 v[24:27], v188 offset:0
  ds_read_b128 v[28:31], v189 offset:0
  ds_read_b128 v[32:35], v190 offset:0
  ds_read_b128 v[36:39], v191 offset:0
  ds_read_b128 v[40:43], v188 offset:4096
  ds_read_b128 v[44:47], v189 offset:4096
  ds_read_b128 v[48:51], v190 offset:4096
  ds_read_b128 v[52:55], v191 offset:4096
  ds_read_b128 v[56:59], v188 offset:8192
  ds_read_b128 v[60:63], v189 offset:8192
  ds_read_b128 v[64:67], v190 offset:8192
  ds_read_b128 v[68:71], v191 offset:8192
  s_waitcnt lgkmcnt(11)
  v_dot2c_f32_bf16 v220, s22, v24
  v_dot2c_f32_bf16 v220, s22, v25
  v_dot2c_f32_bf16 v220, s22, v26
  v_dot2c_f32_bf16 v220, s22, v27
  v_dot2c_f32_bf16 v221, v24, v24
  v_dot2c_f32_bf16 v221, v25, v25
  v_dot2c_f32_bf16 v221, v26, v26
  v_dot2c_f32_bf16 v221, v27, v27
  v_permlane32_swap_b32 v24, v26
  v_permlane32_swap_b32 v25, v27
  s_waitcnt lgkmcnt(10)
  v_dot2c_f32_bf16 v220, s22, v28
  v_dot2c_f32_bf16 v220, s22, v29
  v_dot2c_f32_bf16 v220, s22, v30
  v_dot2c_f32_bf16 v220, s22, v31
  v_dot2c_f32_bf16 v221, v28, v28
  v_dot2c_f32_bf16 v221, v29, v29
  v_dot2c_f32_bf16 v221, v30, v30
  v_dot2c_f32_bf16 v221, v31, v31
  v_permlane32_swap_b32 v28, v30
  v_permlane32_swap_b32 v29, v31
  s_waitcnt lgkmcnt(9)
  v_dot2c_f32_bf16 v220, s22, v32
  v_dot2c_f32_bf16 v220, s22, v33
  v_dot2c_f32_bf16 v220, s22, v34
  v_dot2c_f32_bf16 v220, s22, v35
  v_dot2c_f32_bf16 v221, v32, v32
  v_dot2c_f32_bf16 v221, v33, v33
  v_dot2c_f32_bf16 v221, v34, v34
  v_dot2c_f32_bf16 v221, v35, v35
  v_permlane32_swap_b32 v32, v34
  v_permlane32_swap_b32 v33, v35
  s_waitcnt lgkmcnt(8)
  v_dot2c_f32_bf16 v220, s22, v36
  v_dot2c_f32_bf16 v220, s22, v37
  v_dot2c_f32_bf16 v220, s22, v38
  v_dot2c_f32_bf16 v220, s22, v39
  v_dot2c_f32_bf16 v221, v36, v36
  v_dot2c_f32_bf16 v221, v37, v37
  v_dot2c_f32_bf16 v221, v38, v38
  v_dot2c_f32_bf16 v221, v39, v39
  v_permlane32_swap_b32 v36, v38
  v_permlane32_swap_b32 v37, v39
  ds_read_b128 v[72:75], v188 offset:12288
  ds_read_b128 v[76:79], v189 offset:12288
  ds_read_b128 v[80:83], v190 offset:12288
  ds_read_b128 v[84:87], v191 offset:12288
  s_waitcnt lgkmcnt(11)
  v_dot2c_f32_bf16 v220, s22, v40
  v_dot2c_f32_bf16 v220, s22, v41
  v_dot2c_f32_bf16 v220, s22, v42
  v_dot2c_f32_bf16 v220, s22, v43
  v_dot2c_f32_bf16 v221, v40, v40
  v_dot2c_f32_bf16 v221, v41, v41
  v_dot2c_f32_bf16 v221, v42, v42
  v_dot2c_f32_bf16 v221, v43, v43
  v_permlane32_swap_b32 v40, v42
  v_permlane32_swap_b32 v41, v43
  s_waitcnt lgkmcnt(10)
  v_dot2c_f32_bf16 v220, s22, v44
  v_dot2c_f32_bf16 v220, s22, v45
  v_dot2c_f32_bf16 v220, s22, v46
  v_dot2c_f32_bf16 v220, s22, v47
  v_dot2c_f32_bf16 v221, v44, v44
  v_dot2c_f32_bf16 v221, v45, v45
  v_dot2c_f32_bf16 v221, v46, v46
  v_dot2c_f32_bf16 v221, v47, v47
  v_permlane32_swap_b32 v44, v46
  v_permlane32_swap_b32 v45, v47
  s_waitcnt lgkmcnt(9)
  v_dot2c_f32_bf16 v220, s22, v48
  v_dot2c_f32_bf16 v220, s22, v49
  v_dot2c_f32_bf16 v220, s22, v50
  v_dot2c_f32_bf16 v220, s22, v51
  v_dot2c_f32_bf16 v221, v48, v48
  v_dot2c_f32_bf16 v221, v49, v49
  v_dot2c_f32_bf16 v221, v50, v50
  v_dot2c_f32_bf16 v221, v51, v51
  v_permlane32_swap_b32 v48, v50
  v_permlane32_swap_b32 v49, v51
  s_waitcnt lgkmcnt(8)
  v_dot2c_f32_bf16 v220, s22, v52
  v_dot2c_f32_bf16 v220, s22, v53
  v_dot2c_f32_bf16 v220, s22, v54
  v_dot2c_f32_bf16 v220, s22, v55
  v_dot2c_f32_bf16 v221, v52, v52
  v_dot2c_f32_bf16 v221, v53, v53
  v_dot2c_f32_bf16 v221, v54, v54
  v_dot2c_f32_bf16 v221, v55, v55
  v_permlane32_swap_b32 v52, v54
  v_permlane32_swap_b32 v53, v55
  ds_read_b128 v[88:91], v188 offset:16384
  ds_read_b128 v[92:95], v189 offset:16384
  ds_read_b128 v[96:99], v190 offset:16384
  ds_read_b128 v[100:103], v191 offset:16384
  s_waitcnt lgkmcnt(11)
  v_dot2c_f32_bf16 v220, s22, v56
  v_dot2c_f32_bf16 v220, s22, v57
  v_dot2c_f32_bf16 v220, s22, v58
  v_dot2c_f32_bf16 v220, s22, v59
  v_dot2c_f32_bf16 v221, v56, v56
  v_dot2c_f32_bf16 v221, v57, v57
  v_dot2c_f32_bf16 v221, v58, v58
  v_dot2c_f32_bf16 v221, v59, v59
  v_permlane32_swap_b32 v56, v58
  v_permlane32_swap_b32 v57, v59
  s_waitcnt lgkmcnt(10)
  v_dot2c_f32_bf16 v220, s22, v60
  v_dot2c_f32_bf16 v220, s22, v61
  v_dot2c_f32_bf16 v220, s22, v62
  v_dot2c_f32_bf16 v220, s22, v63
  v_dot2c_f32_bf16 v221, v60, v60
  v_dot2c_f32_bf16 v221, v61, v61
  v_dot2c_f32_bf16 v221, v62, v62
  v_dot2c_f32_bf16 v221, v63, v63
  v_permlane32_swap_b32 v60, v62
  v_permlane32_swap_b32 v61, v63
  s_waitcnt lgkmcnt(9)
  v_dot2c_f32_bf16 v220, s22, v64
  v_dot2c_f32_bf16 v220, s22, v65
  v_dot2c_f32_bf16 v220, s22, v66
  v_dot2c_f32_bf16 v220, s22, v67
  v_dot2c_f32_bf16 v221, v64, v64
  v_dot2c_f32_bf16 v221, v65, v65
  v_dot2c_f32_bf16 v221, v66, v66
  v_dot2c_f32_bf16 v221, v67, v67
  v_permlane32_swap_b32 v64, v66
  v_permlane32_swap_b32 v65, v67
  s_waitcnt lgkmcnt(8)
  v_dot2c_f32_bf16 v220, s22, v68
  v_dot2c_f32_bf16 v220, s22, v69
  v_dot2c_f32_bf16 v220, s22, v70
  v_dot2c_f32_bf16 v220, s22, v71
  v_dot2c_f32_bf16 v221, v68, v68
  v_dot2c_f32_bf16 v221, v69, v69
  v_dot2c_f32_bf16 v221, v70, v70
  v_dot2c_f32_bf16 v221, v71, v71
  v_permlane32_swap_b32 v68, v70
  v_permlane32_swap_b32 v69, v71
  ds_read_b128 v[104:107], v188 offset:20480
  ds_read_b128 v[108:111], v189 offset:20480
  ds_read_b128 v[112:115], v190 offset:20480
  ds_read_b128 v[116:119], v191 offset:20480
  ds_read_b128 v[120:123], v188 offset:24576
  ds_read_b128 v[124:127], v189 offset:24576
  ds_read_b128 v[128:131], v190 offset:24576
  ds_read_b128 v[132:135], v191 offset:24576
  s_lshr_b32 s58, s18, 2
  s_mul_i32 s58, s58, 1536
  s_add_u32 s58, s58, 20185088
  v_min_u32 v11, 44, v2
  v_lshlrev_b32 v11, 5, v11
  s_waitcnt lgkmcnt(0)
  s_cmp_lg_u32 s16, 0
  s_cbranch_scc1 J_nopoll
  s_mov_b32 s46, 0
Lpoll_3:
  buffer_load_dword v6, v11, s[8:11], s58 offen sc1
  s_add_u32 s46, s46, 1
  s_waitcnt vmcnt(0)
  v_cmp_ne_u32 s[54:55], 0, v6
  s_cmp_gt_u32 s46, 300000
  s_cbranch_scc1 Lpd_4
  s_cmp_eq_u64 s[54:55], exec
  s_cbranch_scc0 Lpoll_3
Lpd_4:
J_nopoll:
  s_barrier
  s_lshl_b32 s56, s16, 10
  s_add_u32 s57, s56, s40
  s_add_u32 s58, s57, 0
  s_add_u32 m0, s56, 0
  s_nop 0
  buffer_load_dwordx4 v1, s[8:11], s58 offen sc1 lds
  v_dot2c_f32_bf16 v220, s22, v72
  v_dot2c_f32_bf16 v220, s22, v73
  v_dot2c_f32_bf16 v220, s22, v74
  v_dot2c_f32_bf16 v220, s22, v75
  v_dot2c_f32_bf16 v221, v72, v72
  v_dot2c_f32_bf16 v221, v73, v73
  v_dot2c_f32_bf16 v221, v74, v74
  v_dot2c_f32_bf16 v221, v75, v75
  v_permlane32_swap_b32 v72, v74
  v_permlane32_swap_b32 v73, v75
  s_add_u32 s58, s57, 29696
  s_add_u32 m0, s56, 29696
  s_nop 0
  buffer_load_dwordx4 v1, s[8:11], s58 offen sc1 lds
  v_dot2c_f32_bf16 v220, s22, v76
  v_dot2c_f32_bf16 v220, s22, v77
  v_dot2c_f32_bf16 v220, s22, v78
  v_dot2c_f32_bf16 v220, s22, v79
  v_dot2c_f32_bf16 v221, v76, v76
  v_dot2c_f32_bf16 v221, v77, v77
  v_dot2c_f32_bf16 v221, v78, v78
  v_dot2c_f32_bf16 v221, v79, v79
  v_permlane32_swap_b32 v76, v78
  v_permlane32_swap_b32 v77, v79
  s_add_u32 s58, s57, 4096
  s_add_u32 m0, s56, 4096
  s_nop 0
  buffer_load_dwordx4 v1, s[8:11], s58 offen sc1 lds
  v_dot2c_f32_bf16 v220, s22, v80
  v_dot2c_f32_bf16 v220, s22, v81
  v_dot2c_f32_bf16 v220, s22, v82
  v_dot2c_f32_bf16 v220, s22, v83
  v_dot2c_f32_bf16 v221, v80, v80
  v_dot2c_f32_bf16 v221, v81, v81
  v_dot2c_f32_bf16 v221, v82, v82
  v_dot2c_f32_bf16 v221, v83, v83
  v_permlane32_swap_b32 v80, v82
  v_permlane32_swap_b32 v81, v83
  s_add_u32 s58, s57, 33792
  s_add_u32 m0, s56, 33792
  s_nop 0
  buffer_load_dwordx4 v1, s[8:11], s58 offen sc1 lds
  v_dot2c_f32_bf16 v220, s22, v84
  v_dot2c_f32_bf16 v220, s22, v85
  v_dot2c_f32_bf16 v220, s22, v86
  v_dot2c_f32_bf16 v220, s22, v87
  v_dot2c_f32_bf16 v221, v84, v84
  v_dot2c_f32_bf16 v221, v85, v85
  v_dot2c_f32_bf16 v221, v86, v86
  v_dot2c_f32_bf16 v221, v87, v87
  v_permlane32_swap_b32 v84, v86
  v_permlane32_swap_b32 v85, v87
  s_add_u32 s58, s57, 8192
  s_add_u32 m0, s56, 8192
  s_nop 0
  buffer_load_dwordx4 v1, s[8:11], s58 offen sc1 lds
  v_dot2c_f32_bf16 v220, s22, v88
  v_dot2c_f32_bf16 v220, s22, v89
  v_dot2c_f32_bf16 v220, s22, v90
  v_dot2c_f32_bf16 v220, s22, v91
  v_dot2c_f32_bf16 v221, v88, v88
  v_dot2c_f32_bf16 v221, v89, v89
  v_dot2c_f32_bf16 v221, v90, v90
  v_dot2c_f32_bf16 v221, v91, v91
  v_permlane32_swap_b32 v88, v90
  v_permlane32_swap_b32 v89, v91
  s_add_u32 s58, s57, 37888
  s_add_u32 m0, s56, 37888
  s_nop 0
  buffer_load_dwordx4 v1, s[8:11], s58 offen sc1 lds
  v_dot2c_f32_bf16 v220, s22, v92
  v_dot2c_f32_bf16 v220, s22, v93
  v_dot2c_f32_bf16 v220, s22, v94
  v_dot2c_f32_bf16 v220, s22, v95
  v_dot2c_f32_bf16 v221, v92, v92
  v_dot2c_f32_bf16 v221, v93, v93
  v_dot2c_f32_bf16 v221, v94, v94
  v_dot2c_f32_bf16 v221, v95, v95
  v_permlane32_swap_b32 v92, v94
  v_permlane32_swap_b32 v93, v95
  s_add_u32 s58, s57, 12288
  s_add_u32 m0, s56, 12288
  s_nop 0
  buffer_load_dwordx4 v1, s[8:11], s58 offen sc1 lds
  v_dot2c_f32_bf16 v220, s22, v96
  v_dot2c_f32_bf16 v220, s22, v97
  v_dot2c_f32_bf16 v220, s22, v98
  v_dot2c_f32_bf16 v220, s22, v99
  v_dot2c_f32_bf16 v221, v96, v96
  v_dot2c_f32_bf16 v221, v97, v97
  v_dot2c_f32_bf16 v221, v98, v98
  v_dot2c_f32_bf16 v221, v99, v99
  v_permlane32_swap_b32 v96, v98
  v_permlane32_swap_b32 v97, v99
  s_add_u32 s58, s57, 41984
  s_add_u32 m0, s56, 41984
  s_nop 0
  buffer_load_dwordx4 v1, s[8:11], s58 offen sc1 lds
  v_dot2c_f32_bf16 v220, s22, v100
  v_dot2c_f32_bf16 v220, s22, v101
  v_dot2c_f32_bf16 v220, s22, v102
  v_dot2c_f32_bf16 v220, s22, v103
  v_dot2c_f32_bf16 v221, v100, v100
  v_dot2c_f32_bf16 v221, v101, v101
  v_dot2c_f32_bf16 v221, v102, v102
  v_dot2c_f32_bf16 v221, v103, v103
  v_permlane32_swap_b32 v100, v102
  v_permlane32_swap_b32 v101, v103
  s_add_u32 s58, s57, 16384
  s_add_u32 m0, s56, 16384
  s_nop 0
  buffer_load_dwordx4 v1, s[8:11], s58 offen sc1 lds
  v_dot2c_f32_bf16 v220, s22, v104
  v_dot2c_f32_bf16 v220, s22, v105
  v_dot2c_f32_bf16 v220, s22, v106
  v_dot2c_f32_bf16 v220, s22, v107
  v_dot2c_f32_bf16 v221, v104, v104
  v_dot2c_f32_bf16 v221, v105, v105
  v_dot2c_f32_bf16 v221, v106, v106
  v_dot2c_f32_bf16 v221, v107, v107
  v_permlane32_swap_b32 v104, v106
  v_permlane32_swap_b32 v105, v107
  s_add_u32 s58, s57, 46080
  s_add_u32 m0, s56, 46080
  s_nop 0
  buffer_load_dwordx4 v1, s[8:11], s58 offen sc1 lds
  v_dot2c_f32_bf16 v220, s22, v108
  v_dot2c_f32_bf16 v220, s22, v109
  v_dot2c_f32_bf16 v220, s22, v110
  v_dot2c_f32_bf16 v220, s22, v111
  v_dot2c_f32_bf16 v221, v108, v108
  v_dot2c_f32_bf16 v221, v109, v109
  v_dot2c_f32_bf16 v221, v110, v110
  v_dot2c_f32_bf16 v221, v111, v111
  v_permlane32_swap_b32 v108, v110
  v_permlane32_swap_b32 v109, v111
  s_add_u32 s58, s57, 20480
  s_add_u32 m0, s56, 20480
  s_nop 0
  buffer_load_dwordx4 v1, s[8:11], s58 offen sc1 lds
  v_dot2c_f32_bf16 v220, s22, v112
  v_dot2c_f32_bf16 v220, s22, v113
  v_dot2c_f32_bf16 v220, s22, v114
  v_dot2c_f32_bf16 v220, s22, v115
  v_dot2c_f32_bf16 v221, v112, v112
  v_dot2c_f32_bf16 v221, v113, v113
  v_dot2c_f32_bf16 v221, v114, v114
  v_dot2c_f32_bf16 v221, v115, v115
  v_permlane32_swap_b32 v112, v114
  v_permlane32_swap_b32 v113, v115
  s_add_u32 s58, s57, 50176
  s_add_u32 m0, s56, 50176
  s_nop 0
  buffer_load_dwordx4 v1, s[8:11], s58 offen sc1 lds
  v_dot2c_f32_bf16 v220, s22, v116
  v_dot2c_f32_bf16 v220, s22, v117
  v_dot2c_f32_bf16 v220, s22, v118
  v_dot2c_f32_bf16 v220, s22, v119
  v_dot2c_f32_bf16 v221, v116, v116
  v_dot2c_f32_bf16 v221, v117, v117
  v_dot2c_f32_bf16 v221, v118, v118
  v_dot2c_f32_bf16 v221, v119, v119
  v_permlane32_swap_b32 v116, v118
  v_permlane32_swap_b32 v117, v119
  s_add_u32 s58, s57, 24576
  s_add_u32 m0, s56, 24576
  s_nop 0
  buffer_load_dwordx4 v1, s[8:11], s58 offen sc1 lds
  v_dot2c_f32_bf16 v220, s22, v120
  v_dot2c_f32_bf16 v220, s22, v121
  v_dot2c_f32_bf16 v220, s22, v122
  v_dot2c_f32_bf16 v220, s22, v123
  v_dot2c_f32_bf16 v221, v120, v120
  v_dot2c_f32_bf16 v221, v121, v121
  v_dot2c_f32_bf16 v221, v122, v122
  v_dot2c_f32_bf16 v221, v123, v123
  v_permlane32_swap_b32 v120, v122
  v_permlane32_swap_b32 v121, v123
  s_add_u32 s58, s57, 54272
  s_add_u32 m0, s56, 54272
  s_nop 0
  buffer_load_dwordx4 v1, s[8:11], s58 offen sc1 lds
  v_dot2c_f32_bf16 v220, s22, v124
  v_dot2c_f32_bf16 v220, s22, v125
  v_dot2c_f32_bf16 v220, s22, v126
  v_dot2c_f32_bf16 v220, s22, v127
  v_dot2c_f32_bf16 v221, v124, v124
  v_dot2c_f32_bf16 v221, v125, v125
  v_dot2c_f32_bf16 v221, v126, v126
  v_dot2c_f32_bf16 v221, v127, v127
  v_permlane32_swap_b32 v124, v126
  v_permlane32_swap_b32 v125, v127
  s_add_u32 s58, s57, 25600
  s_add_u32 m0, s56, 25600
  s_nop 0
  buffer_load_dwordx4 v1, s[8:11], s58 offen sc1 lds
  v_dot2c_f32_bf16 v220, s22, v128
  v_dot2c_f32_bf16 v220, s22, v129
  v_dot2c_f32_bf16 v220, s22, v130
  v_dot2c_f32_bf16 v220, s22, v131
  v_dot2c_f32_bf16 v221, v128, v128
  v_dot2c_f32_bf16 v221, v129, v129
  v_dot2c_f32_bf16 v221, v130, v130
  v_dot2c_f32_bf16 v221, v131, v131
  v_permlane32_swap_b32 v128, v130
  v_permlane32_swap_b32 v129, v131
  s_add_u32 s58, s57, 55296
  s_add_u32 m0, s56, 55296
  s_nop 0
  buffer_load_dwordx4 v1, s[8:11], s58 offen sc1 lds
  v_dot2c_f32_bf16 v220, s22, v132
  v_dot2c_f32_bf16 v220, s22, v133
  v_dot2c_f32_bf16 v220, s22, v134
  v_dot2c_f32_bf16 v220, s22, v135
  v_dot2c_f32_bf16 v221, v132, v132
  v_dot2c_f32_bf16 v221, v133, v133
  v_dot2c_f32_bf16 v221, v134, v134
  v_dot2c_f32_bf16 v221, v135, v135
  v_permlane32_swap_b32 v132, v134
  v_permlane32_swap_b32 v133, v135
  s_nop 0
  v_permlane32_swap_b32 v220, v221
  v_add_f32 v220, v220, v221
  buffer_load_dwordx4 v[16:19], v207, s[68:71], s47 offen offset:0
  buffer_load_dwordx4 v[20:23], v207, s[68:71], s47 offen offset:32
  s_add_u32 s4, s41, s20
  s_add_u32 s5, s40, s20
  s_lshl_b32 s56, s16, 12
  v_add_u32 v7, s56, v1
  s_lshl_b32 s56, s16, 10
  v_add_u32 v8, s56, v2
  s_add_u32 s59, s27, 0
  s_waitcnt vmcnt(10)
  s_barrier
  v_lshlrev_b32 v11, 5, v0
  v_lshrrev_b32 v6, 3, v2
  v_and_or_b32 v11, v6, 16, v11
  s_mov_b32 s58, 20201472
  ds_read_b128 v[184:187], v1 offset:0
  buffer_load_dwordx4 v[168:171], v11, s[8:11], s58 offen sc1
  ds_read_b128 v[196:199], v1 offset:29696
  ds_read_b128 v[188:191], v1 offset:1024
  ds_read_b128 v[200:203], v1 offset:30720
  ds_read_b128 v[192:195], v1 offset:2048
  ds_read_b128 v[204:207], v1 offset:31744
  v_mov_b32 v221, v220
  v_mov_b32 v210, 0
  s_nop 0
  v_permlane32_swap_b32 v220, v221
  v_mul_f32 v220, 0xbb124925, v220
  v_mul_f32 v221, 0x3b124925, v221
  v_cvt_pk_bf16_f32 v208, v220, v220
  v_fma_f32 v221, -v220, v220, v221
  v_and_b32 v209, 0xffff0000, v208
  v_max_f32 v221, 0, v221
  v_sub_f32 v209, v220, v209
  v_add_f32 v221, 0x3727c5ac, v221
  v_cvt_pk_bf16_f32 v209, v209, v210
  v_rsq_f32 v222, v221
  v_mov_b32 v210, v208
  v_mov_b32 v211, v209
  v_mul_f32 v223, 0x3fb8aa3b, v222
  s_waitcnt lgkmcnt(5)
  v_mfma_f32_32x32x16_bf16 v[136:151], v[24:27], v[184:187], 0
  ds_read_b128 v[184:187], v1 offset:3072
  s_add_u32 m0, s20, 74752
  s_add_u32 s57, s5, 59392
  buffer_load_dwordx4 v1, s[8:11], s57 offen offset:0 sc1 lds
  s_waitcnt lgkmcnt(5)
  v_mfma_f32_32x32x16_bf16 v[152:167], v[24:27], v[196:199], 0
  ds_read_b128 v[196:199], v1 offset:32768
  v_cndmask_b32 v10, v223, v222, s[52:53]
  s_waitcnt lgkmcnt(5)
  v_mfma_f32_32x32x16_bf16 v[136:151], v[28:31], v[188:191], v[136:151]
  ds_read_b128 v[188:191], v1 offset:4096
  buffer_load_dwordx4 v1, s[8:11], s57 offen offset:1024 sc1 lds
  ds_write_b32 v5, v10
  s_waitcnt lgkmcnt(6)
  v_mfma_f32_32x32x16_bf16 v[152:167], v[28:31], v[200:203], v[152:167]
  ds_read_b128 v[200:203], v1 offset:33792
  ds_read_b128 v[240:243], v4 offset:128
  ds_read_b128 v[244:247], v4 offset:160
  ds_read_b128 v[248:251], v4 offset:192
  ds_read_b128 v[252:255], v4 offset:224
  ds_read_b128 v[224:227], v4 offset:0
  s_waitcnt lgkmcnt(11)
  v_mfma_f32_32x32x16_bf16 v[136:151], v[32:35], v[192:195], v[136:151]
  ds_read_b128 v[192:195], v1 offset:5120
  buffer_load_dwordx4 v1, s[8:11], s57 offen offset:2048 sc1 lds
  ds_read_b128 v[228:231], v4 offset:32
  ds_read_b128 v[232:235], v4 offset:64
  s_waitcnt lgkmcnt(13)
  v_mfma_f32_32x32x16_bf16 v[152:167], v[32:35], v[204:207], v[152:167]
  ds_read_b128 v[204:207], v1 offset:34816
  ds_read_b128 v[236:239], v4 offset:96
  s_waitcnt lgkmcnt(14)
  v_mfma_f32_32x32x16_bf16 v[136:151], v[36:39], v[184:187], v[136:151]
  ds_read_b128 v[184:187], v1 offset:6144
  buffer_load_dwordx4 v1, s[8:11], s57 offen offset:3072 sc1 lds
  s_waitcnt lgkmcnt(14)
  v_mfma_f32_32x32x16_bf16 v[152:167], v[36:39], v[196:199], v[152:167]
  ds_read_b128 v[196:199], v1 offset:35840
  s_waitcnt lgkmcnt(14)
  v_mfma_f32_32x32x16_bf16 v[136:151], v[40:43], v[188:191], v[136:151]
  ds_read_b128 v[188:191], v1 offset:7168
  s_add_u32 m0, s20, 78848
  s_add_u32 s57, s5, 63488
  buffer_load_dwordx4 v1, s[8:11], s57 offen offset:0 sc1 lds
  s_waitcnt lgkmcnt(13)
  v_mfma_f32_32x32x16_bf16 v[152:167], v[40:43], v[200:203], v[152:167]
  ds_read_b128 v[200:203], v1 offset:36864
  s_waitcnt lgkmcnt(8)
  v_mfma_f32_32x32x16_bf16 v[136:151], v[44:47], v[192:195], v[136:151]
  ds_read_b128 v[192:195], v1 offset:8192
  buffer_load_dwordx4 v1, s[8:11], s57 offen offset:1024 sc1 lds
  s_waitcnt lgkmcnt(6)
  v_mfma_f32_32x32x16_bf16 v[152:167], v[44:47], v[204:207], v[152:167]
  ds_read_b128 v[204:207], v1 offset:37888
  s_waitcnt lgkmcnt(5)
  v_mfma_f32_32x32x16_bf16 v[136:151], v[48:51], v[184:187], v[136:151]
  ds_read_b128 v[184:187], v1 offset:9216
  buffer_load_dwordx4 v1, s[8:11], s57 offen offset:2048 sc1 lds
  s_waitcnt lgkmcnt(5)
  v_mfma_f32_32x32x16_bf16 v[152:167], v[48:51], v[196:199], v[152:167]
  ds_read_b128 v[196:199], v1 offset:38912
  s_waitcnt lgkmcnt(5)
  v_mfma_f32_32x32x16_bf16 v[136:151], v[52:55], v[188:191], v[136:151]
  buffer_load_dwordx4 v1, s[8:11], s57 offen offset:3072 sc1 lds
  s_waitcnt lgkmcnt(4)
  v_mfma_f32_32x32x16_bf16 v[152:167], v[52:55], v[200:203], v[152:167]
  s_waitcnt lgkmcnt(3)
  v_mfma_f32_32x32x16_bf16 v[136:151], v[56:59], v[192:195], v[136:151]
  s_waitcnt lgkmcnt(2)
  v_mfma_f32_32x32x16_bf16 v[152:167], v[56:59], v[204:207], v[152:167]
  s_waitcnt lgkmcnt(1)
  v_mfma_f32_32x32x16_bf16 v[136:151], v[60:63], v[184:187], v[136:151]
  s_waitcnt lgkmcnt(0)
  v_mfma_f32_32x32x16_bf16 v[152:167], v[60:63], v[196:199], v[152:167]
  s_waitcnt vmcnt(8)
  v_min3_u32 v172, v168, v169, v170
  v_min_u32 v172, v172, v171
  v_cmp_ne_u32 s[54:55], 0, v172
  s_nop 0
  s_cmp_eq_u64 s[54:55], exec
  s_cbranch_scc0 M_pdok_s
M_pdok:
  s_and_b32 s56, s45, 1
  s_cmp_lg_u32 s56, 0
  s_cselect_b64 s[54:55], -1, 0
  v_cndmask_b32 v168, v168, v169, s[54:55]
  v_cndmask_b32 v170, v170, v171, s[54:55]
  s_and_b32 s56, s45, 2
  s_cmp_lg_u32 s56, 0
  s_cselect_b64 s[54:55], -1, 0
  v_cndmask_b32 v168, v168, v170, s[54:55]
  v_cmp_eq_u32 s[54:55], s44, v168
  s_cmp_ge_u32 s45, 4
  s_cselect_b32 s56, s55, s54
  s_cmp_eq_u32 s56, -1
  s_cselect_b64 vcc, -1, 0
  v_mov_b32 v9, 1
  v_or_b32 v6, s16, v2
  v_min_u32 v6, 1, v6
  v_lshlrev_b32 v6, 30, v6
  ds_read_b128 v[188:191], v1 offset:10240
  s_barrier
  ds_read_b128 v[200:203], v1 offset:39936
  ds_read_b128 v[192:195], v1 offset:11264
  ds_read_b128 v[184:187], v1 offset:12288
  ds_read_b128 v[204:207], v1 offset:40960
  ds_read_b128 v[196:199], v1 offset:41984
  v_permlane32_swap_b32 v16, v18
  v_permlane32_swap_b32 v17, v19
  v_permlane32_swap_b32 v20, v22
  v_permlane32_swap_b32 v21, v23
  s_waitcnt lgkmcnt(5)
  v_mfma_f32_32x32x16_bf16 v[136:151], v[64:67], v[188:191], v[136:151]
  ds_read_b128 v[188:191], v1 offset:13312
  s_add_u32 m0, s21, 104448
  s_add_u32 s57, s41, s21
  buffer_load_dwordx4 v1, s[8:11], s57 offen offset:0 sc1 lds
  s_waitcnt lgkmcnt(5)
  v_mfma_f32_32x32x16_bf16 v[152:167], v[64:67], v[200:203], v[152:167]
  ds_read_b128 v[200:203], v1 offset:43008
  s_add_u32 s3, s42, 0
  buffer_load_dwordx4 a[0:3], v1, s[8:11], s3 offen offset:0 sc1
  s_waitcnt lgkmcnt(5)
  v_mfma_f32_32x32x16_bf16 v[136:151], v[68:71], v[192:195], v[136:151]
  ds_read_b128 v[192:195], v1 offset:14336
  s_add_u32 s3, s42, 0
  buffer_load_dwordx4 a[4:7], v1, s[8:11], s3 offen offset:1024 sc1
  s_waitcnt lgkmcnt(5)
  v_mfma_f32_32x32x16_bf16 v[136:151], v[72:75], v[184:187], v[136:151]
  ds_read_b128 v[184:187], v1 offset:15360
  buffer_load_dwordx4 v1, s[8:11], s57 offen offset:1024 sc1 lds
  s_waitcnt lgkmcnt(5)
  v_mfma_f32_32x32x16_bf16 v[152:167], v[68:71], v[204:207], v[152:167]
  ds_read_b128 v[204:207], v1 offset:44032
  s_add_u32 s3, s42, 0
  buffer_load_dwordx4 a[8:11], v1, s[8:11], s3 offen offset:2048 sc1
  s_waitcnt lgkmcnt(4)
  v_mfma_f32_32x32x16_bf16 v[136:151], v[76:79], v[188:191], v[136:151]
  ds_read_b128 v[188:191], v1 offset:16384
  v_mfma_f32_32x32x16_bf16 v[152:167], v[72:75], v[196:199], v[152:167]
  ds_read_b128 v[196:199], v1 offset:45056
  s_add_u32 s3, s42, 0
  buffer_load_dwordx4 a[12:15], v1, s[8:11], s3 offen offset:3072 sc1
  s_waitcnt lgkmcnt(5)
  v_mfma_f32_32x32x16_bf16 v[152:167], v[76:79], v[200:203], v[152:167]
  ds_read_b128 v[200:203], v1 offset:46080
  buffer_load_dwordx4 v1, s[8:11], s57 offen offset:2048 sc1 lds
  s_waitcnt lgkmcnt(5)
  v_mfma_f32_32x32x16_bf16 v[136:151], v[80:83], v[192:195], v[136:151]
  ds_read_b128 v[192:195], v1 offset:17408
  s_add_u32 s3, s42, 4096
  buffer_load_dwordx4 a[16:19], v1, s[8:11], s3 offen offset:0 sc1
  s_waitcnt lgkmcnt(5)
  v_mfma_f32_32x32x16_bf16 v[136:151], v[84:87], v[184:187], v[136:151]
  ds_read_b128 v[184:187], v1 offset:18432
  s_waitcnt lgkmcnt(5)
  v_mfma_f32_32x32x16_bf16 v[152:167], v[80:83], v[204:207], v[152:167]
  ds_read_b128 v[204:207], v1 offset:47104
  buffer_load_dwordx4 v1, s[8:11], s57 offen offset:3072 sc1 lds
  s_add_u32 s3, s42, 4096
  buffer_load_dwordx4 a[20:23], v1, s[8:11], s3 offen offset:1024 sc1
  s_waitcnt lgkmcnt(5)
  v_mfma_f32_32x32x16_bf16 v[136:151], v[88:91], v[188:191], v[136:151]
  ds_read_b128 v[188:191], v1 offset:19456
  s_waitcnt lgkmcnt(5)
  v_mfma_f32_32x32x16_bf16 v[152:167], v[84:87], v[196:199], v[152:167]
  ds_read_b128 v[196:199], v1 offset:48128
  s_add_u32 s3, s42, 4096
  buffer_load_dwordx4 a[24:27], v1, s[8:11], s3 offen offset:2048 sc1
  s_waitcnt lgkmcnt(5)
  v_mfma_f32_32x32x16_bf16 v[152:167], v[88:91], v[200:203], v[152:167]
  ds_read_b128 v[200:203], v1 offset:49152
  s_waitcnt lgkmcnt(5)
  v_mfma_f32_32x32x16_bf16 v[136:151], v[92:95], v[192:195], v[136:151]
  ds_read_b128 v[192:195], v1 offset:20480
  s_add_u32 m0, s21, 108544
  s_add_u32 s57, s41, s21
  s_add_u32 s57, s57, 4096
  buffer_load_dwordx4 v1, s[8:11], s57 offen offset:0 sc1 lds
  s_waitcnt lgkmcnt(5)
  v_mfma_f32_32x32x16_bf16 v[136:151], v[96:99], v[184:187], v[136:151]
  ds_read_b128 v[184:187], v1 offset:21504
  s_add_u32 s3, s42, 4096
  buffer_load_dwordx4 a[28:31], v1, s[8:11], s3 offen offset:3072 sc1
  s_add_u32 s3, s42, 8192
  buffer_load_dwordx4 a[32:35], v1, s[8:11], s3 offen offset:0 sc1
  s_waitcnt lgkmcnt(5)
  v_mfma_f32_32x32x16_bf16 v[152:167], v[92:95], v[204:207], v[152:167]
  ds_read_b128 v[204:207], v1 offset:50176
  s_waitcnt lgkmcnt(5)
  v_mfma_f32_32x32x16_bf16 v[136:151], v[100:103], v[188:191], v[136:151]
  ds_read_b128 v[188:191], v1 offset:22528
  s_add_u32 s3, s42, 8192
  buffer_load_dwordx4 a[36:39], v1, s[8:11], s3 offen offset:1024 sc1
  s_waitcnt lgkmcnt(5)
  v_mfma_f32_32x32x16_bf16 v[152:167], v[96:99], v[196:199], v[152:167]
  ds_read_b128 v[196:199], v1 offset:51200
  buffer_load_dwordx4 v1, s[8:11], s57 offen offset:1024 sc1 lds
  s_waitcnt lgkmcnt(5)
  v_mfma_f32_32x32x16_bf16 v[152:167], v[100:103], v[200:203], v[152:167]
  ds_read_b128 v[200:203], v1 offset:52224
  s_waitcnt vmcnt(16)
  s_barrier
  s_add_u32 s3, s42, 8192
  buffer_load_dwordx4 a[40:43], v1, s[8:11], s3 offen offset:2048 sc1
  s_waitcnt lgkmcnt(5)
  v_mfma_f32_32x32x16_bf16 v[136:151], v[104:107], v[192:195], v[136:151]
  ds_read_b128 v[192:195], v1 offset:23552
  s_waitcnt lgkmcnt(5)
  v_mfma_f32_32x32x16_bf16 v[136:151], v[108:111], v[184:187], v[136:151]
  ds_read_b128 v[184:187], v1 offset:24576
  buffer_load_dwordx4 v1, s[8:11], s57 offen offset:2048 sc1 lds
  s_add_u32 s3, s42, 8192
  buffer_load_dwordx4 a[44:47], v1, s[8:11], s3 offen offset:3072 sc1
  s_waitcnt lgkmcnt(5)
  v_mfma_f32_32x32x16_bf16 v[152:167], v[104:107], v[204:207], v[152:167]
  ds_read_b128 v[204:207], v1 offset:53248
  s_waitcnt lgkmcnt(5)
  v_mfma_f32_32x32x16_bf16 v[136:151], v[112:115], v[188:191], v[136:151]
  ds_read_b128 v[188:191], v1 offset:25600
  s_add_u32 s3, s42, 12288
  buffer_load_dwordx4 a[48:51], v1, s[8:11], s3 offen offset:0 sc1
  s_waitcnt lgkmcnt(5)
  v_mfma_f32_32x32x16_bf16 v[152:167], v[108:111], v[196:199], v[152:167]
  ds_read_b128 v[196:199], v1 offset:54272
  s_waitcnt lgkmcnt(5)
  v_mfma_f32_32x32x16_bf16 v[152:167], v[112:115], v[200:203], v[152:167]
  ds_read_b128 v[200:203], v1 offset:55296
  buffer_load_dwordx4 v1, s[8:11], s57 offen offset:3072 sc1 lds
  s_add_u32 s3, s42, 12288
  buffer_load_dwordx4 a[52:55], v1, s[8:11], s3 offen offset:1024 sc1
  s_waitcnt lgkmcnt(5)
  v_mfma_f32_32x32x16_bf16 v[136:151], v[116:119], v[192:195], v[136:151]
  ds_read_b128 v[192:195], v1 offset:26624
  s_waitcnt lgkmcnt(5)
  v_mfma_f32_32x32x16_bf16 v[136:151], v[120:123], v[184:187], v[136:151]
  ds_read_b128 v[184:187], v1 offset:27648
  s_add_u32 s3, s42, 12288
  buffer_load_dwordx4 a[56:59], v1, s[8:11], s3 offen offset:2048 sc1
  s_waitcnt lgkmcnt(5)
  v_mfma_f32_32x32x16_bf16 v[152:167], v[116:119], v[204:207], v[152:167]
  ds_read_b128 v[204:207], v1 offset:56320
  s_add_u32 m0, s21, 112640
  s_add_u32 s57, s41, s21
  s_add_u32 s57, s57, 8192
  buffer_load_dwordx4 v1, s[8:11], s57 offen offset:0 sc1 lds
  s_waitcnt lgkmcnt(5)
  v_mfma_f32_32x32x16_bf16 v[136:151], v[124:127], v[188:191], v[136:151]
  ds_read_b128 v[188:191], v1 offset:28672
  s_add_u32 s3, s42, 12288
  buffer_load_dwordx4 a[60:63], v1, s[8:11], s3 offen offset:3072 sc1
  s_waitcnt lgkmcnt(5)
  v_mfma_f32_32x32x16_bf16 v[152:167], v[120:123], v[196:199], v[152:167]
  ds_read_b128 v[196:199], v1 offset:57344
  s_add_u32 s3, s42, 16384
  buffer_load_dwordx4 a[64:67], v1, s[8:11], s3 offen offset:0 sc1
  s_waitcnt lgkmcnt(5)
  v_mfma_f32_32x32x16_bf16 v[152:167], v[124:127], v[200:203], v[152:167]
  ds_read_b128 v[200:203], v1 offset:58368
  s_waitcnt lgkmcnt(5)
  v_mfma_f32_32x32x16_bf16 v[136:151], v[128:131], v[192:195], v[136:151]
  ds_read_b128 v[192:195], v12 offset:9216
  buffer_load_dwordx4 v1, s[8:11], s57 offen offset:1024 sc1 lds
  s_add_u32 s3, s42, 16384
  buffer_load_dwordx4 a[68:71], v1, s[8:11], s3 offen offset:1024 sc1
  s_waitcnt lgkmcnt(5)
  v_mfma_f32_32x32x16_bf16 v[136:151], v[132:135], v[184:187], v[136:151]
  ds_read_b128 v[184:187], v12 offset:11264
  s_and_b32 s6, s17, 3
  s_lshl_b32 s6, s6, 2
  s_add_u32 s6, s6, s16
  s_lshl_b32 s6, s6, 10
  s_add_u32 s6, s6, M_wo0-M_start
  s_min_u32 s6, s6, M_last-M_start-1024
  buffer_load_dword v11, v1, s[96:99], s6 offen
  s_waitcnt lgkmcnt(5)
  v_mfma_f32_32x32x16_bf16 v[152:167], v[128:131], v[204:207], v[152:167]
  ds_read_b128 v[204:207], v12 offset:10240
  s_add_u32 s3, s42, 16384
  buffer_load_dwordx4 a[72:75], v1, s[8:11], s3 offen offset:2048 sc1
  s_waitcnt lgkmcnt(5)
  v_mfma_f32_32x32x16_bf16 v[136:151], v[208:211], v[188:191], v[136:151]
  s_barrier
  ds_read_b128 v[188:191], v12 offset:13312
  s_waitcnt lgkmcnt(5)
  v_mfma_f32_32x32x16_bf16 v[152:167], v[132:135], v[196:199], v[152:167]
  ds_read_b128 v[196:199], v12 offset:12288
  buffer_load_dwordx4 v1, s[8:11], s57 offen offset:2048 sc1 lds
  s_add_u32 s3, s42, 16384
  buffer_load_dwordx4 a[76:79], v1, s[8:11], s3 offen offset:3072 sc1
  s_waitcnt lgkmcnt(5)
  v_mfma_f32_32x32x16_bf16 v[152:167], v[208:211], v[200:203], v[152:167]
  ds_read_b128 v[200:203], v12 offset:14336
  s_nop 1
  v_mul_f32 v136, v136, v240
  v_mul_f32 v137, v137, v241
  v_mul_f32 v138, v138, v242
  v_mul_f32 v139, v139, v243
  v_exp_f32 v212, v136 clamp
  v_max_f32 v213, 0, v136
  v_exp_f32 v214, v137 clamp
  v_max_f32 v215, 0, v137
  v_exp_f32 v216, v138 clamp
  v_max_f32 v217, 0, v138
  v_exp_f32 v218, v139 clamp
  v_max_f32 v219, 0, v139
  v_fma_f32 v213, v213, s23, v14
  v_fma_f32 v215, v215, s23, v14
  v_fma_f32 v217, v217, s23, v14
  v_fma_f32 v219, v219, s23, v14
  v_mul_f32 v140, v140, v244
  s_waitcnt lgkmcnt(5)
  v_mfma_f32_32x32x16_bf16 v[168:183], v[192:195], v[24:27], 0
  ds_read_b128 v[192:195], v12 offset:15360
  s_add_u32 s3, s42, 20480
  buffer_load_dwordx4 a[80:83], v1, s[8:11], s3 offen offset:0 sc1
  v_mul_f32 v141, v141, v245
  v_mul_f32 v142, v142, v246
  v_mul_f32 v143, v143, v247
  v_add_f32 v136, v213, v212
  v_add_f32 v137, v215, v214
  v_add_f32 v138, v217, v216
  v_add_f32 v139, v219, v218
  v_exp_f32 v212, v140 clamp
  v_max_f32 v213, 0, v140
  v_exp_f32 v214, v141 clamp
  v_max_f32 v215, 0, v141
  v_exp_f32 v216, v142 clamp
  v_max_f32 v217, 0, v142
  v_max_f32 v219, 0, v143
  s_waitcnt lgkmcnt(4)
  v_mfma_f32_32x32x16_bf16 v[168:183], v[204:207], v[28:31], v[168:183]
  ds_read_b128 v[204:207], v12 offset:16384
  buffer_load_dwordx4 v1, s[8:11], s57 offen offset:3072 sc1 lds
  v_exp_f32 v218, v143 clamp
  v_fma_f32 v213, v213, s23, v14
  v_fma_f32 v215, v215, s23, v14
  v_fma_f32 v217, v217, s23, v14
  v_fma_f32 v219, v219, s23, v14
  v_mul_f32 v144, v144, v248
  v_mul_f32 v145, v145, v249
  v_mul_f32 v146, v146, v250
  v_mul_f32 v147, v147, v251
  v_add_f32 v140, v213, v212
  v_add_f32 v141, v215, v214
  v_add_f32 v142, v217, v216
  v_add_f32 v143, v219, v218
  v_mul_f32 v152, v152, v224
  v_mul_f32 v153, v153, v225
  v_exp_f32 v212, v144 clamp
  v_mfma_f32_32x32x16_bf16 v[168:183], v[184:187], v[32:35], v[168:183]
  ds_read_b128 v[184:187], v12 offset:17408
  s_add_u32 s3, s42, 20480
  buffer_load_dwordx4 a[84:87], v1, s[8:11], s3 offen offset:1024 sc1
  v_max_f32 v213, 0, v144
  v_exp_f32 v214, v145 clamp
  v_max_f32 v215, 0, v145
  v_exp_f32 v216, v146 clamp
  v_max_f32 v217, 0, v146
  v_exp_f32 v218, v147 clamp
  v_max_f32 v219, 0, v147
  v_mul_f32 v154, v154, v226
  v_mul_f32 v155, v155, v227
  v_cvt_pk_bf16_f32 v136, v136, v137
  v_mul_f32 v156, v156, v228
  v_mul_f32 v157, v157, v229
  v_mul_f32 v158, v158, v230
  v_mul_f32 v159, v159, v231
  s_waitcnt lgkmcnt(4)
  v_mfma_f32_32x32x16_bf16 v[168:183], v[196:199], v[36:39], v[168:183]
  ds_read_b128 v[196:199], v12 offset:18432
  s_xor_b32 s7, s30, 0
  buffer_load_dwordx4 v[24:27], v1, s[8:11], s7 offen offset:0 sc1
  v_cvt_pk_bf16_f32 v152, v152, v153
  v_fma_f32 v213, v213, s23, v14
  v_fma_f32 v215, v215, s23, v14
  v_fma_f32 v217, v217, s23, v14
  v_fma_f32 v219, v219, s23, v14
  v_cvt_pk_bf16_f32 v137, v138, v139
  v_cvt_pk_bf16_f32 v153, v154, v155
  v_mul_f32 v148, v148, v252
  v_mul_f32 v149, v149, v253
  v_mul_f32 v150, v150, v254
  v_mul_f32 v151, v151, v255
  v_cvt_pk_bf16_f32 v138, v140, v141
  v_cvt_pk_bf16_f32 v139, v142, v143
  v_cvt_pk_bf16_f32 v154, v156, v157
  v_cvt_pk_bf16_f32 v155, v158, v159
  v_add_f32 v144, v213, v212
  v_add_f32 v145, v215, v214
  v_mfma_f32_32x32x16_bf16 v[168:183], v[188:191], v[40:43], v[168:183]
  ds_read_b128 v[188:191], v12 offset:19456
  s_add_u32 s3, s42, 20480
  buffer_load_dwordx4 a[88:91], v1, s[8:11], s3 offen offset:2048 sc1
  v_add_f32 v146, v217, v216
  v_add_f32 v147, v219, v218
  v_exp_f32 v212, v148 clamp
  v_max_f32 v213, 0, v148
  v_exp_f32 v214, v149 clamp
  v_max_f32 v215, 0, v149
  v_exp_f32 v216, v150 clamp
  v_max_f32 v217, 0, v150
  v_exp_f32 v218, v151 clamp
  v_max_f32 v219, 0, v151
  v_cndmask_b32 v136, 0, v136, s[48:49]
  v_cndmask_b32 v137, 0, v137, s[48:49]
  v_cndmask_b32 v138, 0, v138, s[48:49]
  s_waitcnt lgkmcnt(5)
  v_mfma_f32_32x32x16_bf16 v[168:183], v[200:203], v[44:47], v[168:183]
  ds_read_b128 v[200:203], v12 offset:20480
  s_add_u32 m0, s21, 116736
  s_add_u32 s57, s41, s21
  s_add_u32 s57, s57, 12288
  buffer_load_dwordx4 v1, s[8:11], s57 offen offset:0 sc1 lds
  s_add_u32 s3, s42, 20480
  buffer_load_dwordx4 a[92:95], v1, s[8:11], s3 offen offset:3072 sc1
  s_xor_b32 s7, s30, 0
  buffer_load_dwordx4 v[28:31], v1, s[8:11], s7 offen offset:1024 sc1
  v_cndmask_b32 v139, 0, v139, s[48:49]
  v_cndmask_b32 v152, v152, v15, s[50:51]
  v_cndmask_b32 v153, v153, v15, s[50:51]
  v_cndmask_b32 v154, v154, v15, s[50:51]
  v_cndmask_b32 v155, v155, v15, s[50:51]
  v_fma_f32 v213, v213, s23, v14
  v_fma_f32 v215, v215, s23, v14
  v_mfma_f32_32x32x16_bf16 v[240:255], v[136:139], v[152:155], 0
  v_fma_f32 v217, v217, s23, v14
  v_fma_f32 v219, v219, s23, v14
  v_add_f32 v148, v213, v212
  v_add_f32 v149, v215, v214
  v_add_f32 v150, v217, v216
  v_add_f32 v151, v219, v218
  v_mul_f32 v160, v160, v232
  v_mul_f32 v161, v161, v233
  v_mul_f32 v162, v162, v234
  v_mul_f32 v163, v163, v235
  v_mul_f32 v164, v164, v236
  v_mul_f32 v165, v165, v237
  v_mul_f32 v166, v166, v238
  v_mul_f32 v167, v167, v239
  v_cvt_pk_bf16_f32 v140, v144, v145
  v_cvt_pk_bf16_f32 v141, v146, v147
  v_cvt_pk_bf16_f32 v142, v148, v149
  v_cvt_pk_bf16_f32 v143, v150, v151
  v_cvt_pk_bf16_f32 v156, v160, v161
  v_cvt_pk_bf16_f32 v157, v162, v163
  v_cvt_pk_bf16_f32 v158, v164, v165
  s_waitcnt lgkmcnt(5)
  v_mfma_f32_32x32x16_bf16 v[168:183], v[192:195], v[48:51], v[168:183]
  ds_read_b128 v[192:195], v12 offset:21504
  s_add_u32 s3, s42, 24576
  buffer_load_dwordx4 a[96:99], v1, s[8:11], s3 offen offset:0 sc1
  s_xor_b32 s7, s30, 0
  buffer_load_dwordx4 v[32:35], v1, s[8:11], s7 offen offset:2048 sc1
  v_cvt_pk_bf16_f32 v159, v166, v167
  v_cndmask_b32 v140, 0, v140, s[48:49]
  v_cndmask_b32 v141, 0, v141, s[48:49]
  v_cndmask_b32 v142, 0, v142, s[48:49]
  v_cndmask_b32 v143, 0, v143, s[48:49]
  v_cndmask_b32 v156, v156, v15, s[50:51]
  v_cndmask_b32 v157, v157, v15, s[50:51]
  v_cndmask_b32 v158, v158, v15, s[50:51]
  v_cndmask_b32 v159, v159, v15, s[50:51]
  s_waitcnt lgkmcnt(5)
  v_mfma_f32_32x32x16_bf16 v[168:183], v[204:207], v[52:55], v[168:183]
  ds_read_b128 v[204:207], v12 offset:22528
  buffer_load_dwordx4 v1, s[8:11], s57 offen offset:1024 sc1 lds
  v_mfma_f32_32x32x16_bf16 v[240:255], v[140:143], v[156:159], v[240:255]
  s_add_u32 s3, s42, 24576
  buffer_load_dwordx4 a[100:103], v1, s[8:11], s3 offen offset:1024 sc1
  s_xor_b32 s7, s30, 0
  buffer_load_dwordx4 v[36:39], v1, s[8:11], s7 offen offset:3072 sc1
  s_waitcnt lgkmcnt(5)
  v_mfma_f32_32x32x16_bf16 v[168:183], v[184:187], v[56:59], v[168:183]
  ds_read_b128 v[184:187], v12 offset:23552
  s_waitcnt lgkmcnt(5)
  v_mfma_f32_32x32x16_bf16 v[168:183], v[196:199], v[60:63], v[168:183]
  s_nop 3
  ds_write_b128 v7, v[240:243] offset:0
  s_add_u32 s3, s42, 24576
  buffer_load_dwordx4 a[104:107], v1, s[8:11], s3 offen offset:2048 sc1
  s_waitcnt lgkmcnt(5)
  v_mfma_f32_32x32x16_bf16 v[168:183], v[188:191], v[64:67], v[168:183]
  ds_read_b128 v[196:199], v12 offset:24576
  s_xor_b32 s7, s30, 4096
  buffer_load_dwordx4 v[40:43], v1, s[8:11], s7 offen offset:0 sc1
  ds_write_b128 v7, v[244:247] offset:1024
  s_waitcnt lgkmcnt(6)
  v_mfma_f32_32x32x16_bf16 v[168:183], v[200:203], v[68:71], v[168:183]
  ds_read_b128 v[188:191], v12 offset:25600
  buffer_load_dwordx4 v1, s[8:11], s57 offen offset:2048 sc1 lds
  s_add_u32 s3, s42, 24576
  buffer_load_dwordx4 a[108:111], v1, s[8:11], s3 offen offset:3072 sc1
  s_waitcnt lgkmcnt(6)
  v_mfma_f32_32x32x16_bf16 v[168:183], v[192:195], v[72:75], v[168:183]
  ds_write_b128 v7, v[248:251] offset:2048
  s_xor_b32 s7, s30, 4096
  buffer_load_dwordx4 v[44:47], v1, s[8:11], s7 offen offset:1024 sc1
  s_waitcnt lgkmcnt(6)
  v_mfma_f32_32x32x16_bf16 v[168:183], v[204:207], v[76:79], v[168:183]
  ds_read_b128 v[200:203], v12 offset:26624
  s_add_u32 s3, s43, 0
  buffer_load_dwordx4 a[112:115], v1, s[8:11], s3 offen offset:0 sc1
  ds_write_b128 v7, v[252:255] offset:3072
  s_waitcnt lgkmcnt(7)
  v_mfma_f32_32x32x16_bf16 v[168:183], v[184:187], v[80:83], v[168:183]
  ds_read_b128 v[192:195], v12 offset:27648
  s_xor_b32 s7, s30, 4096
  buffer_load_dwordx4 v[48:51], v1, s[8:11], s7 offen offset:2048 sc1
  ds_read_b128 v[204:207], v12 offset:28672
  s_waitcnt lgkmcnt(7)
  v_mfma_f32_32x32x16_bf16 v[168:183], v[196:199], v[84:87], v[168:183]
  ds_read_b128 v[184:187], v12 offset:29696
  s_add_u32 s3, s43, 0
  buffer_load_dwordx4 a[116:119], v1, s[8:11], s3 offen offset:1024 sc1
  ds_read_b128 v[196:199], v12 offset:30720
  s_waitcnt lgkmcnt(7)
  v_mfma_f32_32x32x16_bf16 v[168:183], v[188:191], v[88:91], v[168:183]
  s_waitcnt lgkmcnt(4)
  s_barrier
  s_xor_b32 s7, s30, 4096
  buffer_load_dwordx4 v[52:55], v1, s[8:11], s7 offen offset:3072 sc1
  ds_read_b32 v224, v8 offset:0
  v_mfma_f32_32x32x16_bf16 v[168:183], v[200:203], v[92:95], v[168:183]
  ds_read_b32 v225, v8 offset:4096
  ds_read_b32 v226, v8 offset:8192
  ds_read_b32 v227, v8 offset:12288
  ds_read_b32 v228, v8 offset:256
  ds_read_b32 v229, v8 offset:4352
  ds_read_b32 v230, v8 offset:8448
  s_waitcnt lgkmcnt(10)
  v_mfma_f32_32x32x16_bf16 v[168:183], v[192:195], v[96:99], v[168:183]
  ds_read_b32 v231, v8 offset:12544
  ds_read_b32 v232, v8 offset:512
  ds_read_b32 v233, v8 offset:4608
  ds_read_b32 v234, v8 offset:8704
  ds_read_b32 v235, v8 offset:12800
  ds_read_b32 v236, v8 offset:768
  s_waitcnt lgkmcnt(15)
  v_mfma_f32_32x32x16_bf16 v[168:183], v[204:207], v[100:103], v[168:183]
  ds_read_b32 v237, v8 offset:4864
  ds_read_b32 v238, v8 offset:8960
  ds_read_b32 v239, v8 offset:13056
  ds_read_b128 v[188:191], v12 offset:31744
  ds_read_b128 v[200:203], v12 offset:32768
  ds_read_b128 v[192:195], v12 offset:33792
  s_waitcnt lgkmcnt(15)
  v_mfma_f32_32x32x16_bf16 v[168:183], v[184:187], v[104:107], v[168:183]
  ds_read_b128 v[204:207], v12 offset:34816
  ds_read_b128 v[184:187], v12 offset:35840
  v_add_f32 v224, v224, v225
  v_mfma_f32_32x32x16_bf16 v[168:183], v[196:199], v[108:111], v[168:183]
  ds_read_b128 v[196:199], v12 offset:36864
  v_add_f32 v226, v226, v227
  s_waitcnt lgkmcnt(15)
  v_add_f32 v228, v228, v229
  v_add_f32 v224, v224, v226
  buffer_atomic_add_f32 v224, v2, s[8:11], s59 offen offset:0
  s_waitcnt lgkmcnt(14)
  v_add_f32 v230, v230, v231
  s_waitcnt lgkmcnt(12)
  v_add_f32 v232, v232, v233
  s_waitcnt lgkmcnt(10)
  v_add_f32 v234, v234, v235
  v_add_f32 v228, v228, v230
  s_waitcnt lgkmcnt(8)
  v_add_f32 v236, v236, v237
  v_add_f32 v232, v232, v234
  s_waitcnt lgkmcnt(6)
  v_add_f32 v238, v238, v239
  s_waitcnt lgkmcnt(5)
  v_mfma_f32_32x32x16_bf16 v[168:183], v[188:191], v[112:115], v[168:183]
  buffer_atomic_add_f32 v228, v2, s[8:11], s59 offen offset:256
  buffer_atomic_add_f32 v232, v2, s[8:11], s59 offen offset:512
  ds_read_b128 v[188:191], v12 offset:37888
  v_add_f32 v236, v236, v238
  s_waitcnt lgkmcnt(5)
  v_mfma_f32_32x32x16_bf16 v[168:183], v[200:203], v[116:119], v[168:183]
  buffer_atomic_add_f32 v236, v2, s[8:11], s59 offen offset:768
  s_waitcnt lgkmcnt(4)
  v_mfma_f32_32x32x16_bf16 v[168:183], v[192:195], v[120:123], v[168:183]
  s_waitcnt lgkmcnt(3)
  v_mfma_f32_32x32x16_bf16 v[168:183], v[204:207], v[124:127], v[168:183]
  s_waitcnt lgkmcnt(2)
  v_mfma_f32_32x32x16_bf16 v[168:183], v[184:187], v[128:131], v[168:183]
  s_waitcnt lgkmcnt(1)
  v_mfma_f32_32x32x16_bf16 v[168:183], v[196:199], v[132:135], v[168:183]
  s_waitcnt lgkmcnt(0)
  v_mfma_f32_32x32x16_bf16 v[168:183], v[188:191], v[208:211], v[168:183]
  s_nop 7
  s_nop 4
  v_mul_f32 v168, v168, v223
  v_mul_f32 v169, v169, v223
  v_mul_f32 v170, v170, v223
  v_mul_f32 v171, v171, v223
  v_exp_f32 v212, v168 clamp
  v_max_f32 v213, 0, v168
  v_exp_f32 v214, v169 clamp
  v_max_f32 v215, 0, v169
  v_exp_f32 v216, v170 clamp
  v_max_f32 v217, 0, v170
  v_exp_f32 v218, v171 clamp
  v_max_f32 v219, 0, v171
  v_fma_f32 v213, v213, s23, v14
  v_fma_f32 v215, v215, s23, v14
  v_fma_f32 v217, v217, s23, v14
  v_fma_f32 v219, v219, s23, v14
  v_mul_f32 v172, v172, v223
  v_mul_f32 v173, v173, v223
  v_mul_f32 v174, v174, v223
  v_mul_f32 v175, v175, v223
  v_add_f32 v168, v213, v212
  v_add_f32 v169, v215, v214
  v_add_f32 v170, v217, v216
  v_add_f32 v171, v219, v218
  v_exp_f32 v212, v172 clamp
  v_max_f32 v213, 0, v172
  v_exp_f32 v214, v173 clamp
  v_max_f32 v215, 0, v173
  v_exp_f32 v216, v174 clamp
  v_max_f32 v217, 0, v174
  v_exp_f32 v218, v175 clamp
  v_max_f32 v219, 0, v175
  v_fma_f32 v213, v213, s23, v14
  v_fma_f32 v215, v215, s23, v14
  v_fma_f32 v217, v217, s23, v14
  v_fma_f32 v219, v219, s23, v14
  v_mul_f32 v176, v176, v223
  v_mul_f32 v177, v177, v223
  v_mul_f32 v178, v178, v223
  v_mul_f32 v179, v179, v223
  v_add_f32 v172, v213, v212
  v_add_f32 v173, v215, v214
  v_add_f32 v174, v217, v216
  v_add_f32 v175, v219, v218
  v_exp_f32 v212, v176 clamp
  v_max_f32 v213, 0, v176
  v_exp_f32 v214, v177 clamp
  v_max_f32 v215, 0, v177
  v_exp_f32 v216, v178 clamp
  v_max_f32 v217, 0, v178
  v_exp_f32 v218, v179 clamp
  v_max_f32 v219, 0, v179
  v_fma_f32 v213, v213, s23, v14
  v_fma_f32 v215, v215, s23, v14
  v_fma_f32 v217, v217, s23, v14
  v_fma_f32 v219, v219, s23, v14
  v_mul_f32 v180, v180, v223
  v_mul_f32 v181, v181, v223
  v_mul_f32 v182, v182, v223
  v_mul_f32 v183, v183, v223
  v_add_f32 v176, v213, v212
  v_add_f32 v177, v215, v214
  v_add_f32 v178, v217, v216
  v_add_f32 v179, v219, v218
  v_exp_f32 v212, v180 clamp
  v_max_f32 v213, 0, v180
  v_exp_f32 v214, v181 clamp
  v_max_f32 v215, 0, v181
  v_exp_f32 v216, v182 clamp
  v_max_f32 v217, 0, v182
  v_exp_f32 v218, v183 clamp
  v_max_f32 v219, 0, v183
  v_fma_f32 v213, v213, s23, v14
  v_fma_f32 v215, v215, s23, v14
  v_fma_f32 v217, v217, s23, v14
  v_fma_f32 v219, v219, s23, v14
  v_cvt_pk_bf16_f32 v168, v168, v169
  v_add_f32 v180, v213, v212
  v_add_f32 v181, v215, v214
  v_add_f32 v182, v217, v216
  v_add_f32 v183, v219, v218
  v_cvt_pk_bf16_f32 v169, v170, v171
  v_cvt_pk_bf16_f32 v170, v172, v173
  v_cvt_pk_bf16_f32 v171, v174, v175
  v_cvt_pk_bf16_f32 v172, v176, v177
  v_cvt_pk_bf16_f32 v173, v178, v179
  v_cvt_pk_bf16_f32 v174, v180, v181
  v_cvt_pk_bf16_f32 v175, v182, v183
  buffer_store_dwordx4 v[168:171], v1, s[8:11], s26 offen offset:0 sc1
  buffer_store_dwordx4 v[172:175], v1, s[8:11], s26 offen offset:1024 sc1
  s_waitcnt vmcnt(2)
  s_barrier
  s_lshr_b32 s6, s17, 3
  s_mul_i32 s6, s6, 14336
  s_and_b32 s3, s17, 7
  s_lshl_b32 s3, s3, 7
  s_add_u32 s6, s6, s3
  s_lshl_b32 s3, s45, 2
  s_add_u32 s6, s6, s3
  s_add_u32 s6, s6, 19016704
  buffer_store_dword v9, v6, s[8:11], s6 offen sc1
  s_waitcnt vmcnt(1)
  s_barrier
  s_cmp_lg_u32 s16, 0
  s_cbranch_scc1 M_nofl0
  s_cbranch_vccz Lpub_7
  s_mov_b64 exec, 1
  buffer_store_dword v15, v2, s[8:11], s28 offen offset:256
  s_mov_b64 exec, -1
Lpubr_8:
M_nofl0:
  v_mov_b32 v10, 1
  s_mul_i32 s44, s16, 6144
  s_lshl_b32 s19, s16, 11
  s_min_u32 s19, s19, 3072
  s_cmp_ge_u32 s17, 28
  s_cbranch_scc1 M_sp0
M_wo0:
  s_cmp_ge_u32 s17, 14
  s_cselect_b32 s58, 16, 0
  buffer_load_dword v6, v0, s[8:11], s29 offen offset:256 sc1
  s_xor_b32 s59, s30, 32768
  buffer_load_dwordx4 a[224:227], v1, s[8:11], s59 offen offset:0 sc1
  s_xor_b32 s59, s30, 32768
  buffer_load_dwordx4 a[228:231], v1, s[8:11], s59 offen offset:1024 sc1
  s_xor_b32 s59, s30, 32768
  buffer_load_dwordx4 a[232:235], v1, s[8:11], s59 offen offset:2048 sc1
  s_xor_b32 s59, s30, 32768
  buffer_load_dwordx4 a[236:239], v1, s[8:11], s59 offen offset:3072 sc1
  s_xor_b32 s59, s30, 36864
  buffer_load_dwordx4 a[240:243], v1, s[8:11], s59 offen offset:0 sc1
  s_xor_b32 s59, s30, 36864
  buffer_load_dwordx4 a[244:247], v1, s[8:11], s59 offen offset:1024 sc1
  s_xor_b32 s59, s30, 36864
  buffer_load_dwordx4 a[248:251], v1, s[8:11], s59 offen offset:2048 sc1
  s_xor_b32 s59, s30, 36864
  buffer_load_dwordx4 a[252:255], v1, s[8:11], s59 offen offset:3072 sc1
  s_xor_b32 s6, s16, 1
  s_mul_i32 s6, s6, 12288
  s_add_u32 s6, s6, 25600
  v_add_u32 v249, s6, v1
  s_xor_b32 s6, s16, 2
  s_mul_i32 s6, s6, 12288
  s_add_u32 s6, s6, 29696
  v_add_u32 v250, s6, v1
  s_xor_b32 s6, s16, 3
  s_mul_i32 s6, s6, 12288
  s_add_u32 s6, s6, 33792
  v_add_u32 v251, s6, v1
  s_mul_i32 s6, s16, 12288
  s_add_u32 s6, s6, 25600
  v_add_u32 v248, s6, v1
  v_and_b32 v11, 0x1c, v2
  s_mov_b32 s7, 18902016
  v_lshrrev_b32 v11, 5, v0
  v_mul_u32_u24 v11, 14336, v11
  v_and_b32 v7, 0x1c, v0
  v_lshl_add_u32 v11, v7, 5, v11
  v_lshrrev_b32 v7, 3, v2
  v_and_or_b32 v11, v7, 16, v11
  s_min_u32 s7, s16, 1
  s_lshl_b32 s7, s7, 30
  v_or_b32 v11, s7, v11
  s_mov_b32 s7, 19016704
  s_waitcnt vmcnt(8)
  v_cmp_ne_u32 s[54:55], 0, v6
  s_nop 0
  s_lshr_b32 s56, s54, s58
  s_and_b32 s56, s56, 0xffff
  s_cmp_eq_u32 s56, 0xffff
  s_cbranch_scc1 M_pqok0
  s_mov_b32 s46, 0
Lpoll_9:
  buffer_load_dword v6, v0, s[8:11], s29 offen offset:256 sc1
  s_add_u32 s46, s46, 1
  s_waitcnt vmcnt(0)
  v_cmp_ne_u32 s[54:55], 0, v6
  s_cmp_gt_u32 s46, 300000
  s_cbranch_scc1 Lpd_10
  s_lshr_b32 s56, s54, s58
  s_and_b32 s56, s56, 0xffff
  s_cmp_eq_u32 s56, 0xffff
  s_cbranch_scc0 Lpoll_9
Lpd_10:
M_pqok0:
  s_cbranch_vccz Lacq_11
Lacqr_12:
  s_xor_b32 s59, s32, 32768
  buffer_load_dwordx4 v[120:123], v1, s[8:11], s59 offen offset:0 sc1
  buffer_load_dwordx4 v[124:127], v1, s[8:11], s59 offen offset:1024 sc1
  buffer_load_dwordx4 v[128:131], v1, s[8:11], s59 offen offset:2048 sc1
  buffer_load_dwordx4 v[132:135], v1, s[8:11], s59 offen offset:3072 sc1
  buffer_load_dwordx4 v[6:9], v11, s[8:11], s7 offen sc1
  s_xor_b32 s59, s32, 36864
  buffer_load_dwordx4 v[136:139], v1, s[8:11], s59 offen offset:0 sc1
  buffer_load_dwordx4 v[140:143], v1, s[8:11], s59 offen offset:1024 sc1
  buffer_load_dwordx4 v[144:147], v1, s[8:11], s59 offen offset:2048 sc1
  buffer_load_dwordx4 v[148:151], v1, s[8:11], s59 offen offset:3072 sc1
  s_xor_b32 s59, s32, 0
  buffer_load_dwordx4 v[152:155], v1, s[8:11], s59 offen offset:0 sc1
  buffer_load_dwordx4 v[156:159], v1, s[8:11], s59 offen offset:1024 sc1
  buffer_load_dwordx4 v[160:163], v1, s[8:11], s59 offen offset:2048 sc1
  buffer_load_dwordx4 v[164:167], v1, s[8:11], s59 offen offset:3072 sc1
  s_cmp_lg_u32 s16, 0
  s_cbranch_scc1 M_kvok0
  s_waitcnt vmcnt(8)
  v_min3_u32 v6, v6, v7, v8
  v_min_u32 v6, v6, v9
  v_cmp_ne_u32 s[54:55], 0, v6
  s_nop 0
  s_cmp_eq_u64 s[54:55], exec
  s_cbranch_scc1 M_kvok0
  s_mov_b32 s46, 0
Lpoll_13:
  buffer_load_dwordx4 v[6:9], v11, s[8:11], s7 offen sc1
  s_add_u32 s46, s46, 1
  s_waitcnt vmcnt(0)
  v_min3_u32 v6, v6, v7, v8
  v_min_u32 v6, v6, v9
  v_cmp_ne_u32 s[54:55], 0, v6
  s_cmp_gt_u32 s46, 300000
  s_cbranch_scc1 Lpd_14
  s_cmp_eq_u64 s[54:55], exec
  s_cbranch_scc0 Lpoll_13
Lpd_14:
M_kvok0:
  s_barrier
  buffer_load_dwordx4 v[56:59], v1, s[8:11], s31 offen offset:0 sc1
  buffer_load_dwordx4 v[60:63], v1, s[8:11], s31 offen offset:1024 sc1
  buffer_load_dwordx4 v[64:67], v1, s[8:11], s31 offen offset:2048 sc1
  buffer_load_dwordx4 v[68:71], v1, s[8:11], s31 offen offset:3072 sc1
  s_add_u32 s58, s31, 4096
  buffer_load_dwordx4 v[72:75], v1, s[8:11], s58 offen offset:0 sc1
  buffer_load_dwordx4 v[76:79], v1, s[8:11], s58 offen offset:1024 sc1
  buffer_load_dwordx4 v[80:83], v1, s[8:11], s58 offen offset:2048 sc1
  buffer_load_dwordx4 v[84:87], v1, s[8:11], s58 offen offset:3072 sc1
  s_add_u32 s58, s31, 8192
  buffer_load_dwordx4 v[88:91], v1, s[8:11], s58 offen offset:0 sc1
  buffer_load_dwordx4 v[92:95], v1, s[8:11], s58 offen offset:1024 sc1
  buffer_load_dwordx4 v[96:99], v1, s[8:11], s58 offen offset:2048 sc1
  buffer_load_dwordx4 v[100:103], v1, s[8:11], s58 offen offset:3072 sc1
  s_add_u32 s58, s31, 12288
  buffer_load_dwordx4 v[104:107], v1, s[8:11], s58 offen offset:0 sc1
  s_waitcnt vmcnt(12)
  v_cvt_pk_bf16_f32 v56, v56, v57
  v_cvt_pk_bf16_f32 v57, v58, v59
  buffer_load_dwordx4 v[108:111], v1, s[8:11], s58 offen offset:1024 sc1
  s_waitcnt vmcnt(12)
  v_cvt_pk_bf16_f32 v58, v60, v61
  v_cvt_pk_bf16_f32 v59, v62, v63
  s_nop 1
  v_mfma_f32_32x32x16_bf16 v[184:199], v[56:59], v[120:123], 0
  buffer_load_dwordx4 v[112:115], v1, s[8:11], s58 offen offset:2048 sc1
  s_waitcnt vmcnt(12)
  v_cvt_pk_bf16_f32 v60, v64, v65
  v_cvt_pk_bf16_f32 v61, v66, v67
  buffer_load_dwordx4 v[116:119], v1, s[8:11], s58 offen offset:3072 sc1
  s_waitcnt vmcnt(12)
  v_cvt_pk_bf16_f32 v62, v68, v69
  v_cvt_pk_bf16_f32 v63, v70, v71
  s_nop 1
  v_mfma_f32_32x32x16_bf16 v[184:199], v[60:63], v[124:127], v[184:199]
  s_xor_b32 s59, s32, 4096
  buffer_load_dwordx4 v[168:171], v1, s[8:11], s59 offen offset:0 sc1
  s_waitcnt vmcnt(12)
  v_cvt_pk_bf16_f32 v64, v72, v73
  v_cvt_pk_bf16_f32 v65, v74, v75
  s_nop 7
  v_add_f32 v252, v14, v196
  v_rcp_f32 v252, v252
  buffer_load_dwordx4 v[172:175], v1, s[8:11], s59 offen offset:1024 sc1
  s_waitcnt vmcnt(12)
  v_cvt_pk_bf16_f32 v66, v76, v77
  v_cvt_pk_bf16_f32 v67, v78, v79
  v_mov_b32 v253, v252
  s_nop 0
  v_mfma_f32_32x32x16_bf16 v[200:215], v[64:67], v[128:131], 0
  v_permlane32_swap_b32 v252, v253
  v_mul_f32 v184, v184, v253
  v_mul_f32 v185, v185, v253
  v_mul_f32 v186, v186, v253
  buffer_load_dwordx4 v[176:179], v1, s[8:11], s59 offen offset:2048 sc1
  s_waitcnt vmcnt(12)
  v_cvt_pk_bf16_f32 v68, v80, v81
  v_cvt_pk_bf16_f32 v69, v82, v83
  v_mul_f32 v187, v187, v253
  v_mul_f32 v188, v188, v253
  v_mul_f32 v189, v189, v253
  v_mul_f32 v190, v190, v253
  v_mul_f32 v191, v191, v253
  v_mul_f32 v192, v192, v253
  v_mul_f32 v193, v193, v253
  v_mul_f32 v194, v194, v253
  v_mul_f32 v195, v195, v253
  buffer_load_dwordx4 v[180:183], v1, s[8:11], s59 offen offset:3072 sc1
  s_waitcnt vmcnt(12)
  v_cvt_pk_bf16_f32 v70, v84, v85
  v_cvt_pk_bf16_f32 v71, v86, v87
  v_mul_f32 v196, v196, v253
  v_mul_f32 v197, v197, v253
  v_mfma_f32_32x32x16_bf16 v[200:215], v[68:71], v[132:135], v[200:215]
  v_mul_f32 v198, v198, v253
  v_mul_f32 v199, v199, v253
  v_cvt_pk_bf16_f32 v120, v184, v185
  v_cvt_pk_bf16_f32 v121, v186, v187
  v_cvt_pk_bf16_f32 v122, v188, v189
  s_waitcnt vmcnt(11)
  v_cvt_pk_bf16_f32 v72, v88, v89
  v_cvt_pk_bf16_f32 v73, v90, v91
  v_cvt_pk_bf16_f32 v123, v190, v191
  v_cvt_pk_bf16_f32 v124, v192, v193
  v_cvt_pk_bf16_f32 v125, v194, v195
  v_mfma_f32_32x32x16_bf16 v[216:231], v[24:27], v[120:123], 0
  v_cvt_pk_bf16_f32 v126, v196, v197
  v_cvt_pk_bf16_f32 v127, v198, v199
  v_lshlrev_b32 v88, 16, v16
  v_add_f32 v254, v14, v212
  v_and_b32 v89, 0xffff0000, v16
  v_rcp_f32 v254, v254
  v_mfma_f32_32x32x16_bf16 v[232:247], a[224:227], v[120:123], 0
  s_add_u32 m0, s20, 74752
  s_add_u32 s57, s4, 59392
  buffer_load_dwordx4 v1, s[8:11], s57 offen offset:0 sc1 lds
  s_waitcnt vmcnt(11)
  v_cvt_pk_bf16_f32 v74, v92, v93
  v_cvt_pk_bf16_f32 v75, v94, v95
  v_mov_b32 v255, v254
  v_mfma_f32_32x32x16_bf16 v[216:231], v[28:31], v[124:127], v[216:231]
  v_lshlrev_b32 v90, 16, v17
  v_permlane32_swap_b32 v254, v255
  v_and_b32 v91, 0xffff0000, v17
  v_mul_f32 v200, v200, v255
  v_mul_f32 v201, v201, v255
  v_mul_f32 v202, v202, v255
  v_mfma_f32_32x32x16_bf16 v[184:199], v[72:75], v[136:139], 0
  buffer_load_dwordx4 v1, s[8:11], s57 offen offset:1024 sc1 lds
  s_waitcnt vmcnt(11)
  v_cvt_pk_bf16_f32 v76, v96, v97
  v_cvt_pk_bf16_f32 v77, v98, v99
  v_mul_f32 v203, v203, v255
  v_mul_f32 v204, v204, v255
  v_mul_f32 v205, v205, v255
  v_mul_f32 v206, v206, v255
  v_mul_f32 v207, v207, v255
  v_mul_f32 v208, v208, v255
  v_mfma_f32_32x32x16_bf16 v[232:247], a[228:231], v[124:127], v[232:247]
  s_add_u32 s3, s43, 0
  buffer_load_dwordx4 a[120:123], v1, s[8:11], s3 offen offset:2048 sc1
  s_waitcnt vmcnt(11)
  v_cvt_pk_bf16_f32 v78, v100, v101
  v_cvt_pk_bf16_f32 v79, v102, v103
  v_mul_f32 v209, v209, v255
  v_mul_f32 v210, v210, v255
  v_mfma_f32_32x32x16_bf16 v[184:199], v[76:79], v[140:143], v[184:199]
  buffer_load_dwordx4 v1, s[8:11], s57 offen offset:2048 sc1 lds
  v_mul_f32 v211, v211, v255
  v_mul_f32 v212, v212, v255
  v_mul_f32 v213, v213, v255
  v_mul_f32 v214, v214, v255
  v_mul_f32 v215, v215, v255
  v_cvt_pk_bf16_f32 v128, v200, v201
  v_cvt_pk_bf16_f32 v129, v202, v203
  v_cvt_pk_bf16_f32 v130, v204, v205
  s_waitcnt vmcnt(11)
  v_cvt_pk_bf16_f32 v80, v104, v105
  v_cvt_pk_bf16_f32 v81, v106, v107
  v_cvt_pk_bf16_f32 v131, v206, v207
  v_cvt_pk_bf16_f32 v132, v208, v209
  v_cvt_pk_bf16_f32 v133, v210, v211
  v_mfma_f32_32x32x16_bf16 v[216:231], v[32:35], v[128:131], v[216:231]
  s_add_u32 s3, s43, 0
  buffer_load_dwordx4 a[124:127], v1, s[8:11], s3 offen offset:3072 sc1
  v_cvt_pk_bf16_f32 v134, v212, v213
  v_cvt_pk_bf16_f32 v135, v214, v215
  v_add_f32 v252, v14, v196
  v_mfma_f32_32x32x16_bf16 v[232:247], a[232:235], v[128:131], v[232:247]
  buffer_load_dwordx4 v1, s[8:11], s57 offen offset:3072 sc1 lds
  s_waitcnt vmcnt(12)
  v_cvt_pk_bf16_f32 v82, v108, v109
  v_cvt_pk_bf16_f32 v83, v110, v111
  v_rcp_f32 v252, v252
  s_nop 0
  v_mfma_f32_32x32x16_bf16 v[200:215], v[80:83], v[144:147], 0
  s_add_u32 s3, s43, 4096
  buffer_load_dwordx4 a[128:131], v1, s[8:11], s3 offen offset:0 sc1
  v_mov_b32 v253, v252
  v_lshlrev_b32 v92, 16, v18
  v_and_b32 v93, 0xffff0000, v18
  v_permlane32_swap_b32 v252, v253
  v_mfma_f32_32x32x16_bf16 v[216:231], v[36:39], v[132:135], v[216:231]
  s_add_u32 m0, s20, 78848
  s_add_u32 s57, s4, 63488
  buffer_load_dwordx4 v1, s[8:11], s57 offen offset:0 sc1 lds
  s_waitcnt vmcnt(13)
  v_cvt_pk_bf16_f32 v84, v112, v113
  v_cvt_pk_bf16_f32 v85, v114, v115
  v_mul_f32 v184, v184, v253
  v_mul_f32 v185, v185, v253
  v_mul_f32 v186, v186, v253
  v_mul_f32 v187, v187, v253
  v_mfma_f32_32x32x16_bf16 v[232:247], a[236:239], v[132:135], v[232:247]
  s_add_u32 s3, s43, 4096
  buffer_load_dwordx4 a[132:135], v1, s[8:11], s3 offen offset:1024 sc1
  s_waitcnt vmcnt(13)
  v_cvt_pk_bf16_f32 v86, v116, v117
  v_cvt_pk_bf16_f32 v87, v118, v119
  v_mul_f32 v188, v188, v253
  v_mul_f32 v189, v189, v253
  v_mfma_f32_32x32x16_bf16 v[200:215], v[84:87], v[148:151], v[200:215]
  buffer_load_dwordx4 v1, s[8:11], s57 offen offset:1024 sc1 lds
  v_mul_f32 v190, v190, v253
  v_mul_f32 v191, v191, v253
  v_mul_f32 v192, v192, v253
  v_mul_f32 v193, v193, v253
  v_mul_f32 v194, v194, v253
  v_mul_f32 v195, v195, v253
  v_mul_f32 v196, v196, v253
  v_mul_f32 v197, v197, v253
  v_mul_f32 v198, v198, v253
  v_mul_f32 v199, v199, v253
  v_cvt_pk_bf16_f32 v136, v184, v185
  v_cvt_pk_bf16_f32 v137, v186, v187
  v_cvt_pk_bf16_f32 v138, v188, v189
  v_cvt_pk_bf16_f32 v139, v190, v191
  v_cvt_pk_bf16_f32 v140, v192, v193
  v_cvt_pk_bf16_f32 v141, v194, v195
  v_mfma_f32_32x32x16_bf16 v[216:231], v[40:43], v[136:139], v[216:231]
  s_add_u32 s3, s43, 4096
  buffer_load_dwordx4 a[136:139], v1, s[8:11], s3 offen offset:2048 sc1
  v_cvt_pk_bf16_f32 v142, v196, v197
  v_cvt_pk_bf16_f32 v143, v198, v199
  v_add_f32 v254, v14, v212
  v_mfma_f32_32x32x16_bf16 v[184:199], v[56:59], v[152:155], 0
  buffer_load_dwordx4 v1, s[8:11], s57 offen offset:2048 sc1 lds
  v_rcp_f32 v254, v254
  v_lshlrev_b32 v94, 16, v19
  v_and_b32 v95, 0xffff0000, v19
  v_mfma_f32_32x32x16_bf16 v[184:199], v[60:63], v[156:159], v[184:199]
  s_add_u32 s3, s43, 4096
  buffer_load_dwordx4 a[140:143], v1, s[8:11], s3 offen offset:3072 sc1
  v_mov_b32 v255, v254
  v_lshlrev_b32 v96, 16, v20
  v_and_b32 v97, 0xffff0000, v20
  v_mfma_f32_32x32x16_bf16 v[232:247], a[240:243], v[136:139], v[232:247]
  buffer_load_dwordx4 v1, s[8:11], s57 offen offset:3072 sc1 lds
  v_permlane32_swap_b32 v254, v255
  v_lshlrev_b32 v98, 16, v21
  v_mul_f32 v200, v200, v255
  v_mul_f32 v201, v201, v255
  v_mfma_f32_32x32x16_bf16 v[216:231], v[44:47], v[140:143], v[216:231]
  v_mul_f32 v202, v202, v255
  v_mul_f32 v203, v203, v255
  v_mul_f32 v204, v204, v255
  v_mul_f32 v205, v205, v255
  v_mul_f32 v206, v206, v255
  v_mul_f32 v207, v207, v255
  v_mul_f32 v208, v208, v255
  v_mul_f32 v209, v209, v255
  v_mul_f32 v210, v210, v255
  v_mul_f32 v211, v211, v255
  v_mfma_f32_32x32x16_bf16 v[232:247], a[244:247], v[140:143], v[232:247]
  s_add_u32 m0, s44, 0
  s_add_u32 s57, s41, s44
  s_add_u32 s57, s57, 89088
  buffer_load_dwordx4 v1, s[8:11], s57 offen offset:0 sc1 lds
  s_add_u32 s3, s43, 8192
  buffer_load_dwordx4 a[144:147], v1, s[8:11], s3 offen offset:0 sc1
  v_mul_f32 v212, v212, v255
  v_mul_f32 v213, v213, v255
  v_mul_f32 v214, v214, v255
  v_mul_f32 v215, v215, v255
  v_cvt_pk_bf16_f32 v144, v200, v201
  v_cvt_pk_bf16_f32 v145, v202, v203
  v_cvt_pk_bf16_f32 v146, v204, v205
  v_cvt_pk_bf16_f32 v147, v206, v207
  v_cvt_pk_bf16_f32 v148, v208, v209
  v_cvt_pk_bf16_f32 v149, v210, v211
  v_mfma_f32_32x32x16_bf16 v[216:231], v[48:51], v[144:147], v[216:231]
  v_cvt_pk_bf16_f32 v150, v212, v213
  v_cvt_pk_bf16_f32 v151, v214, v215
  v_add_f32 v252, v14, v196
  v_and_b32 v99, 0xffff0000, v21
  v_rcp_f32 v252, v252
  v_mfma_f32_32x32x16_bf16 v[200:215], v[64:67], v[160:163], 0
  buffer_load_dwordx4 v1, s[8:11], s57 offen offset:1024 sc1 lds
  s_add_u32 s3, s43, 8192
  buffer_load_dwordx4 a[148:151], v1, s[8:11], s3 offen offset:1024 sc1
  v_mfma_f32_32x32x16_bf16 v[200:215], v[68:71], v[164:167], v[200:215]
  v_mov_b32 v253, v252
  v_lshlrev_b32 v100, 16, v22
  v_and_b32 v101, 0xffff0000, v22
  v_permlane32_swap_b32 v252, v253
  v_lshlrev_b32 v102, 16, v23
  v_mul_f32 v184, v184, v253
  v_mfma_f32_32x32x16_bf16 v[232:247], a[248:251], v[144:147], v[232:247]
  buffer_load_dwordx4 v1, s[8:11], s57 offen offset:2048 sc1 lds
  s_add_u32 s3, s43, 8192
  buffer_load_dwordx4 a[152:155], v1, s[8:11], s3 offen offset:2048 sc1
  v_mfma_f32_32x32x16_bf16 v[216:231], v[52:55], v[148:151], v[216:231]
  v_mul_f32 v185, v185, v253
  v_mul_f32 v186, v186, v253
  v_mul_f32 v187, v187, v253
  v_mul_f32 v188, v188, v253
  v_mul_f32 v189, v189, v253
  v_mul_f32 v190, v190, v253
  v_mfma_f32_32x32x16_bf16 v[232:247], a[252:255], v[148:151], v[232:247]
  buffer_load_dwordx4 v1, s[8:11], s57 offen offset:3072 sc1 lds
  s_add_u32 s3, s43, 8192
  buffer_load_dwordx4 a[156:159], v1, s[8:11], s3 offen offset:3072 sc1
  v_mul_f32 v191, v191, v253
  v_mul_f32 v192, v192, v253
  v_mul_f32 v193, v193, v253
  v_mul_f32 v194, v194, v253
  v_mul_f32 v195, v195, v253
  v_mul_f32 v196, v196, v253
  v_mul_f32 v197, v197, v253
  v_mul_f32 v198, v198, v253
  v_mul_f32 v199, v199, v253
  v_cvt_pk_bf16_f32 v152, v184, v185
  v_cvt_pk_bf16_f32 v153, v186, v187
  v_cvt_pk_bf16_f32 v154, v188, v189
  v_cvt_pk_bf16_f32 v155, v190, v191
  v_cvt_pk_bf16_f32 v156, v192, v193
  v_cvt_pk_bf16_f32 v157, v194, v195
  v_mfma_f32_32x32x16_bf16 v[104:119], a[224:227], v[152:155], 0
  ds_write_b128 v250, v[216:219] offset:0
  v_cvt_pk_bf16_f32 v158, v196, v197
  v_cvt_pk_bf16_f32 v159, v198, v199
  v_add_f32 v254, v14, v212
  s_waitcnt vmcnt(25)
  v_mfma_f32_32x32x16_bf16 v[184:199], v[72:75], v[168:171], 0
  s_add_u32 m0, s44, 4096
  s_add_u32 s57, s41, s44
  s_add_u32 s57, s57, 93184
  buffer_load_dwordx4 v1, s[8:11], s57 offen offset:0 sc1 lds
  s_waitcnt vmcnt(25)
  v_mfma_f32_32x32x16_bf16 v[184:199], v[76:79], v[172:175], v[184:199]
  s_add_u32 s3, s43, 12288
  buffer_load_dwordx4 a[160:163], v1, s[8:11], s3 offen offset:0 sc1
  ds_write_b128 v250, v[220:223] offset:1024
  v_mfma_f32_32x32x16_bf16 v[104:119], a[228:231], v[156:159], v[104:119]
  buffer_load_dwordx4 v1, s[8:11], s57 offen offset:1024 sc1 lds
  s_add_u32 s3, s43, 12288
  buffer_load_dwordx4 a[164:167], v1, s[8:11], s3 offen offset:1024 sc1
  v_rcp_f32 v254, v254
  s_nop 4
  v_add_f32 v252, v14, v196
  ds_write_b128 v250, v[224:227] offset:2048
  v_mov_b32 v255, v254
  v_rcp_f32 v252, v252
  s_nop 0
  v_permlane32_swap_b32 v254, v255
  v_and_b32 v103, 0xffff0000, v23
  v_mul_f32 v200, v200, v255
  v_mul_f32 v201, v201, v255
  v_mfma_f32_32x32x16_bf16 v[88:103], v[24:27], v[152:155], v[88:103]
  ds_write_b128 v250, v[228:231] offset:3072
  v_mul_f32 v202, v202, v255
  v_mul_f32 v203, v203, v255
  v_mul_f32 v204, v204, v255
  v_mul_f32 v205, v205, v255
  v_mul_f32 v206, v206, v255
  v_mul_f32 v207, v207, v255
  v_mul_f32 v208, v208, v255
  v_mul_f32 v209, v209, v255
  v_mfma_f32_32x32x16_bf16 v[88:103], v[28:31], v[156:159], v[88:103]
  v_mul_f32 v210, v210, v255
  v_mul_f32 v211, v211, v255
  v_mul_f32 v212, v212, v255
  v_mul_f32 v213, v213, v255
  v_mul_f32 v214, v214, v255
  v_mul_f32 v215, v215, v255
  v_cvt_pk_bf16_f32 v160, v200, v201
  v_cvt_pk_bf16_f32 v161, v202, v203
  v_cvt_pk_bf16_f32 v162, v204, v205
  v_cvt_pk_bf16_f32 v163, v206, v207
  v_cvt_pk_bf16_f32 v164, v208, v209
  v_cvt_pk_bf16_f32 v165, v210, v211
  v_mfma_f32_32x32x16_bf16 v[104:119], a[232:235], v[160:163], v[104:119]
  ds_write_b128 v251, v[232:235] offset:0
  v_cvt_pk_bf16_f32 v166, v212, v213
  v_cvt_pk_bf16_f32 v167, v214, v215
  v_mov_b32 v253, v252
  s_waitcnt vmcnt(27)
  v_mfma_f32_32x32x16_bf16 v[200:215], v[80:83], v[176:179], 0
  v_permlane32_swap_b32 v252, v253
  v_mul_f32 v184, v184, v253
  v_mul_f32 v185, v185, v253
  v_mul_f32 v186, v186, v253
  s_waitcnt vmcnt(26)
  v_mfma_f32_32x32x16_bf16 v[200:215], v[84:87], v[180:183], v[200:215]
  ds_write_b128 v251, v[236:239] offset:1024
  v_mul_f32 v187, v187, v253
  v_mul_f32 v188, v188, v253
  v_mul_f32 v189, v189, v253
  v_mul_f32 v190, v190, v253
  v_mfma_f32_32x32x16_bf16 v[104:119], a[236:239], v[164:167], v[104:119]
  v_mul_f32 v191, v191, v253
  v_cvt_pk_bf16_f32 v168, v184, v185
  v_cvt_pk_bf16_f32 v169, v186, v187
  v_cvt_pk_bf16_f32 v170, v188, v189
  v_cvt_pk_bf16_f32 v171, v190, v191
  v_mul_f32 v192, v192, v253
  v_mul_f32 v193, v193, v253
  v_mfma_f32_32x32x16_bf16 v[104:119], a[240:243], v[168:171], v[104:119]
  ds_write_b128 v251, v[240:243] offset:2048
  v_add_f32 v254, v14, v212
  v_mul_f32 v194, v194, v253
  v_rcp_f32 v254, v254
  v_mul_f32 v195, v195, v253
  v_mul_f32 v196, v196, v253
  v_mul_f32 v197, v197, v253
  v_mul_f32 v198, v198, v253
  v_mfma_f32_32x32x16_bf16 v[88:103], v[32:35], v[160:163], v[88:103]
  v_mul_f32 v199, v199, v253
  v_cvt_pk_bf16_f32 v172, v192, v193
  v_cvt_pk_bf16_f32 v173, v194, v195
  v_cvt_pk_bf16_f32 v174, v196, v197
  v_cvt_pk_bf16_f32 v175, v198, v199
  v_mov_b32 v255, v254
  v_mfma_f32_32x32x16_bf16 v[88:103], v[36:39], v[164:167], v[88:103]
  ds_write_b128 v251, v[244:247] offset:3072
  v_permlane32_swap_b32 v254, v255
  v_mul_f32 v200, v200, v255
  v_mul_f32 v201, v201, v255
  v_mfma_f32_32x32x16_bf16 v[104:119], a[244:247], v[172:175], v[104:119]
  v_mul_f32 v202, v202, v255
  v_mul_f32 v203, v203, v255
  v_mul_f32 v204, v204, v255
  v_mul_f32 v205, v205, v255
  v_mul_f32 v206, v206, v255
  v_mul_f32 v207, v207, v255
  v_cvt_pk_bf16_f32 v176, v200, v201
  v_cvt_pk_bf16_f32 v177, v202, v203
  v_cvt_pk_bf16_f32 v178, v204, v205
  v_cvt_pk_bf16_f32 v179, v206, v207
  v_mfma_f32_32x32x16_bf16 v[88:103], v[40:43], v[168:171], v[88:103]
  v_mul_f32 v208, v208, v255
  v_mul_f32 v209, v209, v255
  v_mul_f32 v210, v210, v255
  v_mul_f32 v211, v211, v255
  v_mul_f32 v212, v212, v255
  v_mul_f32 v213, v213, v255
  v_mfma_f32_32x32x16_bf16 v[104:119], a[248:251], v[176:179], v[104:119]
  v_mul_f32 v214, v214, v255
  v_mul_f32 v215, v215, v255
  v_cvt_pk_bf16_f32 v180, v208, v209
  v_cvt_pk_bf16_f32 v181, v210, v211
  v_cvt_pk_bf16_f32 v182, v212, v213
  v_cvt_pk_bf16_f32 v183, v214, v215
  v_mfma_f32_32x32x16_bf16 v[88:103], v[44:47], v[172:175], v[88:103]
  s_waitcnt lgkmcnt(0)
  s_barrier
  ds_read_b128 v[120:123], v248 offset:4096
  ds_read_b128 v[124:127], v248 offset:5120
  ds_read_b128 v[128:131], v248 offset:6144
  ds_read_b128 v[132:135], v248 offset:7168
  ds_read_b128 v[136:139], v248 offset:8192
  ds_read_b128 v[140:143], v248 offset:9216
  v_mfma_f32_32x32x16_bf16 v[104:119], a[252:255], v[180:183], v[104:119]
  ds_read_b128 v[144:147], v248 offset:10240
  ds_read_b128 v[148:151], v248 offset:11264
  v_mfma_f32_32x32x16_bf16 v[88:103], v[48:51], v[176:179], v[88:103]
  v_mfma_f32_32x32x16_bf16 v[88:103], v[52:55], v[180:183], v[88:103]
  s_nop 7
  s_nop 0
  ds_write_b128 v249, v[104:107] offset:0
  s_waitcnt lgkmcnt(4)
  v_add_f32 v120, v120, v136
  v_add_f32 v121, v121, v137
  ds_write_b128 v249, v[108:111] offset:1024
  v_add_f32 v122, v122, v138
  v_add_f32 v123, v123, v139
  s_waitcnt lgkmcnt(4)
  v_add_f32 v124, v124, v140
  v_add_f32 v125, v125, v141
  v_add_f32 v126, v126, v142
  v_add_f32 v127, v127, v143
  s_waitcnt lgkmcnt(3)
  v_add_f32 v128, v128, v144
  v_add_f32 v129, v129, v145
  ds_write_b128 v249, v[112:115] offset:2048
  v_add_f32 v130, v130, v146
  v_add_f32 v131, v131, v147
  s_waitcnt lgkmcnt(3)
  v_add_f32 v132, v132, v148
  v_add_f32 v133, v133, v149
  v_add_f32 v134, v134, v150
  v_add_f32 v135, v135, v151
  v_pk_add_f32 v[88:89], v[88:89], v[120:121]
  v_pk_add_f32 v[90:91], v[90:91], v[122:123]
  ds_write_b128 v249, v[116:119] offset:3072
  v_pk_add_f32 v[92:93], v[92:93], v[124:125]
  v_pk_add_f32 v[94:95], v[94:95], v[126:127]
  v_pk_add_f32 v[96:97], v[96:97], v[128:129]
  v_pk_add_f32 v[98:99], v[98:99], v[130:131]
  v_pk_add_f32 v[100:101], v[100:101], v[132:133]
  v_pk_add_f32 v[102:103], v[102:103], v[134:135]
  s_waitcnt lgkmcnt(0)
  s_barrier
  ds_read_b128 v[136:139], v248 offset:0
  ds_read_b128 v[140:143], v248 offset:1024
  ds_read_b128 v[144:147], v248 offset:2048
  ds_read_b128 v[148:151], v248 offset:3072
  s_waitcnt lgkmcnt(3)
  v_pk_add_f32 v[88:89], v[88:89], v[136:137]
  v_pk_add_f32 v[90:91], v[90:91], v[138:139]
  s_waitcnt lgkmcnt(2)
  v_pk_add_f32 v[92:93], v[92:93], v[140:141]
  v_pk_add_f32 v[94:95], v[94:95], v[142:143]
  s_waitcnt lgkmcnt(1)
  v_pk_add_f32 v[96:97], v[96:97], v[144:145]
  v_pk_add_f32 v[98:99], v[98:99], v[146:147]
  s_waitcnt lgkmcnt(0)
  v_pk_add_f32 v[100:101], v[100:101], v[148:149]
  v_pk_add_f32 v[102:103], v[102:103], v[150:151]
  v_cvt_pk_bf16_f32 v16, v88, v89
  v_cvt_pk_bf16_f32 v17, v90, v91
  v_cvt_pk_bf16_f32 v18, v92, v93
  v_cvt_pk_bf16_f32 v19, v94, v95
  buffer_store_dwordx4 v[16:19], v1, s[8:11], s33 offen sc1
  v_cvt_pk_bf16_f32 v20, v96, v97
  v_cvt_pk_bf16_f32 v21, v98, v99
  v_cvt_pk_bf16_f32 v22, v100, v101
  v_cvt_pk_bf16_f32 v23, v102, v103
  buffer_store_dwordx4 v[20:23], v1, s[8:11], s33 offen offset:1024 sc1
  v_mov_b32 v10, 0
  v_mov_b32 v11, 0
  v_dot2c_f32_bf16 v10, s22, v16
  v_dot2c_f32_bf16 v10, s22, v17
  v_dot2c_f32_bf16 v10, s22, v18
  v_dot2c_f32_bf16 v10, s22, v19
  v_dot2c_f32_bf16 v10, s22, v20
  v_dot2c_f32_bf16 v10, s22, v21
  v_dot2c_f32_bf16 v10, s22, v22
  v_dot2c_f32_bf16 v10, s22, v23
  v_dot2c_f32_bf16 v11, v16, v16
  v_dot2c_f32_bf16 v11, v17, v17
  v_dot2c_f32_bf16 v11, v18, v18
  v_dot2c_f32_bf16 v11, v19, v19
  v_dot2c_f32_bf16 v11, v20, v20
  v_dot2c_f32_bf16 v11, v21, v21
  v_dot2c_f32_bf16 v11, v22, v22
  v_dot2c_f32_bf16 v11, v23, v23
  s_add_u32 s56, s34, 0
  s_nop 1
  v_permlane32_swap_b32 v10, v11
  v_add_f32 v10, v10, v11
  v_or_b32 v10, 1, v10
  s_waitcnt vmcnt(0)
  s_cbranch_vccz Lpub_15
  buffer_store_dword v10, v1, s[8:11], s56 offen
Lpubr_16:
  s_waitcnt lgkmcnt(0)
  s_barrier
M_up0:
  s_nop 7
  s_nop 5
  s_add_u32 s59, s25, 0
  s_mov_b32 s46, 0
Lpoll_17:
  buffer_load_dwordx4 v[208:211], v1, s[8:11], s59 offen offset:0 sc1
  buffer_load_dwordx4 v[212:215], v1, s[8:11], s59 offen offset:1024 sc1
  buffer_load_dwordx4 v[216:219], v1, s[8:11], s59 offen offset:2048 sc1
  buffer_load_dwordx4 v[220:223], v1, s[8:11], s59 offen offset:3072 sc1
  s_add_u32 s46, s46, 1
  s_waitcnt vmcnt(0)
  v_min3_u32 v6, v208, v209, v210
  v_min3_u32 v7, v211, v212, v213
  v_min3_u32 v8, v214, v215, v216
  v_min3_u32 v9, v217, v218, v219
  v_min3_u32 v6, v6, v220, v221
  v_min3_u32 v7, v7, v8, v9
  v_min_u32 v6, v6, v7
  v_cmp_ne_u32 s[54:55], 0, v6
  s_cmp_gt_u32 s46, 300000
  s_cbranch_scc1 Lpd_18
  s_cmp_eq_u64 s[54:55], exec
  s_cbranch_scc0 Lpoll_17
Lpd_18:
  s_cbranch_vccz Lacq_19
Lacqr_20:
  s_add_u32 s59, s35, 4096
  buffer_load_dwordx4 v[24:27], v1, s[8:11], s24 offen offset:0 sc1
  buffer_load_dwordx4 v[28:31], v1, s[8:11], s24 offen offset:1024 sc1
  buffer_load_dwordx4 v[32:35], v1, s[8:11], s24 offen offset:2048 sc1
  buffer_load_dwordx4 v[36:39], v1, s[8:11], s24 offen offset:3072 sc1
  s_add_u32 s56, s24, 4096
  buffer_load_dwordx4 v[40:43], v1, s[8:11], s56 offen offset:0 sc1
  buffer_load_dwordx4 v[44:47], v1, s[8:11], s56 offen offset:1024 sc1
  buffer_load_dwordx4 v[48:51], v1, s[8:11], s56 offen offset:2048 sc1
  buffer_load_dwordx4 v[52:55], v1, s[8:11], s56 offen offset:3072 sc1
  s_add_u32 s56, s24, 8192
  buffer_load_dwordx4 v[56:59], v1, s[8:11], s56 offen offset:0 sc1
  buffer_load_dwordx4 v[60:63], v1, s[8:11], s56 offen offset:1024 sc1
  buffer_load_dwordx4 v[64:67], v1, s[8:11], s56 offen offset:2048 sc1
  buffer_load_dwordx4 v[68:71], v1, s[8:11], s56 offen offset:3072 sc1
  s_add_u32 s56, s24, 12288
  buffer_load_dwordx4 v[72:75], v1, s[8:11], s56 offen offset:0 sc1
  ds_read_b128 v[224:227], v12 offset:38912
  ds_read_b128 v[228:231], v13 offset:3072
  ds_read_b128 v[232:235], v12 offset:39936
  ds_read_b128 v[236:239], v13 offset:4096
  ds_read_b128 v[240:243], v12 offset:40960
  ds_read_b128 v[244:247], v13 offset:5120
  ds_read_b128 v[200:203], v12 offset:41984
  ds_read_b128 v[204:207], v13 offset:6144
  v_add_f32 v208, v208, v209
  v_add_f32 v215, v215, v216
  v_add_f32 v208, v208, v210
  v_add_f32 v215, v215, v217
  v_add_f32 v208, v208, v211
  v_add_f32 v215, v215, v218
  v_add_f32 v208, v208, v212
  v_add_f32 v215, v215, v219
  v_add_f32 v208, v208, v213
  v_add_f32 v215, v215, v220
  v_add_f32 v208, v208, v214
  v_add_f32 v215, v215, v221
  v_mov_b32 v210, 0
  v_add_f32 v220, v208, v215
  v_mov_b32 v221, v220
  s_nop 1
  v_permlane32_swap_b32 v220, v221
  v_mul_f32 v220, 0xbb124925, v220
  v_mul_f32 v221, 0x3b124925, v221
  v_cvt_pk_bf16_f32 v208, v220, v220
  v_fma_f32 v221, -v220, v220, v221
  v_and_b32 v209, 0xffff0000, v208
  v_max_f32 v221, 0, v221
  v_sub_f32 v209, v220, v209
  v_add_f32 v221, 0x3727c5ac, v221
  v_cvt_pk_bf16_f32 v209, v209, v210
  v_mov_b32 v210, v208
  v_mov_b32 v211, v209
  v_rsq_f32 v222, v221
  s_nop 0
  v_mul_f32 v223, 0xbfb8aa3b, v222
  s_waitcnt vmcnt(12)
  s_waitcnt lgkmcnt(4)
  v_mfma_f32_32x32x16_bf16 v[136:151], v[224:227], v[24:27], 0
  buffer_load_dwordx4 v[76:79], v1, s[8:11], s56 offen offset:1024 sc1
  ds_read_b128 v[224:227], v12 offset:43008
  v_mfma_f32_32x32x16_bf16 v[152:167], v[228:231], v[24:27], 0
  ds_read_b128 v[228:231], v13 offset:7168
  s_waitcnt vmcnt(12)
  v_mfma_f32_32x32x16_bf16 v[136:151], v[232:235], v[28:31], v[136:151]
  buffer_load_dwordx4 v[80:83], v1, s[8:11], s56 offen offset:2048 sc1
  ds_read_b128 v[232:235], v12 offset:44032
  v_mfma_f32_32x32x16_bf16 v[152:167], v[236:239], v[28:31], v[152:167]
  ds_read_b128 v[236:239], v13 offset:8192
  s_waitcnt vmcnt(12)
  s_waitcnt lgkmcnt(4)
  v_mfma_f32_32x32x16_bf16 v[136:151], v[240:243], v[32:35], v[136:151]
  buffer_load_dwordx4 v[84:87], v1, s[8:11], s56 offen offset:3072 sc1
  ds_read_b128 v[240:243], v12 offset:45056
  v_mfma_f32_32x32x16_bf16 v[152:167], v[244:247], v[32:35], v[152:167]
  ds_read_b128 v[244:247], v13 offset:9216
  s_waitcnt vmcnt(12)
  v_mfma_f32_32x32x16_bf16 v[136:151], v[200:203], v[36:39], v[136:151]
  s_add_u32 s56, s24, 16384
  buffer_load_dwordx4 v[88:91], v1, s[8:11], s56 offen offset:0 sc1
  ds_read_b128 v[200:203], v12 offset:46080
  v_mfma_f32_32x32x16_bf16 v[152:167], v[204:207], v[36:39], v[152:167]
  ds_read_b128 v[204:207], v13 offset:10240
  s_waitcnt vmcnt(12)
  s_waitcnt lgkmcnt(4)
  v_mfma_f32_32x32x16_bf16 v[136:151], v[224:227], v[40:43], v[136:151]
  buffer_load_dwordx4 v[92:95], v1, s[8:11], s56 offen offset:1024 sc1
  ds_read_b128 v[224:227], v12 offset:47104
  v_mfma_f32_32x32x16_bf16 v[152:167], v[228:231], v[40:43], v[152:167]
  ds_read_b128 v[228:231], v13 offset:11264
  s_waitcnt vmcnt(12)
  v_mfma_f32_32x32x16_bf16 v[136:151], v[232:235], v[44:47], v[136:151]
  buffer_load_dwordx4 v[96:99], v1, s[8:11], s56 offen offset:2048 sc1
  ds_read_b128 v[232:235], v12 offset:48128
  v_mfma_f32_32x32x16_bf16 v[152:167], v[236:239], v[44:47], v[152:167]
  ds_read_b128 v[236:239], v13 offset:12288
  s_waitcnt vmcnt(12)
  s_waitcnt lgkmcnt(4)
  v_mfma_f32_32x32x16_bf16 v[136:151], v[240:243], v[48:51], v[136:151]
  buffer_load_dwordx4 v[100:103], v1, s[8:11], s56 offen offset:3072 sc1
  ds_read_b128 v[240:243], v12 offset:49152
  v_mfma_f32_32x32x16_bf16 v[152:167], v[244:247], v[48:51], v[152:167]
  ds_read_b128 v[244:247], v13 offset:13312
  s_waitcnt vmcnt(12)
  v_mfma_f32_32x32x16_bf16 v[136:151], v[200:203], v[52:55], v[136:151]
  s_add_u32 s56, s24, 20480
  buffer_load_dwordx4 v[104:107], v1, s[8:11], s56 offen offset:0 sc1
  ds_read_b128 v[200:203], v12 offset:50176
  v_mfma_f32_32x32x16_bf16 v[152:167], v[204:207], v[52:55], v[152:167]
  ds_read_b128 v[204:207], v13 offset:14336
  s_waitcnt vmcnt(12)
  s_waitcnt lgkmcnt(4)
  v_mfma_f32_32x32x16_bf16 v[136:151], v[224:227], v[56:59], v[136:151]
  buffer_load_dwordx4 v[108:111], v1, s[8:11], s56 offen offset:1024 sc1
  ds_read_b128 v[224:227], v12 offset:51200
  v_mfma_f32_32x32x16_bf16 v[152:167], v[228:231], v[56:59], v[152:167]
  ds_read_b128 v[228:231], v13 offset:15360
  s_waitcnt vmcnt(12)
  v_mfma_f32_32x32x16_bf16 v[136:151], v[232:235], v[60:63], v[136:151]
  buffer_load_dwordx4 v[112:115], v1, s[8:11], s56 offen offset:2048 sc1
  ds_read_b128 v[232:235], v12 offset:52224
  v_mfma_f32_32x32x16_bf16 v[152:167], v[236:239], v[60:63], v[152:167]
  ds_read_b128 v[236:239], v13 offset:16384
  s_waitcnt vmcnt(12)
  s_waitcnt lgkmcnt(4)
  v_mfma_f32_32x32x16_bf16 v[136:151], v[240:243], v[64:67], v[136:151]
  buffer_load_dwordx4 v[116:119], v1, s[8:11], s56 offen offset:3072 sc1
  ds_read_b128 v[240:243], v12 offset:53248
  v_mfma_f32_32x32x16_bf16 v[152:167], v[244:247], v[64:67], v[152:167]
  ds_read_b128 v[244:247], v13 offset:17408
  s_waitcnt vmcnt(12)
  v_mfma_f32_32x32x16_bf16 v[136:151], v[200:203], v[68:71], v[136:151]
  s_add_u32 s56, s24, 24576
  buffer_load_dwordx4 v[120:123], v1, s[8:11], s56 offen offset:0 sc1
  ds_read_b128 v[200:203], v12 offset:54272
  v_mfma_f32_32x32x16_bf16 v[152:167], v[204:207], v[68:71], v[152:167]
  ds_read_b128 v[204:207], v13 offset:18432
  s_waitcnt vmcnt(12)
  s_waitcnt lgkmcnt(4)
  v_mfma_f32_32x32x16_bf16 v[136:151], v[224:227], v[72:75], v[136:151]
  buffer_load_dwordx4 v[124:127], v1, s[8:11], s56 offen offset:1024 sc1
  ds_read_b128 v[224:227], v12 offset:55296
  v_mfma_f32_32x32x16_bf16 v[152:167], v[228:231], v[72:75], v[152:167]
  ds_read_b128 v[228:231], v13 offset:19456
  s_waitcnt vmcnt(12)
  v_mfma_f32_32x32x16_bf16 v[136:151], v[232:235], v[76:79], v[136:151]
  buffer_load_dwordx4 v[128:131], v1, s[8:11], s56 offen offset:2048 sc1
  ds_read_b128 v[232:235], v12 offset:56320
  v_mfma_f32_32x32x16_bf16 v[152:167], v[236:239], v[76:79], v[152:167]
  ds_read_b128 v[236:239], v13 offset:20480
  s_waitcnt vmcnt(12)
  s_waitcnt lgkmcnt(4)
  v_mfma_f32_32x32x16_bf16 v[136:151], v[240:243], v[80:83], v[136:151]
  buffer_load_dwordx4 v[132:135], v1, s[8:11], s56 offen offset:3072 sc1
  ds_read_b128 v[240:243], v12 offset:57344
  v_mfma_f32_32x32x16_bf16 v[152:167], v[244:247], v[80:83], v[152:167]
  ds_read_b128 v[244:247], v13 offset:21504
  s_waitcnt vmcnt(12)
  v_mfma_f32_32x32x16_bf16 v[136:151], v[200:203], v[84:87], v[136:151]
  ds_read_b128 v[200:203], v12 offset:58368
  v_mfma_f32_32x32x16_bf16 v[152:167], v[204:207], v[84:87], v[152:167]
  ds_read_b128 v[204:207], v13 offset:22528
  s_waitcnt vmcnt(11)
  s_waitcnt lgkmcnt(4)
  v_mfma_f32_32x32x16_bf16 v[136:151], v[224:227], v[88:91], v[136:151]
  ds_read_b128 v[224:227], v12 offset:59392
  v_mfma_f32_32x32x16_bf16 v[152:167], v[228:231], v[88:91], v[152:167]
  ds_read_b128 v[228:231], v13 offset:23552
  s_waitcnt vmcnt(10)
  v_mfma_f32_32x32x16_bf16 v[136:151], v[232:235], v[92:95], v[136:151]
  ds_read_b128 v[232:235], v12 offset:60416
  v_mfma_f32_32x32x16_bf16 v[152:167], v[236:239], v[92:95], v[152:167]
  ds_read_b128 v[236:239], v13 offset:24576
  s_waitcnt vmcnt(9)
  s_waitcnt lgkmcnt(4)
  v_mfma_f32_32x32x16_bf16 v[136:151], v[240:243], v[96:99], v[136:151]
  ds_read_b128 v[240:243], v12 offset:61440
  v_mfma_f32_32x32x16_bf16 v[152:167], v[244:247], v[96:99], v[152:167]
  ds_read_b128 v[244:247], v13 offset:25600
  s_add_u32 m0, s19, 24576
  s_add_u32 s57, s41, s19
  s_add_u32 s57, s57, 113664
  buffer_load_dwordx4 v1, s[8:11], s57 offen offset:0 sc1 lds
  s_waitcnt vmcnt(9)
  v_mfma_f32_32x32x16_bf16 v[136:151], v[200:203], v[100:103], v[136:151]
  ds_read_b128 v[200:203], v12 offset:62464
  v_mfma_f32_32x32x16_bf16 v[152:167], v[204:207], v[100:103], v[152:167]
  ds_read_b128 v[204:207], v13 offset:26624
  buffer_load_dwordx4 v1, s[8:11], s57 offen offset:1024 sc1 lds
  s_waitcnt vmcnt(9)
  s_waitcnt lgkmcnt(4)
  v_mfma_f32_32x32x16_bf16 v[136:151], v[224:227], v[104:107], v[136:151]
  ds_read_b128 v[224:227], v12 offset:63488
  v_mfma_f32_32x32x16_bf16 v[152:167], v[228:231], v[104:107], v[152:167]
  ds_read_b128 v[228:231], v13 offset:27648
  s_waitcnt vmcnt(8)
  v_mfma_f32_32x32x16_bf16 v[136:151], v[232:235], v[108:111], v[136:151]
  ds_read_b128 v[232:235], v12 offset:64512
  s_add_u32 m0, s20, 29696
  s_add_u32 s57, s4, 118784
  buffer_load_dwordx4 v1, s[8:11], s57 offen offset:0 sc1 lds
  v_mfma_f32_32x32x16_bf16 v[152:167], v[236:239], v[108:111], v[152:167]
  ds_read_b128 v[236:239], v13 offset:28672
  s_waitcnt vmcnt(8)
  s_waitcnt lgkmcnt(4)
  v_mfma_f32_32x32x16_bf16 v[136:151], v[240:243], v[112:115], v[136:151]
  ds_read_b128 v[240:243], v13 offset:0
  v_mfma_f32_32x32x16_bf16 v[152:167], v[244:247], v[112:115], v[152:167]
  ds_read_b128 v[244:247], v13 offset:29696
  buffer_load_dwordx4 v1, s[8:11], s57 offen offset:1024 sc1 lds
  s_waitcnt vmcnt(8)
  v_mfma_f32_32x32x16_bf16 v[136:151], v[200:203], v[116:119], v[136:151]
  ds_read_b128 v[200:203], v13 offset:1024
  v_mfma_f32_32x32x16_bf16 v[152:167], v[204:207], v[116:119], v[152:167]
  ds_read_b128 v[204:207], v13 offset:30720
  s_waitcnt vmcnt(7)
  s_waitcnt lgkmcnt(4)
  v_mfma_f32_32x32x16_bf16 v[136:151], v[224:227], v[120:123], v[136:151]
  ds_read_b128 v[224:227], v13 offset:2048
  buffer_load_dwordx4 v1, s[8:11], s57 offen offset:2048 sc1 lds
  v_mfma_f32_32x32x16_bf16 v[152:167], v[228:231], v[120:123], v[152:167]
  ds_read_b128 v[228:231], v13 offset:31744
  s_waitcnt vmcnt(7)
  v_mfma_f32_32x32x16_bf16 v[136:151], v[232:235], v[124:127], v[136:151]
  ds_read_b128 v[232:235], v12 offset:9216
  v_mfma_f32_32x32x16_bf16 v[152:167], v[236:239], v[124:127], v[152:167]
  ds_read_b128 v[236:239], v12 offset:10240
  buffer_load_dwordx4 v1, s[8:11], s57 offen offset:3072 sc1 lds
  s_waitcnt vmcnt(7)
  s_waitcnt lgkmcnt(4)
  v_mfma_f32_32x32x16_bf16 v[136:151], v[240:243], v[128:131], v[136:151]
  ds_read_b128 v[240:243], v12 offset:11264
  v_mfma_f32_32x32x16_bf16 v[152:167], v[244:247], v[128:131], v[152:167]
  ds_read_b128 v[244:247], v12 offset:12288
  s_waitcnt vmcnt(6)
  v_mfma_f32_32x32x16_bf16 v[136:151], v[200:203], v[132:135], v[136:151]
  ds_read_b128 v[200:203], v12 offset:13312
  s_add_u32 m0, s20, 33792
  s_add_u32 s57, s4, 122880
  buffer_load_dwordx4 v1, s[8:11], s57 offen offset:0 sc1 lds
  v_mfma_f32_32x32x16_bf16 v[152:167], v[204:207], v[132:135], v[152:167]
  ds_read_b128 v[204:207], v12 offset:14336
  s_waitcnt lgkmcnt(4)
  v_mfma_f32_32x32x16_bf16 v[136:151], v[224:227], v[208:211], v[136:151]
  ds_read_b128 v[224:227], v12 offset:15360
  v_mfma_f32_32x32x16_bf16 v[152:167], v[228:231], v[208:211], v[152:167]
  ds_read_b128 v[228:231], v12 offset:16384
  buffer_load_dwordx4 v1, s[8:11], s57 offen offset:1024 sc1 lds
  v_mfma_f32_32x32x16_bf16 v[168:183], v[232:235], v[24:27], 0
  ds_read_b128 v[232:235], v12 offset:17408
  v_mfma_f32_32x32x16_bf16 v[168:183], v[236:239], v[28:31], v[168:183]
  ds_read_b128 v[236:239], v12 offset:18432
  s_waitcnt lgkmcnt(4)
  v_mfma_f32_32x32x16_bf16 v[168:183], v[240:243], v[32:35], v[168:183]
  ds_read_b128 v[240:243], v12 offset:19456
  buffer_load_dwordx4 v1, s[8:11], s57 offen offset:2048 sc1 lds
  s_nop 0
  v_mul_f32 v212, v136, v223
  v_mul_f32 v214, v137, v223
  v_mfma_f32_32x32x16_bf16 v[168:183], v[244:247], v[36:39], v[168:183]
  ds_read_b128 v[244:247], v12 offset:20480
  v_mul_f32 v216, v138, v223
  v_mul_f32 v218, v139, v223
  v_exp_f32 v212, v212
  v_mul_f32 v213, v136, v144
  v_mfma_f32_32x32x16_bf16 v[168:183], v[200:203], v[40:43], v[168:183]
  ds_read_b128 v[200:203], v12 offset:21504
  v_exp_f32 v214, v214
  v_exp_f32 v216, v216
  v_fma_f32 v212, v212, v221, v221
  v_mfma_f32_32x32x16_bf16 v[168:183], v[204:207], v[44:47], v[168:183]
  ds_read_b128 v[204:207], v12 offset:22528
  buffer_load_dwordx4 v1, s[8:11], s57 offen offset:3072 sc1 lds
  v_exp_f32 v218, v218
  s_waitcnt lgkmcnt(4)
  v_mfma_f32_32x32x16_bf16 v[168:183], v[224:227], v[48:51], v[168:183]
  ds_read_b128 v[224:227], v12 offset:23552
  v_fma_f32 v214, v214, v221, v221
  v_fma_f32 v216, v216, v221, v221
  v_fma_f32 v218, v218, v221, v221
  v_rcp_f32 v212, v212
  v_mfma_f32_32x32x16_bf16 v[168:183], v[228:231], v[52:55], v[168:183]
  ds_read_b128 v[228:231], v12 offset:24576
  s_waitcnt vmcnt(8)
  s_barrier
  v_rcp_f32 v214, v214
  v_rcp_f32 v216, v216
  v_mfma_f32_32x32x16_bf16 v[168:183], v[232:235], v[56:59], v[168:183]
  ds_read_b128 v[232:235], v12 offset:25600
  v_rcp_f32 v218, v218
  v_mul_f32 v215, v137, v145
  v_mul_f32 v217, v138, v146
  v_mul_f32 v219, v139, v147
  v_mfma_f32_32x32x16_bf16 v[168:183], v[236:239], v[60:63], v[168:183]
  ds_read_b128 v[236:239], v12 offset:26624
  s_add_u32 m0, s20, 104448
  s_add_u32 s57, s4, 148480
  buffer_load_dwordx4 v1, s[8:11], s57 offen offset:0 sc1 lds
  s_waitcnt lgkmcnt(4)
  v_mfma_f32_32x32x16_bf16 v[168:183], v[240:243], v[64:67], v[168:183]
  ds_read_b128 v[240:243], v12 offset:27648
  v_mul_f32 v136, v213, v212
  v_mul_f32 v137, v215, v214
  v_mul_f32 v138, v217, v216
  v_mul_f32 v139, v219, v218
  v_mul_f32 v212, v140, v223
  v_mfma_f32_32x32x16_bf16 v[168:183], v[244:247], v[68:71], v[168:183]
  ds_read_b128 v[244:247], v12 offset:28672
  v_mul_f32 v214, v141, v223
  v_mul_f32 v216, v142, v223
  v_mul_f32 v218, v143, v223
  v_exp_f32 v212, v212
  v_mfma_f32_32x32x16_bf16 v[168:183], v[200:203], v[72:75], v[168:183]
  ds_read_b128 v[200:203], v12 offset:29696
  v_exp_f32 v214, v214
  v_exp_f32 v216, v216
  v_fma_f32 v212, v212, v221, v221
  v_mfma_f32_32x32x16_bf16 v[168:183], v[204:207], v[76:79], v[168:183]
  ds_read_b128 v[204:207], v12 offset:30720
  buffer_load_dwordx4 v1, s[8:11], s57 offen offset:1024 sc1 lds
  v_exp_f32 v218, v218
  s_waitcnt lgkmcnt(4)
  v_mfma_f32_32x32x16_bf16 v[168:183], v[224:227], v[80:83], v[168:183]
  ds_read_b128 v[224:227], v12 offset:31744
  v_fma_f32 v214, v214, v221, v221
  v_fma_f32 v216, v216, v221, v221
  v_fma_f32 v218, v218, v221, v221
  v_rcp_f32 v212, v212
  v_mfma_f32_32x32x16_bf16 v[168:183], v[228:231], v[84:87], v[168:183]
  ds_read_b128 v[228:231], v12 offset:32768
  v_rcp_f32 v214, v214
  v_rcp_f32 v216, v216
  v_mul_f32 v213, v140, v148
  v_mfma_f32_32x32x16_bf16 v[168:183], v[232:235], v[88:91], v[168:183]
  ds_read_b128 v[232:235], v12 offset:33792
  v_rcp_f32 v218, v218
  v_mul_f32 v215, v141, v149
  v_mul_f32 v217, v142, v150
  v_mul_f32 v219, v143, v151
  v_mfma_f32_32x32x16_bf16 v[168:183], v[236:239], v[92:95], v[168:183]
  ds_read_b128 v[236:239], v12 offset:34816
  buffer_load_dwordx4 v1, s[8:11], s57 offen offset:2048 sc1 lds
  v_mul_f32 v140, v213, v212
  v_mul_f32 v141, v215, v214
  s_waitcnt lgkmcnt(4)
  v_mfma_f32_32x32x16_bf16 v[168:183], v[240:243], v[96:99], v[168:183]
  ds_read_b128 v[240:243], v12 offset:35840
  v_mul_f32 v142, v217, v216
  v_mul_f32 v143, v219, v218
  v_cvt_pk_bf16_f32 v248, v136, v137
  v_cvt_pk_bf16_f32 v249, v138, v139
  v_cvt_pk_bf16_f32 v250, v140, v141
  v_mfma_f32_32x32x16_bf16 v[168:183], v[244:247], v[100:103], v[168:183]
  ds_read_b128 v[244:247], v12 offset:36864
  v_cvt_pk_bf16_f32 v251, v142, v143
  v_mul_f32 v212, v152, v223
  v_mul_f32 v214, v153, v223
  v_mul_f32 v216, v154, v223
  v_mul_f32 v218, v155, v223
  v_mfma_f32_32x32x16_bf16 v[168:183], v[200:203], v[104:107], v[168:183]
  ds_read_b128 v[200:203], v12 offset:37888
  buffer_store_dwordx4 v[248:251], v1, s[8:11], s35 offen offset:0 sc1
  v_exp_f32 v212, v212
  v_mfma_f32_32x32x16_bf16 v[168:183], v[204:207], v[108:111], v[168:183]
  ds_read_b128 v[204:207], v1 offset:0
  buffer_load_dwordx4 v1, s[8:11], s57 offen offset:3072 sc1 lds
  v_exp_f32 v214, v214
  s_waitcnt lgkmcnt(4)
  v_mfma_f32_32x32x16_bf16 v[168:183], v[224:227], v[112:115], v[168:183]
  ds_read_b128 v[224:227], v1 offset:1024
  s_add_u32 s3, s43, 12288
  buffer_load_dwordx4 a[168:171], v1, s[8:11], s3 offen offset:2048 sc1
  v_fma_f32 v212, v212, v221, v221
  v_mfma_f32_32x32x16_bf16 v[168:183], v[228:231], v[116:119], v[168:183]
  ds_read_b128 v[228:231], v1 offset:2048
  v_exp_f32 v216, v216
  v_exp_f32 v218, v218
  v_fma_f32 v214, v214, v221, v221
  v_mfma_f32_32x32x16_bf16 v[168:183], v[232:235], v[120:123], v[168:183]
  ds_read_b128 v[232:235], v1 offset:3072
  v_fma_f32 v216, v216, v221, v221
  v_fma_f32 v218, v218, v221, v221
  v_rcp_f32 v212, v212
  v_mul_f32 v213, v152, v160
  v_mfma_f32_32x32x16_bf16 v[168:183], v[236:239], v[124:127], v[168:183]
  ds_read_b128 v[236:239], v1 offset:4096
  s_add_u32 m0, s20, 108544
  s_add_u32 s57, s4, 152576
  buffer_load_dwordx4 v1, s[8:11], s57 offen offset:0 sc1 lds
  s_waitcnt lgkmcnt(4)
  v_mfma_f32_32x32x16_bf16 v[168:183], v[240:243], v[128:131], v[168:183]
  ds_read_b128 v[240:243], v1 offset:5120
  s_add_u32 s3, s43, 12288
  buffer_load_dwordx4 a[172:175], v1, s[8:11], s3 offen offset:3072 sc1
  v_mul_f32 v215, v153, v161
  v_mfma_f32_32x32x16_bf16 v[168:183], v[244:247], v[132:135], v[168:183]
  ds_read_b128 v[244:247], v1 offset:6144
  v_rcp_f32 v214, v214
  v_rcp_f32 v216, v216
  v_mul_f32 v217, v154, v162
  v_mfma_f32_32x32x16_bf16 v[168:183], v[200:203], v[208:211], v[168:183]
  ds_read_b128 v[200:203], v1 offset:7168
  s_add_u32 s3, s43, 16384
  buffer_load_dwordx4 a[176:179], v1, s[8:11], s3 offen offset:0 sc1
  v_mul_f32 v219, v155, v163
  v_mfma_f32_32x32x16_bf16 v[184:199], v[204:207], v[24:27], 0
  ds_read_b128 v[204:207], v1 offset:8192
  buffer_load_dwordx4 v1, s[8:11], s57 offen offset:1024 sc1 lds
  v_rcp_f32 v218, v218
  s_waitcnt lgkmcnt(4)
  v_mfma_f32_32x32x16_bf16 v[184:199], v[224:227], v[28:31], v[184:199]
  ds_read_b128 v[224:227], v1 offset:9216
  v_mul_f32 v152, v213, v212
  v_mul_f32 v153, v215, v214
  v_mul_f32 v154, v217, v216
  v_mul_f32 v155, v219, v218
  v_mul_f32 v212, v156, v223
  v_mfma_f32_32x32x16_bf16 v[184:199], v[228:231], v[32:35], v[184:199]
  ds_read_b128 v[228:231], v1 offset:10240
  s_and_b32 s6, s17, 3
  s_lshl_b32 s6, s6, 2
  s_add_u32 s6, s6, s16
  s_lshl_b32 s6, s6, 10
  s_add_u32 s6, s6, M_down0-M_start
  s_min_u32 s6, s6, M_last-M_start-1024
  buffer_load_dword v7, v1, s[96:99], s6 offen
  v_mfma_f32_32x32x16_bf16 v[184:199], v[232:235], v[36:39], v[184:199]
  ds_read_b128 v[232:235], v1 offset:11264
  s_add_u32 s3, s43, 16384
  buffer_load_dwordx4 a[180:183], v1, s[8:11], s3 offen offset:1024 sc1
  v_mul_f32 v214, v157, v223
  v_mfma_f32_32x32x16_bf16 v[184:199], v[236:239], v[40:43], v[184:199]
  ds_read_b128 v[236:239], v1 offset:12288
  buffer_load_dwordx4 v1, s[8:11], s57 offen offset:2048 sc1 lds
  v_mul_f32 v216, v158, v223
  v_mul_f32 v218, v159, v223
  s_waitcnt lgkmcnt(4)
  v_mfma_f32_32x32x16_bf16 v[184:199], v[240:243], v[44:47], v[184:199]
  ds_read_b128 v[240:243], v1 offset:13312
  s_add_u32 s3, s43, 16384
  buffer_load_dwordx4 a[184:187], v1, s[8:11], s3 offen offset:2048 sc1
  v_mul_f32 v213, v156, v164
  v_mfma_f32_32x32x16_bf16 v[184:199], v[244:247], v[48:51], v[184:199]
  ds_read_b128 v[244:247], v1 offset:14336
  v_exp_f32 v212, v212
  v_exp_f32 v214, v214
  v_fma_f32 v212, v212, v221, v221
  v_mfma_f32_32x32x16_bf16 v[184:199], v[200:203], v[52:55], v[184:199]
  ds_read_b128 v[200:203], v1 offset:15360
  v_exp_f32 v216, v216
  v_exp_f32 v218, v218
  v_fma_f32 v214, v214, v221, v221
  v_mfma_f32_32x32x16_bf16 v[184:199], v[204:207], v[56:59], v[184:199]
  ds_read_b128 v[204:207], v1 offset:16384
  buffer_load_dwordx4 v1, s[8:11], s57 offen offset:3072 sc1 lds
  s_add_u32 s3, s43, 16384
  buffer_load_dwordx4 a[188:191], v1, s[8:11], s3 offen offset:3072 sc1
  s_waitcnt lgkmcnt(4)
  v_mfma_f32_32x32x16_bf16 v[184:199], v[224:227], v[60:63], v[184:199]
  ds_read_b128 v[224:227], v1 offset:17408
  v_fma_f32 v216, v216, v221, v221
  v_fma_f32 v218, v218, v221, v221
  v_rcp_f32 v212, v212
  v_mul_f32 v215, v157, v165
  v_mfma_f32_32x32x16_bf16 v[184:199], v[228:231], v[64:67], v[184:199]
  ds_read_b128 v[228:231], v1 offset:18432
  v_rcp_f32 v214, v214
  v_rcp_f32 v216, v216
  v_mul_f32 v217, v158, v166
  v_mfma_f32_32x32x16_bf16 v[184:199], v[232:235], v[68:71], v[184:199]
  ds_read_b128 v[232:235], v1 offset:19456
  s_add_u32 s3, s43, 20480
  buffer_load_dwordx4 a[192:195], v1, s[8:11], s3 offen offset:0 sc1
  v_mul_f32 v219, v159, v167
  v_mfma_f32_32x32x16_bf16 v[184:199], v[236:239], v[72:75], v[184:199]
  ds_read_b128 v[236:239], v1 offset:20480
  v_rcp_f32 v218, v218
  v_mul_f32 v156, v213, v212
  v_mul_f32 v157, v215, v214
  v_mul_f32 v158, v217, v216
  s_waitcnt lgkmcnt(4)
  v_mfma_f32_32x32x16_bf16 v[184:199], v[240:243], v[76:79], v[184:199]
  ds_read_b128 v[240:243], v1 offset:21504
  v_mul_f32 v159, v219, v218
  v_cvt_pk_bf16_f32 v252, v152, v153
  v_cvt_pk_bf16_f32 v253, v154, v155
  v_cvt_pk_bf16_f32 v254, v156, v157
  v_cvt_pk_bf16_f32 v255, v158, v159
  v_mfma_f32_32x32x16_bf16 v[184:199], v[244:247], v[80:83], v[184:199]
  ds_read_b128 v[244:247], v1 offset:22528
  buffer_store_dwordx4 v[252:255], v1, s[8:11], s35 offen offset:1024 sc1
  s_waitcnt vmcnt(18)
  s_barrier
  v_mul_f32 v212, v168, v223
  v_mfma_f32_32x32x16_bf16 v[184:199], v[200:203], v[84:87], v[184:199]
  ds_read_b128 v[200:203], v1 offset:23552
  s_add_u32 s3, s43, 20480
  buffer_load_dwordx4 a[196:199], v1, s[8:11], s3 offen offset:1024 sc1
  v_mul_f32 v214, v169, v223
  v_mfma_f32_32x32x16_bf16 v[184:199], v[204:207], v[88:91], v[184:199]
  ds_read_b128 v[204:207], v1 offset:24576
  s_add_u32 m0, s20, 134144
  s_add_u32 s57, s4, 178176
  buffer_load_dwordx4 v1, s[8:11], s57 offen offset:0 sc1 lds
  s_waitcnt lgkmcnt(4)
  v_mfma_f32_32x32x16_bf16 v[184:199], v[224:227], v[92:95], v[184:199]
  ds_read_b128 v[224:227], v1 offset:25600
  s_add_u32 s3, s43, 20480
  buffer_load_dwordx4 a[200:203], v1, s[8:11], s3 offen offset:2048 sc1
  v_mul_f32 v216, v170, v223
  v_mfma_f32_32x32x16_bf16 v[184:199], v[228:231], v[96:99], v[184:199]
  ds_read_b128 v[228:231], v1 offset:26624
  v_mul_f32 v218, v171, v223
  v_exp_f32 v212, v212
  v_exp_f32 v214, v214
  v_mfma_f32_32x32x16_bf16 v[184:199], v[232:235], v[100:103], v[184:199]
  ds_read_b128 v[232:235], v1 offset:27648
  buffer_load_dwordx4 v1, s[8:11], s57 offen offset:1024 sc1 lds
  v_exp_f32 v216, v216
  v_mfma_f32_32x32x16_bf16 v[184:199], v[236:239], v[104:107], v[184:199]
  ds_read_b128 v[236:239], v1 offset:28672
  s_add_u32 s3, s43, 20480
  buffer_load_dwordx4 a[204:207], v1, s[8:11], s3 offen offset:3072 sc1
  v_fma_f32 v212, v212, v221, v221
  s_waitcnt lgkmcnt(4)
  v_mfma_f32_32x32x16_bf16 v[184:199], v[240:243], v[108:111], v[184:199]
  ds_read_b128 v[240:243], v1 offset:29696
  v_exp_f32 v218, v218
  v_fma_f32 v214, v214, v221, v221
  v_fma_f32 v216, v216, v221, v221
  v_fma_f32 v218, v218, v221, v221
  v_mfma_f32_32x32x16_bf16 v[184:199], v[244:247], v[112:115], v[184:199]
  ds_read_b128 v[244:247], v1 offset:30720
  v_rcp_f32 v212, v212
  v_rcp_f32 v214, v214
  v_mul_f32 v213, v168, v176
  v_mfma_f32_32x32x16_bf16 v[184:199], v[200:203], v[116:119], v[184:199]
  ds_read_b128 v[200:203], v1 offset:31744
  buffer_load_dwordx4 v1, s[8:11], s57 offen offset:2048 sc1 lds
  s_add_u32 s3, s43, 24576
  buffer_load_dwordx4 a[208:211], v1, s[8:11], s3 offen offset:0 sc1
  v_mfma_f32_32x32x16_bf16 v[184:199], v[204:207], v[120:123], v[184:199]
  ds_read_b128 v[204:207], v1 offset:32768
  v_rcp_f32 v216, v216
  v_rcp_f32 v218, v218
  v_mul_f32 v215, v169, v177
  s_waitcnt lgkmcnt(4)
  v_mfma_f32_32x32x16_bf16 v[184:199], v[224:227], v[124:127], v[184:199]
  ds_read_b128 v[224:227], v1 offset:33792
  v_mul_f32 v217, v170, v178
  v_mul_f32 v219, v171, v179
  v_mul_f32 v168, v213, v212
  v_mul_f32 v169, v215, v214
  v_mul_f32 v170, v217, v216
  v_mfma_f32_32x32x16_bf16 v[184:199], v[228:231], v[128:131], v[184:199]
  ds_read_b128 v[228:231], v1 offset:34816
  s_add_u32 s3, s43, 24576
  buffer_load_dwordx4 a[212:215], v1, s[8:11], s3 offen offset:1024 sc1
  v_mul_f32 v171, v219, v218
  v_mfma_f32_32x32x16_bf16 v[184:199], v[232:235], v[132:135], v[184:199]
  ds_read_b128 v[232:235], v1 offset:35840
  buffer_load_dwordx4 v1, s[8:11], s57 offen offset:3072 sc1 lds
  v_mul_f32 v212, v172, v223
  v_mul_f32 v214, v173, v223
  v_mfma_f32_32x32x16_bf16 v[184:199], v[236:239], v[208:211], v[184:199]
  ds_read_b128 v[236:239], v1 offset:36864
  v_mul_f32 v216, v174, v223
  v_mul_f32 v218, v175, v223
  v_exp_f32 v212, v212
  v_mul_f32 v213, v172, v180
  s_waitcnt lgkmcnt(4)
  v_mfma_f32_32x32x16_bf16 v[136:151], v[240:243], v[24:27], 0
  ds_read_b128 v[240:243], v1 offset:37888
  s_add_u32 s3, s43, 24576
  buffer_load_dwordx4 a[216:219], v1, s[8:11], s3 offen offset:2048 sc1
  v_fma_f32 v212, v212, v221, v221
  v_mfma_f32_32x32x16_bf16 v[136:151], v[244:247], v[28:31], v[136:151]
  ds_read_b128 v[244:247], v1 offset:38912
  v_exp_f32 v214, v214
  v_exp_f32 v216, v216
  v_fma_f32 v214, v214, v221, v221
  v_mfma_f32_32x32x16_bf16 v[136:151], v[200:203], v[32:35], v[136:151]
  ds_read_b128 v[200:203], v1 offset:39936
  s_add_u32 m0, s20, 138240
  s_add_u32 s57, s4, 182272
  buffer_load_dwordx4 v1, s[8:11], s57 offen offset:0 sc1 lds
  v_mfma_f32_32x32x16_bf16 v[136:151], v[204:207], v[36:39], v[136:151]
  ds_read_b128 v[204:207], v1 offset:40960
  s_add_u32 s3, s43, 24576
  buffer_load_dwordx4 a[220:223], v1, s[8:11], s3 offen offset:3072 sc1
  v_fma_f32 v216, v216, v221, v221
  s_waitcnt lgkmcnt(4)
  v_mfma_f32_32x32x16_bf16 v[136:151], v[224:227], v[40:43], v[136:151]
  ds_read_b128 v[224:227], v1 offset:41984
  v_exp_f32 v218, v218
  v_rcp_f32 v212, v212
  v_fma_f32 v218, v218, v221, v221
  v_mfma_f32_32x32x16_bf16 v[136:151], v[228:231], v[44:47], v[136:151]
  ds_read_b128 v[228:231], v1 offset:43008
  v_rcp_f32 v214, v214
  v_rcp_f32 v216, v216
  v_mul_f32 v215, v173, v181
  v_mfma_f32_32x32x16_bf16 v[136:151], v[232:235], v[48:51], v[136:151]
  ds_read_b128 v[232:235], v1 offset:44032
  buffer_load_dwordx4 v1, s[8:11], s57 offen offset:1024 sc1 lds
  v_rcp_f32 v218, v218
  v_mfma_f32_32x32x16_bf16 v[136:151], v[236:239], v[52:55], v[136:151]
  ds_read_b128 v[236:239], v1 offset:45056
  v_mul_f32 v217, v174, v182
  v_mul_f32 v219, v175, v183
  v_mul_f32 v172, v213, v212
  v_mul_f32 v173, v215, v214
  v_mul_f32 v174, v217, v216
  s_waitcnt lgkmcnt(4)
  v_mfma_f32_32x32x16_bf16 v[136:151], v[240:243], v[56:59], v[136:151]
  ds_read_b128 v[240:243], v1 offset:46080
  v_mul_f32 v175, v219, v218
  v_cvt_pk_bf16_f32 v248, v168, v169
  v_cvt_pk_bf16_f32 v249, v170, v171
  v_cvt_pk_bf16_f32 v250, v172, v173
  v_cvt_pk_bf16_f32 v251, v174, v175
  v_mfma_f32_32x32x16_bf16 v[136:151], v[244:247], v[60:63], v[136:151]
  ds_read_b128 v[244:247], v1 offset:47104
  buffer_store_dwordx4 v[248:251], v1, s[8:11], s35 offen offset:2048 sc1
  v_mul_f32 v212, v184, v223
  v_mul_f32 v214, v185, v223
  v_mfma_f32_32x32x16_bf16 v[136:151], v[200:203], v[64:67], v[136:151]
  ds_read_b128 v[200:203], v1 offset:48128
  buffer_load_dwordx4 v1, s[8:11], s57 offen offset:2048 sc1 lds
  v_mul_f32 v216, v186, v223
  v_mul_f32 v218, v187, v223
  v_mfma_f32_32x32x16_bf16 v[136:151], v[204:207], v[68:71], v[136:151]
  ds_read_b128 v[204:207], v1 offset:49152
  v_exp_f32 v212, v212
  v_exp_f32 v214, v214
  v_fma_f32 v212, v212, v221, v221
  s_waitcnt lgkmcnt(4)
  v_mfma_f32_32x32x16_bf16 v[136:151], v[224:227], v[72:75], v[136:151]
  ds_read_b128 v[224:227], v1 offset:50176
  v_exp_f32 v216, v216
  v_exp_f32 v218, v218
  v_fma_f32 v214, v214, v221, v221
  v_mfma_f32_32x32x16_bf16 v[136:151], v[228:231], v[76:79], v[136:151]
  ds_read_b128 v[228:231], v1 offset:51200
  v_fma_f32 v216, v216, v221, v221
  v_fma_f32 v218, v218, v221, v221
  v_rcp_f32 v212, v212
  v_mul_f32 v213, v184, v192
  v_mfma_f32_32x32x16_bf16 v[136:151], v[232:235], v[80:83], v[136:151]
  ds_read_b128 v[232:235], v1 offset:52224
  buffer_load_dwordx4 v1, s[8:11], s57 offen offset:3072 sc1 lds
  v_rcp_f32 v214, v214
  v_mfma_f32_32x32x16_bf16 v[136:151], v[236:239], v[84:87], v[136:151]
  ds_read_b128 v[236:239], v1 offset:53248
  v_rcp_f32 v216, v216
  v_rcp_f32 v218, v218
  v_mul_f32 v215, v185, v193
  s_waitcnt lgkmcnt(4)
  v_mfma_f32_32x32x16_bf16 v[136:151], v[240:243], v[88:91], v[136:151]
  ds_read_b128 v[240:243], v1 offset:54272
  s_waitcnt vmcnt(19)
  s_waitcnt vmcnt(16)
  s_barrier
  v_mul_f32 v217, v186, v194
  v_mul_f32 v219, v187, v195
  v_mul_f32 v184, v213, v212
  v_mul_f32 v185, v215, v214
  v_mfma_f32_32x32x16_bf16 v[136:151], v[244:247], v[92:95], v[136:151]
  ds_read_b128 v[244:247], v1 offset:55296
  v_mul_f32 v186, v217, v216
  v_mul_f32 v187, v219, v218
  v_mul_f32 v212, v188, v223
  v_mul_f32 v214, v189, v223
  v_mul_f32 v216, v190, v223
  v_mfma_f32_32x32x16_bf16 v[136:151], v[200:203], v[96:99], v[136:151]
  ds_read_b128 v[200:203], v1 offset:56320
  s_add_u32 m0, s20, 0
  s_add_u32 s57, s5, 0
  buffer_load_dwordx4 v1, s[8:11], s57 offen offset:0 sc1 lds
  v_mfma_f32_32x32x16_bf16 v[136:151], v[204:207], v[100:103], v[136:151]
  ds_read_b128 v[204:207], v1 offset:57344
  v_mul_f32 v218, v191, v223
  v_exp_f32 v212, v212
  v_exp_f32 v214, v214
  s_waitcnt lgkmcnt(4)
  v_mfma_f32_32x32x16_bf16 v[136:151], v[224:227], v[104:107], v[136:151]
  ds_read_b128 v[224:227], v1 offset:58368
  v_exp_f32 v216, v216
  v_exp_f32 v218, v218
  v_fma_f32 v212, v212, v221, v221
  v_mfma_f32_32x32x16_bf16 v[136:151], v[228:231], v[108:111], v[136:151]
  ds_read_b128 v[228:231], v12 offset:38912
  buffer_load_dwordx4 v1, s[8:11], s57 offen offset:1024 sc1 lds
  v_fma_f32 v214, v214, v221, v221
  v_fma_f32 v216, v216, v221, v221
  v_mfma_f32_32x32x16_bf16 v[136:151], v[232:235], v[112:115], v[136:151]
  ds_read_b128 v[232:235], v12 offset:39936
  v_fma_f32 v218, v218, v221, v221
  v_rcp_f32 v212, v212
  v_rcp_f32 v214, v214
  v_mfma_f32_32x32x16_bf16 v[136:151], v[236:239], v[116:119], v[136:151]
  ds_read_b128 v[236:239], v12 offset:40960
  v_rcp_f32 v216, v216
  v_rcp_f32 v218, v218
  v_mul_f32 v213, v188, v196
  s_waitcnt lgkmcnt(4)
  v_mfma_f32_32x32x16_bf16 v[136:151], v[240:243], v[120:123], v[136:151]
  ds_read_b128 v[240:243], v12 offset:41984
  buffer_load_dwordx4 v1, s[8:11], s57 offen offset:2048 sc1 lds
  v_mul_f32 v215, v189, v197
  v_mul_f32 v217, v190, v198
  v_mfma_f32_32x32x16_bf16 v[136:151], v[244:247], v[124:127], v[136:151]
  ds_read_b128 v[244:247], v12 offset:43008
  v_mul_f32 v219, v191, v199
  v_mul_f32 v188, v213, v212
  v_mul_f32 v189, v215, v214
  v_mul_f32 v190, v217, v216
  v_mul_f32 v191, v219, v218
  v_mfma_f32_32x32x16_bf16 v[136:151], v[200:203], v[128:131], v[136:151]
  ds_read_b128 v[200:203], v12 offset:44032
  v_cvt_pk_bf16_f32 v252, v184, v185
  v_cvt_pk_bf16_f32 v253, v186, v187
  v_cvt_pk_bf16_f32 v254, v188, v189
  v_cvt_pk_bf16_f32 v255, v190, v191
  v_mfma_f32_32x32x16_bf16 v[136:151], v[204:207], v[132:135], v[136:151]
  ds_read_b128 v[204:207], v12 offset:45056
  buffer_store_dwordx4 v[252:255], v1, s[8:11], s35 offen offset:3072 sc1
  s_waitcnt lgkmcnt(4)
  v_mfma_f32_32x32x16_bf16 v[136:151], v[224:227], v[208:211], v[136:151]
  ds_read_b128 v[224:227], v12 offset:46080
  buffer_load_dwordx4 v1, s[8:11], s57 offen offset:3072 sc1 lds
  v_mfma_f32_32x32x16_bf16 v[152:167], v[228:231], v[24:27], 0
  ds_read_b128 v[228:231], v12 offset:47104
  v_mfma_f32_32x32x16_bf16 v[152:167], v[232:235], v[28:31], v[152:167]
  ds_read_b128 v[232:235], v12 offset:48128
  v_mfma_f32_32x32x16_bf16 v[152:167], v[236:239], v[32:35], v[152:167]
  ds_read_b128 v[236:239], v12 offset:49152
  s_add_u32 m0, s20, 4096
  s_add_u32 s57, s5, 4096
  buffer_load_dwordx4 v1, s[8:11], s57 offen offset:0 sc1 lds
  s_waitcnt lgkmcnt(4)
  v_mfma_f32_32x32x16_bf16 v[152:167], v[240:243], v[36:39], v[152:167]
  ds_read_b128 v[240:243], v12 offset:50176
  v_mul_f32 v212, v136, v223
  v_mul_f32 v214, v137, v223
  v_mul_f32 v216, v138, v223
  v_mul_f32 v218, v139, v223
  v_mul_f32 v213, v136, v144
  v_mfma_f32_32x32x16_bf16 v[152:167], v[244:247], v[40:43], v[152:167]
  ds_read_b128 v[244:247], v12 offset:51200
  v_exp_f32 v212, v212
  v_exp_f32 v214, v214
  v_fma_f32 v212, v212, v221, v221
  v_mfma_f32_32x32x16_bf16 v[152:167], v[200:203], v[44:47], v[152:167]
  ds_read_b128 v[200:203], v12 offset:52224
  v_exp_f32 v216, v216
  v_exp_f32 v218, v218
  v_fma_f32 v214, v214, v221, v221
  v_mfma_f32_32x32x16_bf16 v[152:167], v[204:207], v[48:51], v[152:167]
  ds_read_b128 v[204:207], v12 offset:53248
  buffer_load_dwordx4 v1, s[8:11], s57 offen offset:1024 sc1 lds
  v_fma_f32 v216, v216, v221, v221
  v_fma_f32 v218, v218, v221, v221
  s_waitcnt lgkmcnt(4)
  v_mfma_f32_32x32x16_bf16 v[152:167], v[224:227], v[52:55], v[152:167]
  ds_read_b128 v[224:227], v12 offset:54272
  v_rcp_f32 v212, v212
  v_rcp_f32 v214, v214
  v_mul_f32 v215, v137, v145
  v_mfma_f32_32x32x16_bf16 v[152:167], v[228:231], v[56:59], v[152:167]
  ds_read_b128 v[228:231], v12 offset:55296
  v_rcp_f32 v216, v216
  v_rcp_f32 v218, v218
  v_mul_f32 v217, v138, v146
  v_mfma_f32_32x32x16_bf16 v[152:167], v[232:235], v[60:63], v[152:167]
  ds_read_b128 v[232:235], v12 offset:56320
  buffer_load_dwordx4 v1, s[8:11], s57 offen offset:2048 sc1 lds
  v_mul_f32 v219, v139, v147
  v_mul_f32 v136, v213, v212
  v_mfma_f32_32x32x16_bf16 v[152:167], v[236:239], v[64:67], v[152:167]
  ds_read_b128 v[236:239], v12 offset:57344
  v_mul_f32 v137, v215, v214
  v_mul_f32 v138, v217, v216
  v_mul_f32 v139, v219, v218
  v_mul_f32 v212, v140, v223
  v_mul_f32 v214, v141, v223
  s_waitcnt lgkmcnt(4)
  v_mfma_f32_32x32x16_bf16 v[152:167], v[240:243], v[68:71], v[152:167]
  ds_read_b128 v[240:243], v12 offset:58368
  v_mul_f32 v216, v142, v223
  v_mul_f32 v218, v143, v223
  v_exp_f32 v212, v212
  v_mul_f32 v213, v140, v148
  v_mfma_f32_32x32x16_bf16 v[152:167], v[244:247], v[72:75], v[152:167]
  ds_read_b128 v[244:247], v12 offset:59392
  s_waitcnt vmcnt(10)
  s_waitcnt vmcnt(4)
  s_cbranch_vccz Lpub_21
  s_mov_b64 exec, 1
  buffer_store_dword v15, v2, s[8:11], s36 offen offset:64
  s_mov_b64 exec, -1
Lpubr_22:
  s_nop 0
  buffer_load_dwordx4 v1, s[8:11], s57 offen offset:3072 sc1 lds
  v_fma_f32 v212, v212, v221, v221
  v_mfma_f32_32x32x16_bf16 v[152:167], v[200:203], v[76:79], v[152:167]
  ds_read_b128 v[200:203], v12 offset:60416
  v_exp_f32 v214, v214
  v_exp_f32 v216, v216
  v_fma_f32 v214, v214, v221, v221
  v_mfma_f32_32x32x16_bf16 v[152:167], v[204:207], v[80:83], v[152:167]
  ds_read_b128 v[204:207], v12 offset:61440
  v_exp_f32 v218, v218
  v_fma_f32 v216, v216, v221, v221
  v_rcp_f32 v212, v212
  s_waitcnt lgkmcnt(4)
  v_mfma_f32_32x32x16_bf16 v[152:167], v[224:227], v[84:87], v[152:167]
  ds_read_b128 v[224:227], v12 offset:62464
  v_fma_f32 v218, v218, v221, v221
  v_rcp_f32 v214, v214
  v_rcp_f32 v216, v216
  v_mfma_f32_32x32x16_bf16 v[152:167], v[228:231], v[88:91], v[152:167]
  ds_read_b128 v[228:231], v12 offset:63488
  s_barrier
  v_rcp_f32 v218, v218
  v_mul_f32 v215, v141, v149
  v_mul_f32 v217, v142, v150
  v_mfma_f32_32x32x16_bf16 v[152:167], v[232:235], v[92:95], v[152:167]
  ds_read_b128 v[232:235], v12 offset:64512
  v_mul_f32 v219, v143, v151
  v_mul_f32 v140, v213, v212
  v_mul_f32 v141, v215, v214
  v_mul_f32 v142, v217, v216
  v_mul_f32 v143, v219, v218
  v_mfma_f32_32x32x16_bf16 v[152:167], v[236:239], v[96:99], v[152:167]
  ds_read_b128 v[236:239], v13 offset:0
  s_add_u32 m0, s44, 29696
  s_add_u32 s57, s40, s44
  s_add_u32 s57, s57, 29696
  buffer_load_dwordx4 v1, s[8:11], s57 offen offset:0 sc1 lds
  s_waitcnt lgkmcnt(4)
  v_mfma_f32_32x32x16_bf16 v[152:167], v[240:243], v[100:103], v[152:167]
  ds_read_b128 v[240:243], v13 offset:1024
  v_cvt_pk_bf16_f32 v248, v136, v137
  v_cvt_pk_bf16_f32 v249, v138, v139
  v_cvt_pk_bf16_f32 v250, v140, v141
  v_cvt_pk_bf16_f32 v251, v142, v143
  v_mfma_f32_32x32x16_bf16 v[152:167], v[244:247], v[104:107], v[152:167]
  ds_read_b128 v[244:247], v13 offset:2048
  buffer_store_dwordx4 v[248:251], v1, s[8:11], s59 offen offset:0 sc1
  buffer_load_dwordx4 v1, s[8:11], s57 offen offset:1024 sc1 lds
  v_mfma_f32_32x32x16_bf16 v[152:167], v[200:203], v[108:111], v[152:167]
  ds_read_b128 v[200:203], v13 offset:3072
  v_mfma_f32_32x32x16_bf16 v[152:167], v[204:207], v[112:115], v[152:167]
  ds_read_b128 v[204:207], v13 offset:4096
  s_waitcnt lgkmcnt(4)
  v_mfma_f32_32x32x16_bf16 v[152:167], v[224:227], v[116:119], v[152:167]
  ds_read_b128 v[224:227], v13 offset:5120
  buffer_load_dwordx4 v1, s[8:11], s57 offen offset:2048 sc1 lds
  v_mfma_f32_32x32x16_bf16 v[152:167], v[228:231], v[120:123], v[152:167]
  ds_read_b128 v[228:231], v13 offset:6144
  v_mfma_f32_32x32x16_bf16 v[152:167], v[232:235], v[124:127], v[152:167]
  ds_read_b128 v[232:235], v13 offset:7168
  buffer_load_dwordx4 v1, s[8:11], s57 offen offset:3072 sc1 lds
  v_mfma_f32_32x32x16_bf16 v[152:167], v[236:239], v[128:131], v[152:167]
  ds_read_b128 v[236:239], v13 offset:8192
  s_waitcnt lgkmcnt(4)
  v_mfma_f32_32x32x16_bf16 v[152:167], v[240:243], v[132:135], v[152:167]
  ds_read_b128 v[240:243], v13 offset:9216
  v_mfma_f32_32x32x16_bf16 v[152:167], v[244:247], v[208:211], v[152:167]
  s_add_u32 m0, s44, 33792
  s_add_u32 s57, s40, s44
  s_add_u32 s57, s57, 33792
  buffer_load_dwordx4 v1, s[8:11], s57 offen offset:0 sc1 lds
  v_mfma_f32_32x32x16_bf16 v[168:183], v[200:203], v[24:27], 0
  ds_read_b128 v[244:247], v13 offset:10240
  ds_read_b128 v[200:203], v13 offset:11264
  v_mfma_f32_32x32x16_bf16 v[168:183], v[204:207], v[28:31], v[168:183]
  ds_read_b128 v[204:207], v13 offset:12288
  s_waitcnt lgkmcnt(4)
  v_mfma_f32_32x32x16_bf16 v[168:183], v[224:227], v[32:35], v[168:183]
  buffer_load_dwordx4 v1, s[8:11], s57 offen offset:1024 sc1 lds
  ds_read_b128 v[224:227], v13 offset:13312
  v_mfma_f32_32x32x16_bf16 v[168:183], v[228:231], v[36:39], v[168:183]
  ds_read_b128 v[228:231], v13 offset:14336
  v_mfma_f32_32x32x16_bf16 v[168:183], v[232:235], v[40:43], v[168:183]
  ds_read_b128 v[232:235], v13 offset:15360
  s_cmp_ge_u32 s17, 28
  s_cbranch_scc1 M_ut0
M_down0:
  v_mfma_f32_32x32x16_bf16 v[168:183], v[236:239], v[44:47], v[168:183]
  ds_read_b128 v[236:239], v13 offset:16384
  buffer_load_dword v6, v3, s[8:11], s37 offen offset:64 sc1
  v_mul_f32 v212, v152, v223
  v_mul_f32 v214, v153, v223
  v_mul_f32 v216, v154, v223
  s_waitcnt lgkmcnt(4)
  v_mfma_f32_32x32x16_bf16 v[168:183], v[240:243], v[48:51], v[168:183]
  ds_read_b128 v[240:243], v13 offset:17408
  v_mul_f32 v218, v155, v223
  v_exp_f32 v212, v212
  v_exp_f32 v214, v214
  v_fma_f32 v212, v212, v221, v221
  v_mfma_f32_32x32x16_bf16 v[168:183], v[244:247], v[52:55], v[168:183]
  ds_read_b128 v[244:247], v13 offset:18432
  v_exp_f32 v216, v216
  v_exp_f32 v218, v218
  v_fma_f32 v214, v214, v221, v221
  v_fma_f32 v216, v216, v221, v221
  v_mfma_f32_32x32x16_bf16 v[168:183], v[200:203], v[56:59], v[168:183]
  ds_read_b128 v[200:203], v13 offset:19456
  v_fma_f32 v218, v218, v221, v221
  v_rcp_f32 v212, v212
  v_rcp_f32 v214, v214
  v_mul_f32 v213, v152, v160
  v_mfma_f32_32x32x16_bf16 v[168:183], v[204:207], v[60:63], v[168:183]
  ds_read_b128 v[204:207], v13 offset:20480
  v_rcp_f32 v216, v216
  v_rcp_f32 v218, v218
  v_mul_f32 v215, v153, v161
  v_mul_f32 v217, v154, v162
  s_waitcnt lgkmcnt(4)
  v_mfma_f32_32x32x16_bf16 v[168:183], v[224:227], v[64:67], v[168:183]
  ds_read_b128 v[224:227], v13 offset:21504
  v_mul_f32 v219, v155, v163
  v_mul_f32 v152, v213, v212
  v_mul_f32 v153, v215, v214
  v_mul_f32 v154, v217, v216
  v_mul_f32 v155, v219, v218
  v_mul_f32 v212, v156, v223
  v_mfma_f32_32x32x16_bf16 v[168:183], v[228:231], v[68:71], v[168:183]
  ds_read_b128 v[228:231], v13 offset:22528
  v_mul_f32 v214, v157, v223
  v_mul_f32 v216, v158, v223
  v_mul_f32 v218, v159, v223
  v_exp_f32 v212, v212
  v_mul_f32 v213, v156, v164
  v_mfma_f32_32x32x16_bf16 v[168:183], v[232:235], v[72:75], v[168:183]
  ds_read_b128 v[232:235], v13 offset:23552
  v_exp_f32 v214, v214
  v_exp_f32 v216, v216
  v_fma_f32 v212, v212, v221, v221
  v_mfma_f32_32x32x16_bf16 v[168:183], v[236:239], v[76:79], v[168:183]
  ds_read_b128 v[236:239], v13 offset:24576
  s_waitcnt vmcnt(0)
  v_cmp_ne_u32 s[54:55], 0, v6
  s_nop 0
  s_cmp_eq_u64 s[54:55], exec
  s_cbranch_scc0 M_hE0_s
M_hE0:
  s_cbranch_vccz Lacq_27
Lacqr_28:
  s_nop 0
  s_add_u32 s56, s39, 0
  buffer_load_dwordx4 v[24:27], v1, s[8:11], s56 offen offset:0 sc1
  s_waitcnt lgkmcnt(4)
  v_mfma_f32_32x32x16_bf16 v[168:183], v[240:243], v[80:83], v[168:183]
  ds_read_b128 v[240:243], v13 offset:25600
  v_exp_f32 v218, v218
  v_fma_f32 v214, v214, v221, v221
  v_fma_f32 v216, v216, v221, v221
  v_fma_f32 v218, v218, v221, v221
  v_mfma_f32_32x32x16_bf16 v[168:183], v[244:247], v[84:87], v[168:183]
  ds_read_b128 v[244:247], v13 offset:26624
  s_add_u32 s56, s39, 0
  buffer_load_dwordx4 v[28:31], v1, s[8:11], s56 offen offset:1024 sc1
  v_mul_f32 v215, v157, v165
  v_mfma_f32_32x32x16_bf16 v[168:183], v[200:203], v[88:91], v[168:183]
  ds_read_b128 v[200:203], v13 offset:27648
  v_rcp_f32 v212, v212
  v_rcp_f32 v214, v214
  v_mul_f32 v217, v158, v166
  v_mfma_f32_32x32x16_bf16 v[168:183], v[204:207], v[92:95], v[168:183]
  ds_read_b128 v[204:207], v13 offset:28672
  s_add_u32 s56, s39, 0
  buffer_load_dwordx4 v[32:35], v1, s[8:11], s56 offen offset:2048 sc1
  v_mul_f32 v219, v159, v167
  s_waitcnt lgkmcnt(4)
  v_mfma_f32_32x32x16_bf16 v[168:183], v[224:227], v[96:99], v[168:183]
  ds_read_b128 v[224:227], v13 offset:29696
  v_rcp_f32 v216, v216
  v_rcp_f32 v218, v218
  v_mul_f32 v156, v213, v212
  v_mfma_f32_32x32x16_bf16 v[168:183], v[228:231], v[100:103], v[168:183]
  ds_read_b128 v[228:231], v13 offset:30720
  s_add_u32 s56, s39, 0
  buffer_load_dwordx4 v[36:39], v1, s[8:11], s56 offen offset:3072 sc1
  v_mul_f32 v157, v215, v214
  v_mfma_f32_32x32x16_bf16 v[168:183], v[232:235], v[104:107], v[168:183]
  ds_read_b128 v[232:235], v13 offset:31744
  v_mul_f32 v158, v217, v216
  v_mul_f32 v159, v219, v218
  v_lshlrev_b32 v88, 16, v16
  v_and_b32 v89, 0xffff0000, v16
  v_lshlrev_b32 v90, 16, v17
  v_mfma_f32_32x32x16_bf16 v[168:183], v[236:239], v[108:111], v[168:183]
  s_add_u32 s56, s39, 4096
  buffer_load_dwordx4 v[40:43], v1, s[8:11], s56 offen offset:3072 sc1
  v_and_b32 v91, 0xffff0000, v17
  v_lshlrev_b32 v92, 16, v18
  s_waitcnt lgkmcnt(4)
  v_mfma_f32_32x32x16_bf16 v[168:183], v[240:243], v[112:115], v[168:183]
  v_and_b32 v93, 0xffff0000, v18
  v_lshlrev_b32 v94, 16, v19
  v_and_b32 v95, 0xffff0000, v19
  v_lshlrev_b32 v96, 16, v20
  v_and_b32 v97, 0xffff0000, v20
  v_mfma_f32_32x32x16_bf16 v[168:183], v[244:247], v[116:119], v[168:183]
  s_add_u32 s56, s39, 8192
  buffer_load_dwordx4 v[44:47], v1, s[8:11], s56 offen offset:0 sc1
  v_lshlrev_b32 v98, 16, v21
  v_and_b32 v99, 0xffff0000, v21
  v_mfma_f32_32x32x16_bf16 v[168:183], v[200:203], v[120:123], v[168:183]
  v_lshlrev_b32 v100, 16, v22
  v_and_b32 v101, 0xffff0000, v22
  v_lshlrev_b32 v102, 16, v23
  v_and_b32 v103, 0xffff0000, v23
  v_cvt_pk_bf16_f32 v252, v152, v153
  s_waitcnt lgkmcnt(3)
  v_mfma_f32_32x32x16_bf16 v[168:183], v[204:207], v[124:127], v[168:183]
  s_add_u32 s56, s39, 8192
  buffer_load_dwordx4 v[48:51], v1, s[8:11], s56 offen offset:1024 sc1
  v_cvt_pk_bf16_f32 v253, v154, v155
  v_cvt_pk_bf16_f32 v254, v156, v157
  s_waitcnt lgkmcnt(2)
  v_mfma_f32_32x32x16_bf16 v[168:183], v[224:227], v[128:131], v[168:183]
  v_cvt_pk_bf16_f32 v255, v158, v159
  s_xor_b32 s6, s16, 1
  s_mul_i32 s6, s6, 12288
  s_add_u32 s6, s6, 55296
  v_add_u32 v201, s6, v1
  s_waitcnt lgkmcnt(1)
  v_mfma_f32_32x32x16_bf16 v[168:183], v[228:231], v[132:135], v[168:183]
  buffer_store_dwordx4 v[252:255], v1, s[8:11], s59 offen offset:1024 sc1
  s_add_u32 s56, s39, 8192
  buffer_load_dwordx4 v[52:55], v1, s[8:11], s56 offen offset:2048 sc1
  s_waitcnt lgkmcnt(0)
  v_mfma_f32_32x32x16_bf16 v[168:183], v[232:235], v[208:211], v[168:183]
  s_barrier
  s_add_u32 s56, s39, 12288
  buffer_load_dwordx4 v[56:59], v1, s[8:11], s56 offen offset:2048 sc1
  s_xor_b32 s6, s16, 2
  s_mul_i32 s6, s6, 12288
  s_add_u32 s6, s6, 59392
  v_add_u32 v202, s6, v1
  s_xor_b32 s6, s16, 3
  s_mul_i32 s6, s6, 12288
  s_add_u32 s6, s6, 63488
  v_add_u32 v203, s6, v1
  s_mul_i32 s6, s16, 12288
  s_add_u32 s6, s6, 55296
  v_add_u32 v200, s6, v1
  v_mul_f32 v212, v168, v223
  v_mul_f32 v214, v169, v223
  v_mul_f32 v216, v170, v223
  s_waitcnt vmcnt(9)
  v_mfma_f32_32x32x16_bf16 v[184:199], a[112:115], v[24:27], 0
  s_add_u32 s56, s39, 12288
  buffer_load_dwordx4 v[60:63], v1, s[8:11], s56 offen offset:3072 sc1
  v_mul_f32 v218, v171, v223
  v_exp_f32 v212, v212
  v_exp_f32 v214, v214
  v_exp_f32 v216, v216
  v_fma_f32 v212, v212, v221, v221
  v_mfma_f32_32x32x16_bf16 v[136:151], a[0:3], v[24:27], 0
  v_exp_f32 v218, v218
  v_fma_f32 v214, v214, v221, v221
  v_fma_f32 v216, v216, v221, v221
  v_fma_f32 v218, v218, v221, v221
  v_rcp_f32 v212, v212
  v_rcp_f32 v214, v214
  v_rcp_f32 v216, v216
  s_waitcnt vmcnt(9)
  v_mfma_f32_32x32x16_bf16 v[184:199], a[116:119], v[28:31], v[184:199]
  s_add_u32 s56, s39, 16384
  buffer_load_dwordx4 v[64:67], v1, s[8:11], s56 offen offset:0 sc1
  v_rcp_f32 v218, v218
  v_mul_f32 v213, v168, v176
  v_mul_f32 v215, v169, v177
  v_mul_f32 v217, v170, v178
  v_mul_f32 v219, v171, v179
  v_mul_f32 v168, v213, v212
  v_mul_f32 v169, v215, v214
  v_mfma_f32_32x32x16_bf16 v[136:151], a[4:7], v[28:31], v[136:151]
  v_mul_f32 v170, v217, v216
  v_mul_f32 v171, v219, v218
  v_mul_f32 v212, v172, v223
  v_mul_f32 v214, v173, v223
  v_mul_f32 v216, v174, v223
  v_mul_f32 v218, v175, v223
  v_exp_f32 v212, v212
  v_exp_f32 v214, v214
  v_fma_f32 v212, v212, v221, v221
  s_waitcnt vmcnt(9)
  v_mfma_f32_32x32x16_bf16 v[184:199], a[120:123], v[32:35], v[184:199]
  s_add_u32 s56, s39, 16384
  buffer_load_dwordx4 v[68:71], v1, s[8:11], s56 offen offset:1024 sc1
  v_exp_f32 v216, v216
  v_exp_f32 v218, v218
  v_fma_f32 v214, v214, v221, v221
  v_fma_f32 v216, v216, v221, v221
  v_fma_f32 v218, v218, v221, v221
  v_mul_f32 v213, v172, v180
  v_mfma_f32_32x32x16_bf16 v[136:151], a[8:11], v[32:35], v[136:151]
  v_rcp_f32 v212, v212
  v_rcp_f32 v214, v214
  v_rcp_f32 v216, v216
  v_rcp_f32 v218, v218
  v_mul_f32 v215, v173, v181
  v_mul_f32 v217, v174, v182
  v_mul_f32 v219, v175, v183
  s_waitcnt vmcnt(9)
  v_mfma_f32_32x32x16_bf16 v[184:199], a[124:127], v[36:39], v[184:199]
  s_add_u32 s56, s39, 20480
  buffer_load_dwordx4 v[72:75], v1, s[8:11], s56 offen offset:1024 sc1
  v_mul_f32 v172, v213, v212
  v_mul_f32 v173, v215, v214
  v_mul_f32 v174, v217, v216
  v_mul_f32 v175, v219, v218
  v_cvt_pk_bf16_f32 v248, v168, v169
  v_cvt_pk_bf16_f32 v249, v170, v171
  v_cvt_pk_bf16_f32 v250, v172, v173
  v_cvt_pk_bf16_f32 v251, v174, v175
  v_mfma_f32_32x32x16_bf16 v[136:151], a[12:15], v[36:39], v[136:151]
  buffer_store_dwordx4 v[248:251], v1, s[8:11], s59 offen offset:2048 sc1
  s_waitcnt vmcnt(10)
  v_mfma_f32_32x32x16_bf16 v[184:199], a[140:143], v[40:43], v[184:199]
  s_add_u32 s56, s39, 20480
  buffer_load_dwordx4 v[76:79], v1, s[8:11], s56 offen offset:2048 sc1
  v_mfma_f32_32x32x16_bf16 v[136:151], a[28:31], v[40:43], v[136:151]
  s_waitcnt vmcnt(10)
  v_mfma_f32_32x32x16_bf16 v[184:199], a[144:147], v[44:47], v[184:199]
  s_add_u32 s56, s39, 20480
  buffer_load_dwordx4 v[80:83], v1, s[8:11], s56 offen offset:3072 sc1
  v_mfma_f32_32x32x16_bf16 v[136:151], a[32:35], v[44:47], v[136:151]
  s_waitcnt vmcnt(10)
  v_mfma_f32_32x32x16_bf16 v[184:199], a[148:151], v[48:51], v[184:199]
  s_add_u32 s56, s39, 24576
  buffer_load_dwordx4 v[84:87], v1, s[8:11], s56 offen offset:0 sc1
  v_mfma_f32_32x32x16_bf16 v[136:151], a[36:39], v[48:51], v[136:151]
  s_waitcnt vmcnt(9)
  v_mfma_f32_32x32x16_bf16 v[184:199], a[152:155], v[52:55], v[184:199]
  s_add_u32 s56, s38, 0
  buffer_load_dwordx4 v[24:27], v1, s[8:11], s56 offen offset:0 sc1
  v_mfma_f32_32x32x16_bf16 v[136:151], a[40:43], v[52:55], v[136:151]
  s_waitcnt vmcnt(9)
  v_mfma_f32_32x32x16_bf16 v[184:199], a[168:171], v[56:59], v[184:199]
  s_add_u32 s56, s38, 0
  buffer_load_dwordx4 v[28:31], v1, s[8:11], s56 offen offset:1024 sc1
  v_mfma_f32_32x32x16_bf16 v[136:151], a[56:59], v[56:59], v[136:151]
  s_waitcnt vmcnt(9)
  v_mfma_f32_32x32x16_bf16 v[184:199], a[172:175], v[60:63], v[184:199]
  s_add_u32 s56, s38, 0
  buffer_load_dwordx4 v[32:35], v1, s[8:11], s56 offen offset:2048 sc1
  v_mfma_f32_32x32x16_bf16 v[136:151], a[60:63], v[60:63], v[136:151]
  s_waitcnt vmcnt(6)
  s_cbranch_vccz Lpub_29
  s_mov_b64 exec, 1
  buffer_store_dword v15, v2, s[8:11], s36 offen offset:0
  s_mov_b64 exec, -1
Lpubr_30:
  s_nop 0
  v_mfma_f32_32x32x16_bf16 v[184:199], a[176:179], v[64:67], v[184:199]
  s_add_u32 s56, s38, 0
  buffer_load_dwordx4 v[36:39], v1, s[8:11], s56 offen offset:3072 sc1
  v_mfma_f32_32x32x16_bf16 v[136:151], a[64:67], v[64:67], v[136:151]
  v_mfma_f32_32x32x16_bf16 v[184:199], a[180:183], v[68:71], v[184:199]
  s_add_u32 s56, s38, 4096
  buffer_load_dwordx4 v[40:43], v1, s[8:11], s56 offen offset:3072 sc1
  v_mfma_f32_32x32x16_bf16 v[136:151], a[68:71], v[68:71], v[136:151]
  v_mfma_f32_32x32x16_bf16 v[184:199], a[196:199], v[72:75], v[184:199]
  s_add_u32 s56, s38, 8192
  buffer_load_dwordx4 v[44:47], v1, s[8:11], s56 offen offset:0 sc1
  v_mfma_f32_32x32x16_bf16 v[136:151], a[84:87], v[72:75], v[136:151]
  s_waitcnt vmcnt(9)
  v_mfma_f32_32x32x16_bf16 v[184:199], a[200:203], v[76:79], v[184:199]
  s_add_u32 s56, s38, 8192
  buffer_load_dwordx4 v[48:51], v1, s[8:11], s56 offen offset:1024 sc1
  v_mfma_f32_32x32x16_bf16 v[136:151], a[88:91], v[76:79], v[136:151]
  s_waitcnt vmcnt(9)
  v_mfma_f32_32x32x16_bf16 v[184:199], a[204:207], v[80:83], v[184:199]
  s_add_u32 s56, s38, 8192
  buffer_load_dwordx4 v[52:55], v1, s[8:11], s56 offen offset:2048 sc1
  v_mfma_f32_32x32x16_bf16 v[136:151], a[92:95], v[80:83], v[136:151]
  s_waitcnt vmcnt(9)
  v_mfma_f32_32x32x16_bf16 v[184:199], a[208:211], v[84:87], v[184:199]
  s_add_u32 s56, s38, 12288
  buffer_load_dwordx4 v[56:59], v1, s[8:11], s56 offen offset:2048 sc1
  v_mfma_f32_32x32x16_bf16 v[136:151], a[96:99], v[84:87], v[136:151]
  s_waitcnt vmcnt(9)
  v_mfma_f32_32x32x16_bf16 v[104:119], a[112:115], v[24:27], 0
  s_add_u32 s56, s38, 12288
  buffer_load_dwordx4 v[60:63], v1, s[8:11], s56 offen offset:3072 sc1
  v_mfma_f32_32x32x16_bf16 v[88:103], a[0:3], v[24:27], v[88:103]
  s_waitcnt vmcnt(9)
  v_mfma_f32_32x32x16_bf16 v[104:119], a[116:119], v[28:31], v[104:119]
  s_add_u32 s56, s38, 16384
  buffer_load_dwordx4 v[64:67], v1, s[8:11], s56 offen offset:0 sc1
  v_mfma_f32_32x32x16_bf16 v[88:103], a[4:7], v[28:31], v[88:103]
  s_waitcnt vmcnt(9)
  v_mfma_f32_32x32x16_bf16 v[104:119], a[120:123], v[32:35], v[104:119]
  s_add_u32 s56, s38, 16384
  buffer_load_dwordx4 v[68:71], v1, s[8:11], s56 offen offset:1024 sc1
  v_mfma_f32_32x32x16_bf16 v[88:103], a[8:11], v[32:35], v[88:103]
  s_waitcnt vmcnt(8)
  v_mfma_f32_32x32x16_bf16 v[104:119], a[124:127], v[36:39], v[104:119]
  s_add_u32 s56, s38, 20480
  buffer_load_dwordx4 v[72:75], v1, s[8:11], s56 offen offset:1024 sc1
  buffer_load_dword v6, v3, s[8:11], s37 offen offset:0 sc1
  v_mfma_f32_32x32x16_bf16 v[88:103], a[12:15], v[36:39], v[88:103]
  s_waitcnt vmcnt(9)
  v_mfma_f32_32x32x16_bf16 v[104:119], a[140:143], v[40:43], v[104:119]
  s_add_u32 s56, s38, 20480
  buffer_load_dwordx4 v[76:79], v1, s[8:11], s56 offen offset:2048 sc1
  v_mfma_f32_32x32x16_bf16 v[88:103], a[28:31], v[40:43], v[88:103]
  s_waitcnt vmcnt(9)
  v_mfma_f32_32x32x16_bf16 v[104:119], a[144:147], v[44:47], v[104:119]
  s_add_u32 s56, s38, 20480
  buffer_load_dwordx4 v[80:83], v1, s[8:11], s56 offen offset:3072 sc1
  v_mfma_f32_32x32x16_bf16 v[88:103], a[32:35], v[44:47], v[88:103]
  s_waitcnt vmcnt(9)
  v_mfma_f32_32x32x16_bf16 v[104:119], a[148:151], v[48:51], v[104:119]
  s_add_u32 s56, s38, 24576
  buffer_load_dwordx4 v[84:87], v1, s[8:11], s56 offen offset:0 sc1
  v_mfma_f32_32x32x16_bf16 v[88:103], a[36:39], v[48:51], v[88:103]
  s_waitcnt vmcnt(9)
  v_mfma_f32_32x32x16_bf16 v[104:119], a[152:155], v[52:55], v[104:119]
  v_mfma_f32_32x32x16_bf16 v[88:103], a[40:43], v[52:55], v[88:103]
  s_waitcnt vmcnt(8)
  v_mfma_f32_32x32x16_bf16 v[104:119], a[168:171], v[56:59], v[104:119]
  s_waitcnt vmcnt(3)
  v_cmp_ne_u32 s[54:55], 0, v6
  s_nop 0
  s_cmp_eq_u64 s[54:55], exec
  s_cbranch_scc0 M_hL0_s
M_hL0:
  s_cbranch_vccz Lacq_33
Lacqr_34:
  s_nop 0
  v_mfma_f32_32x32x16_bf16 v[88:103], a[56:59], v[56:59], v[88:103]
  s_add_u32 s56, s39, 4096
  buffer_load_dwordx4 v[24:27], v1, s[8:11], s56 offen offset:0 sc1
  v_mfma_f32_32x32x16_bf16 v[104:119], a[172:175], v[60:63], v[104:119]
  s_add_u32 s56, s39, 4096
  buffer_load_dwordx4 v[28:31], v1, s[8:11], s56 offen offset:1024 sc1
  v_mfma_f32_32x32x16_bf16 v[88:103], a[60:63], v[60:63], v[88:103]
  s_add_u32 s56, s39, 4096
  buffer_load_dwordx4 v[32:35], v1, s[8:11], s56 offen offset:2048 sc1
  v_mfma_f32_32x32x16_bf16 v[104:119], a[176:179], v[64:67], v[104:119]
  s_add_u32 s56, s39, 8192
  buffer_load_dwordx4 v[36:39], v1, s[8:11], s56 offen offset:3072 sc1
  v_mfma_f32_32x32x16_bf16 v[88:103], a[64:67], v[64:67], v[88:103]
  v_mfma_f32_32x32x16_bf16 v[104:119], a[180:183], v[68:71], v[104:119]
  s_add_u32 s56, s39, 12288
  buffer_load_dwordx4 v[40:43], v1, s[8:11], s56 offen offset:0 sc1
  v_mfma_f32_32x32x16_bf16 v[88:103], a[68:71], v[68:71], v[88:103]
  v_mfma_f32_32x32x16_bf16 v[104:119], a[196:199], v[72:75], v[104:119]
  s_add_u32 s56, s39, 12288
  buffer_load_dwordx4 v[44:47], v1, s[8:11], s56 offen offset:1024 sc1
  v_mfma_f32_32x32x16_bf16 v[88:103], a[84:87], v[72:75], v[88:103]
  s_waitcnt vmcnt(8)
  v_mfma_f32_32x32x16_bf16 v[104:119], a[200:203], v[76:79], v[104:119]
  s_add_u32 s56, s39, 16384
  buffer_load_dwordx4 v[48:51], v1, s[8:11], s56 offen offset:2048 sc1
  v_mfma_f32_32x32x16_bf16 v[88:103], a[88:91], v[76:79], v[88:103]
  s_waitcnt vmcnt(8)
  v_mfma_f32_32x32x16_bf16 v[104:119], a[204:207], v[80:83], v[104:119]
  s_add_u32 s56, s39, 16384
  buffer_load_dwordx4 v[52:55], v1, s[8:11], s56 offen offset:3072 sc1
  v_mfma_f32_32x32x16_bf16 v[88:103], a[92:95], v[80:83], v[88:103]
  s_waitcnt vmcnt(8)
  v_mfma_f32_32x32x16_bf16 v[104:119], a[208:211], v[84:87], v[104:119]
  s_add_u32 s56, s39, 20480
  buffer_load_dwordx4 v[56:59], v1, s[8:11], s56 offen offset:0 sc1
  v_mfma_f32_32x32x16_bf16 v[88:103], a[96:99], v[84:87], v[88:103]
  s_waitcnt vmcnt(8)
  v_mfma_f32_32x32x16_bf16 v[184:199], a[128:131], v[24:27], v[184:199]
  s_add_u32 s56, s39, 24576
  buffer_load_dwordx4 v[60:63], v1, s[8:11], s56 offen offset:1024 sc1
  v_mfma_f32_32x32x16_bf16 v[136:151], a[16:19], v[24:27], v[136:151]
  s_waitcnt vmcnt(8)
  v_mfma_f32_32x32x16_bf16 v[184:199], a[132:135], v[28:31], v[184:199]
  s_add_u32 s56, s39, 24576
  buffer_load_dwordx4 v[64:67], v1, s[8:11], s56 offen offset:2048 sc1
  v_mfma_f32_32x32x16_bf16 v[136:151], a[20:23], v[28:31], v[136:151]
  s_waitcnt vmcnt(8)
  v_mfma_f32_32x32x16_bf16 v[184:199], a[136:139], v[32:35], v[184:199]
  s_add_u32 s56, s39, 24576
  buffer_load_dwordx4 v[68:71], v1, s[8:11], s56 offen offset:3072 sc1
  v_mfma_f32_32x32x16_bf16 v[136:151], a[24:27], v[32:35], v[136:151]
  s_waitcnt vmcnt(8)
  v_mfma_f32_32x32x16_bf16 v[184:199], a[156:159], v[36:39], v[184:199]
  s_add_u32 s56, s38, 4096
  buffer_load_dwordx4 v[72:75], v1, s[8:11], s56 offen offset:0 sc1
  v_mfma_f32_32x32x16_bf16 v[136:151], a[44:47], v[36:39], v[136:151]
  s_waitcnt vmcnt(8)
  v_mfma_f32_32x32x16_bf16 v[184:199], a[160:163], v[40:43], v[184:199]
  s_add_u32 s56, s38, 4096
  buffer_load_dwordx4 v[76:79], v1, s[8:11], s56 offen offset:1024 sc1
  v_mfma_f32_32x32x16_bf16 v[136:151], a[48:51], v[40:43], v[136:151]
  s_waitcnt vmcnt(8)
  v_mfma_f32_32x32x16_bf16 v[184:199], a[164:167], v[44:47], v[184:199]
  s_add_u32 s56, s38, 4096
  buffer_load_dwordx4 v[80:83], v1, s[8:11], s56 offen offset:2048 sc1
  v_mfma_f32_32x32x16_bf16 v[136:151], a[52:55], v[44:47], v[136:151]
  s_waitcnt vmcnt(8)
  v_mfma_f32_32x32x16_bf16 v[184:199], a[184:187], v[48:51], v[184:199]
  s_add_u32 s56, s38, 8192
  buffer_load_dwordx4 v[84:87], v1, s[8:11], s56 offen offset:3072 sc1
  v_mfma_f32_32x32x16_bf16 v[136:151], a[72:75], v[48:51], v[136:151]
  s_waitcnt vmcnt(8)
  v_mfma_f32_32x32x16_bf16 v[184:199], a[188:191], v[52:55], v[184:199]
  s_add_u32 s56, s38, 12288
  buffer_load_dwordx4 v[24:27], v1, s[8:11], s56 offen offset:0 sc1
  v_mfma_f32_32x32x16_bf16 v[136:151], a[76:79], v[52:55], v[136:151]
  s_waitcnt vmcnt(8)
  v_mfma_f32_32x32x16_bf16 v[184:199], a[192:195], v[56:59], v[184:199]
  s_add_u32 s56, s38, 12288
  buffer_load_dwordx4 v[28:31], v1, s[8:11], s56 offen offset:1024 sc1
  v_mfma_f32_32x32x16_bf16 v[136:151], a[80:83], v[56:59], v[136:151]
  s_waitcnt vmcnt(8)
  v_mfma_f32_32x32x16_bf16 v[184:199], a[212:215], v[60:63], v[184:199]
  s_add_u32 s56, s38, 16384
  buffer_load_dwordx4 v[32:35], v1, s[8:11], s56 offen offset:2048 sc1
  v_mfma_f32_32x32x16_bf16 v[136:151], a[100:103], v[60:63], v[136:151]
  s_waitcnt vmcnt(8)
  v_mfma_f32_32x32x16_bf16 v[184:199], a[216:219], v[64:67], v[184:199]
  s_add_u32 s56, s38, 16384
  buffer_load_dwordx4 v[36:39], v1, s[8:11], s56 offen offset:3072 sc1
  v_mfma_f32_32x32x16_bf16 v[136:151], a[104:107], v[64:67], v[136:151]
  s_waitcnt vmcnt(8)
  v_mfma_f32_32x32x16_bf16 v[184:199], a[220:223], v[68:71], v[184:199]
  s_add_u32 s56, s38, 20480
  buffer_load_dwordx4 v[40:43], v1, s[8:11], s56 offen offset:0 sc1
  v_mfma_f32_32x32x16_bf16 v[136:151], a[108:111], v[68:71], v[136:151]
  s_waitcnt vmcnt(8)
  v_mfma_f32_32x32x16_bf16 v[104:119], a[128:131], v[72:75], v[104:119]
  s_add_u32 s56, s38, 24576
  buffer_load_dwordx4 v[44:47], v1, s[8:11], s56 offen offset:1024 sc1
  v_mfma_f32_32x32x16_bf16 v[88:103], a[16:19], v[72:75], v[88:103]
  s_nop 7
  ds_write_b128 v202, v[136:139] offset:0
  s_waitcnt vmcnt(8)
  v_mfma_f32_32x32x16_bf16 v[104:119], a[132:135], v[76:79], v[104:119]
  s_add_u32 s56, s38, 24576
  buffer_load_dwordx4 v[48:51], v1, s[8:11], s56 offen offset:2048 sc1
  v_mfma_f32_32x32x16_bf16 v[88:103], a[20:23], v[76:79], v[88:103]
  ds_write_b128 v202, v[140:143] offset:1024
  s_waitcnt vmcnt(8)
  v_mfma_f32_32x32x16_bf16 v[104:119], a[136:139], v[80:83], v[104:119]
  s_add_u32 s56, s38, 24576
  buffer_load_dwordx4 v[52:55], v1, s[8:11], s56 offen offset:3072 sc1
  ds_write_b128 v202, v[144:147] offset:2048
  v_mfma_f32_32x32x16_bf16 v[88:103], a[24:27], v[80:83], v[88:103]
  s_waitcnt vmcnt(8)
  v_mfma_f32_32x32x16_bf16 v[104:119], a[156:159], v[84:87], v[104:119]
  ds_write_b128 v202, v[148:151] offset:3072
  v_mfma_f32_32x32x16_bf16 v[88:103], a[44:47], v[84:87], v[88:103]
  s_waitcnt vmcnt(7)
  v_mfma_f32_32x32x16_bf16 v[104:119], a[160:163], v[24:27], v[104:119]
  ds_write_b128 v203, v[184:187] offset:0
  v_mfma_f32_32x32x16_bf16 v[88:103], a[48:51], v[24:27], v[88:103]
  ds_write_b128 v203, v[188:191] offset:1024
  s_waitcnt vmcnt(6)
  v_mfma_f32_32x32x16_bf16 v[104:119], a[164:167], v[28:31], v[104:119]
  v_mfma_f32_32x32x16_bf16 v[88:103], a[52:55], v[28:31], v[88:103]
  ds_write_b128 v203, v[192:195] offset:2048
  s_waitcnt vmcnt(5)
  v_mfma_f32_32x32x16_bf16 v[104:119], a[184:187], v[32:35], v[104:119]
  v_mfma_f32_32x32x16_bf16 v[88:103], a[72:75], v[32:35], v[88:103]
  ds_write_b128 v203, v[196:199] offset:3072
  s_waitcnt vmcnt(4)
  v_mfma_f32_32x32x16_bf16 v[104:119], a[188:191], v[36:39], v[104:119]
  v_mfma_f32_32x32x16_bf16 v[88:103], a[76:79], v[36:39], v[88:103]
  s_waitcnt vmcnt(3)
  v_mfma_f32_32x32x16_bf16 v[104:119], a[192:195], v[40:43], v[104:119]
  v_mfma_f32_32x32x16_bf16 v[88:103], a[80:83], v[40:43], v[88:103]
  s_waitcnt lgkmcnt(0)
  s_barrier
  ds_read_b128 v[208:211], v200 offset:4096
  ds_read_b128 v[212:215], v200 offset:5120
  ds_read_b128 v[216:219], v200 offset:6144
  ds_read_b128 v[220:223], v200 offset:7168
  ds_read_b128 v[224:227], v200 offset:8192
  s_waitcnt vmcnt(2)
  v_mfma_f32_32x32x16_bf16 v[104:119], a[212:215], v[44:47], v[104:119]
  ds_read_b128 v[228:231], v200 offset:9216
  ds_read_b128 v[232:235], v200 offset:10240
  ds_read_b128 v[236:239], v200 offset:11264
  v_mfma_f32_32x32x16_bf16 v[88:103], a[100:103], v[44:47], v[88:103]
  s_waitcnt vmcnt(1)
  v_mfma_f32_32x32x16_bf16 v[104:119], a[216:219], v[48:51], v[104:119]
  v_mfma_f32_32x32x16_bf16 v[88:103], a[104:107], v[48:51], v[88:103]
  s_waitcnt lgkmcnt(3)
  v_add_f32 v208, v208, v224
  v_add_f32 v209, v209, v225
  s_waitcnt vmcnt(0)
  v_mfma_f32_32x32x16_bf16 v[104:119], a[220:223], v[52:55], v[104:119]
  v_add_f32 v210, v210, v226
  v_add_f32 v211, v211, v227
  s_waitcnt lgkmcnt(2)
  v_add_f32 v212, v212, v228
  v_add_f32 v213, v213, v229
  v_add_f32 v214, v214, v230
  v_mfma_f32_32x32x16_bf16 v[88:103], a[108:111], v[52:55], v[88:103]
  v_add_f32 v215, v215, v231
  s_waitcnt lgkmcnt(1)
  v_add_f32 v216, v216, v232
  v_add_f32 v217, v217, v233
  v_add_f32 v218, v218, v234
  v_add_f32 v219, v219, v235
  s_waitcnt lgkmcnt(0)
  v_add_f32 v220, v220, v236
  v_add_f32 v221, v221, v237
  v_add_f32 v222, v222, v238
  v_add_f32 v223, v223, v239
  ds_write_b128 v201, v[104:107] offset:0
  s_nop 0
  v_pk_add_f32 v[88:89], v[88:89], v[208:209]
  v_pk_add_f32 v[90:91], v[90:91], v[210:211]
  v_pk_add_f32 v[92:93], v[92:93], v[212:213]
  v_pk_add_f32 v[94:95], v[94:95], v[214:215]
  v_pk_add_f32 v[96:97], v[96:97], v[216:217]
  ds_write_b128 v201, v[108:111] offset:1024
  v_pk_add_f32 v[98:99], v[98:99], v[218:219]
  v_pk_add_f32 v[100:101], v[100:101], v[220:221]
  v_pk_add_f32 v[102:103], v[102:103], v[222:223]
  ds_write_b128 v201, v[112:115] offset:2048
  ds_write_b128 v201, v[116:119] offset:3072
  s_waitcnt lgkmcnt(0)
  s_barrier
  ds_read_b128 v[240:243], v200 offset:0
  ds_read_b128 v[244:247], v200 offset:1024
  ds_read_b128 v[248:251], v200 offset:2048
  ds_read_b128 v[252:255], v200 offset:3072
  s_waitcnt lgkmcnt(3)
  v_pk_add_f32 v[88:89], v[88:89], v[240:241]
  v_pk_add_f32 v[90:91], v[90:91], v[242:243]
  s_waitcnt lgkmcnt(2)
  v_pk_add_f32 v[92:93], v[92:93], v[244:245]
  v_pk_add_f32 v[94:95], v[94:95], v[246:247]
  s_waitcnt lgkmcnt(1)
  v_pk_add_f32 v[96:97], v[96:97], v[248:249]
  v_pk_add_f32 v[98:99], v[98:99], v[250:251]
  s_waitcnt lgkmcnt(0)
  v_pk_add_f32 v[100:101], v[100:101], v[252:253]
  v_pk_add_f32 v[102:103], v[102:103], v[254:255]
  v_cvt_pk_bf16_f32 v16, v88, v89
  v_cvt_pk_bf16_f32 v17, v90, v91
  v_cvt_pk_bf16_f32 v18, v92, v93
  v_cvt_pk_bf16_f32 v19, v94, v95
  buffer_store_dwordx4 v[16:19], v1, s[8:11], s33 offen
  v_cvt_pk_bf16_f32 v20, v96, v97
  v_cvt_pk_bf16_f32 v21, v98, v99
  v_cvt_pk_bf16_f32 v22, v100, v101
  v_cvt_pk_bf16_f32 v23, v102, v103
  buffer_store_dwordx4 v[20:23], v1, s[8:11], s33 offen offset:1024
  v_mov_b32 v10, 0
  v_mov_b32 v11, 0
  v_dot2c_f32_bf16 v10, s22, v16
  v_dot2c_f32_bf16 v10, s22, v17
  v_dot2c_f32_bf16 v10, s22, v18
  v_dot2c_f32_bf16 v10, s22, v19
  v_dot2c_f32_bf16 v10, s22, v20
  v_dot2c_f32_bf16 v10, s22, v21
  v_dot2c_f32_bf16 v10, s22, v22
  v_dot2c_f32_bf16 v10, s22, v23
  v_dot2c_f32_bf16 v11, v16, v16
  v_dot2c_f32_bf16 v11, v17, v17
  v_dot2c_f32_bf16 v11, v18, v18
  v_dot2c_f32_bf16 v11, v19, v19
  v_dot2c_f32_bf16 v11, v20, v20
  v_dot2c_f32_bf16 v11, v21, v21
  v_dot2c_f32_bf16 v11, v22, v22
  v_dot2c_f32_bf16 v11, v23, v23
  s_add_u32 s56, s34, 4096
  s_nop 1
  v_permlane32_swap_b32 v10, v11
  v_add_f32 v10, v10, v11
  v_or_b32 v10, 1, v10
  s_waitcnt vmcnt(0)
  s_cbranch_vccz Lpub_35
  buffer_store_dword v10, v1, s[8:11], s56 offen
Lpubr_36:
M_next0:
  s_nop 7
  s_nop 5
  s_add_u32 s59, s25, 4096
  s_mov_b32 s46, 0
Lpoll_37:
  buffer_load_dwordx4 v[208:211], v1, s[8:11], s59 offen offset:0 sc1
  buffer_load_dwordx4 v[212:215], v1, s[8:11], s59 offen offset:1024 sc1
  buffer_load_dwordx4 v[216:219], v1, s[8:11], s59 offen offset:2048 sc1
  buffer_load_dwordx4 v[220:223], v1, s[8:11], s59 offen offset:3072 sc1
  s_add_u32 s46, s46, 1
  s_waitcnt vmcnt(0)
  v_min3_u32 v6, v208, v209, v210
  v_min3_u32 v7, v211, v212, v213
  v_min3_u32 v8, v214, v215, v216
  v_min3_u32 v9, v217, v218, v219
  v_min3_u32 v6, v6, v220, v221
  v_min3_u32 v7, v7, v8, v9
  v_min_u32 v6, v6, v7
  v_cmp_ne_u32 s[54:55], 0, v6
  s_cmp_gt_u32 s46, 300000
  s_cbranch_scc1 Lpd_38
  s_cmp_eq_u64 s[54:55], exec
  s_cbranch_scc0 Lpoll_37
Lpd_38:
  s_cbranch_vccz Lacq_39
Lacqr_40:
  s_lshl_b32 s56, s16, 12
  v_add_u32 v7, s56, v1
  s_lshl_b32 s56, s16, 10
  v_add_u32 v8, s56, v2
  s_add_u32 s59, s27, 65536
  v_mov_b32 v9, 1
  v_or_b32 v6, s16, v2
  v_min_u32 v6, 1, v6
  v_lshlrev_b32 v6, 30, v6
  buffer_load_dwordx4 v[24:27], v1, s[8:11], s24 offen offset:0 sc1
  buffer_load_dwordx4 v[28:31], v1, s[8:11], s24 offen offset:1024 sc1
  buffer_load_dwordx4 v[32:35], v1, s[8:11], s24 offen offset:2048 sc1
  buffer_load_dwordx4 v[36:39], v1, s[8:11], s24 offen offset:3072 sc1
  s_add_u32 s56, s24, 4096
  buffer_load_dwordx4 v[40:43], v1, s[8:11], s56 offen offset:0 sc1
  buffer_load_dwordx4 v[44:47], v1, s[8:11], s56 offen offset:1024 sc1
  buffer_load_dwordx4 v[48:51], v1, s[8:11], s56 offen offset:2048 sc1
  buffer_load_dwordx4 v[52:55], v1, s[8:11], s56 offen offset:3072 sc1
  s_add_u32 s56, s24, 8192
  buffer_load_dwordx4 v[56:59], v1, s[8:11], s56 offen offset:0 sc1
  buffer_load_dwordx4 v[60:63], v1, s[8:11], s56 offen offset:1024 sc1
  buffer_load_dwordx4 v[64:67], v1, s[8:11], s56 offen offset:2048 sc1
  ds_read_b128 v[184:187], v1 offset:0
  ds_read_b128 v[188:191], v1 offset:1024
  ds_read_b128 v[196:199], v1 offset:29696
  ds_read_b128 v[200:203], v1 offset:30720
  ds_read_b128 v[192:195], v1 offset:2048
  ds_read_b128 v[204:207], v1 offset:31744
  v_add_f32 v208, v208, v209
  v_add_f32 v215, v215, v216
  v_add_f32 v208, v208, v210
  v_add_f32 v215, v215, v217
  v_add_f32 v208, v208, v211
  v_add_f32 v215, v215, v218
  v_add_f32 v208, v208, v212
  v_add_f32 v215, v215, v219
  v_add_f32 v208, v208, v213
  v_add_f32 v215, v215, v220
  v_add_f32 v208, v208, v214
  v_add_f32 v215, v215, v221
  v_mov_b32 v210, 0
  v_add_f32 v220, v208, v215
  v_mov_b32 v221, v220
  s_nop 1
  v_permlane32_swap_b32 v220, v221
  v_mul_f32 v220, 0xbb124925, v220
  v_mul_f32 v221, 0x3b124925, v221
  v_cvt_pk_bf16_f32 v208, v220, v220
  v_fma_f32 v221, -v220, v220, v221
  v_and_b32 v209, 0xffff0000, v208
  v_max_f32 v221, 0, v221
  v_sub_f32 v209, v220, v209
  v_add_f32 v221, 0x3727c5ac, v221
  s_waitcnt vmcnt(10)
  s_waitcnt lgkmcnt(5)
  v_mfma_f32_32x32x16_bf16 v[136:151], v[24:27], v[184:187], 0
  ds_read_b128 v[184:187], v1 offset:3072
  buffer_load_dwordx4 v[68:71], v1, s[8:11], s56 offen offset:3072 sc1
  v_rsq_f32 v222, v221
  s_waitcnt lgkmcnt(4)
  v_mfma_f32_32x32x16_bf16 v[152:167], v[24:27], v[196:199], 0
  ds_read_b128 v[196:199], v1 offset:32768
  v_mul_f32 v223, 0x3fb8aa3b, v222
  v_cvt_pk_bf16_f32 v209, v209, v210
  v_cndmask_b32 v10, v223, v222, s[52:53]
  v_mov_b32 v210, v208
  v_mov_b32 v211, v209
  s_waitcnt vmcnt(10)
  v_mfma_f32_32x32x16_bf16 v[136:151], v[28:31], v[188:191], v[136:151]
  ds_read_b128 v[188:191], v1 offset:4096
  s_add_u32 s56, s24, 12288
  buffer_load_dwordx4 v[72:75], v1, s[8:11], s56 offen offset:0 sc1
  s_waitcnt lgkmcnt(5)
  v_mfma_f32_32x32x16_bf16 v[152:167], v[28:31], v[200:203], v[152:167]
  ds_read_b128 v[200:203], v1 offset:33792
  s_barrier
  ds_write_b32 v5, v10
  ds_read_b128 v[240:243], v4 offset:128
  ds_read_b128 v[244:247], v4 offset:160
  s_waitcnt vmcnt(10)
  s_waitcnt lgkmcnt(8)
  v_mfma_f32_32x32x16_bf16 v[136:151], v[32:35], v[192:195], v[136:151]
  ds_read_b128 v[192:195], v1 offset:5120
  buffer_load_dwordx4 v[76:79], v1, s[8:11], s56 offen offset:1024 sc1
  ds_read_b128 v[248:251], v4 offset:192
  ds_read_b128 v[224:227], v4 offset:0
  s_waitcnt lgkmcnt(10)
  v_mfma_f32_32x32x16_bf16 v[152:167], v[32:35], v[204:207], v[152:167]
  ds_read_b128 v[204:207], v1 offset:34816
  s_add_u32 m0, s19, 54272
  s_add_u32 s57, s40, s19
  s_add_u32 s57, s57, 54272
  buffer_load_dwordx4 v1, s[8:11], s57 offen offset:0 sc1 lds
  s_waitcnt vmcnt(11)
  s_waitcnt lgkmcnt(10)
  v_mfma_f32_32x32x16_bf16 v[136:151], v[36:39], v[184:187], v[136:151]
  ds_read_b128 v[184:187], v1 offset:6144
  buffer_load_dwordx4 v[80:83], v1, s[8:11], s56 offen offset:2048 sc1
  ds_read_b128 v[228:231], v4 offset:32
  ds_read_b128 v[252:255], v4 offset:224
  s_waitcnt lgkmcnt(12)
  v_mfma_f32_32x32x16_bf16 v[152:167], v[36:39], v[196:199], v[152:167]
  ds_read_b128 v[196:199], v1 offset:35840
  buffer_load_dwordx4 v1, s[8:11], s57 offen offset:1024 sc1 lds
  ds_read_b128 v[232:235], v4 offset:64
  ds_read_b128 v[236:239], v4 offset:96
  s_waitcnt vmcnt(12)
  s_waitcnt lgkmcnt(14)
  v_mfma_f32_32x32x16_bf16 v[136:151], v[40:43], v[188:191], v[136:151]
  ds_read_b128 v[188:191], v1 offset:7168
  buffer_load_dwordx4 v[84:87], v1, s[8:11], s56 offen offset:3072 sc1
  s_waitcnt lgkmcnt(14)
  v_mfma_f32_32x32x16_bf16 v[152:167], v[40:43], v[200:203], v[152:167]
  ds_read_b128 v[200:203], v1 offset:36864
  s_waitcnt vmcnt(12)
  s_waitcnt lgkmcnt(11)
  v_mfma_f32_32x32x16_bf16 v[136:151], v[44:47], v[192:195], v[136:151]
  ds_read_b128 v[192:195], v1 offset:8192
  s_add_u32 s56, s24, 16384
  buffer_load_dwordx4 v[88:91], v1, s[8:11], s56 offen offset:0 sc1
  s_waitcnt lgkmcnt(9)
  v_mfma_f32_32x32x16_bf16 v[152:167], v[44:47], v[204:207], v[152:167]
  ds_read_b128 v[204:207], v1 offset:37888
  s_waitcnt vmcnt(12)
  s_waitcnt lgkmcnt(9)
  v_mfma_f32_32x32x16_bf16 v[136:151], v[48:51], v[184:187], v[136:151]
  ds_read_b128 v[184:187], v1 offset:9216
  buffer_load_dwordx4 v[92:95], v1, s[8:11], s56 offen offset:1024 sc1
  s_waitcnt lgkmcnt(7)
  v_mfma_f32_32x32x16_bf16 v[152:167], v[48:51], v[196:199], v[152:167]
  ds_read_b128 v[196:199], v1 offset:38912
  s_waitcnt vmcnt(12)
  s_waitcnt lgkmcnt(5)
  v_mfma_f32_32x32x16_bf16 v[136:151], v[52:55], v[188:191], v[136:151]
  ds_read_b128 v[188:191], v1 offset:10240
  buffer_load_dwordx4 v[96:99], v1, s[8:11], s56 offen offset:2048 sc1
  s_waitcnt lgkmcnt(5)
  v_mfma_f32_32x32x16_bf16 v[152:167], v[52:55], v[200:203], v[152:167]
  ds_read_b128 v[200:203], v1 offset:39936
  s_waitcnt vmcnt(12)
  s_waitcnt lgkmcnt(5)
  v_mfma_f32_32x32x16_bf16 v[136:151], v[56:59], v[192:195], v[136:151]
  ds_read_b128 v[192:195], v1 offset:11264
  buffer_load_dwordx4 v[100:103], v1, s[8:11], s56 offen offset:3072 sc1
  s_waitcnt lgkmcnt(5)
  v_mfma_f32_32x32x16_bf16 v[152:167], v[56:59], v[204:207], v[152:167]
  ds_read_b128 v[204:207], v1 offset:40960
  s_waitcnt vmcnt(12)
  s_waitcnt lgkmcnt(5)
  v_mfma_f32_32x32x16_bf16 v[136:151], v[60:63], v[184:187], v[136:151]
  ds_read_b128 v[184:187], v1 offset:12288
  s_add_u32 s56, s24, 20480
  buffer_load_dwordx4 v[104:107], v1, s[8:11], s56 offen offset:0 sc1
  s_waitcnt lgkmcnt(5)
  v_mfma_f32_32x32x16_bf16 v[152:167], v[60:63], v[196:199], v[152:167]
  ds_read_b128 v[196:199], v1 offset:41984
  s_waitcnt vmcnt(12)
  s_waitcnt lgkmcnt(5)
  v_mfma_f32_32x32x16_bf16 v[136:151], v[64:67], v[188:191], v[136:151]
  ds_read_b128 v[188:191], v1 offset:13312
  buffer_load_dwordx4 v[108:111], v1, s[8:11], s56 offen offset:1024 sc1
  s_waitcnt lgkmcnt(5)
  v_mfma_f32_32x32x16_bf16 v[152:167], v[64:67], v[200:203], v[152:167]
  ds_read_b128 v[200:203], v1 offset:43008
  s_waitcnt vmcnt(12)
  s_waitcnt lgkmcnt(5)
  v_mfma_f32_32x32x16_bf16 v[136:151], v[68:71], v[192:195], v[136:151]
  ds_read_b128 v[192:195], v1 offset:14336
  buffer_load_dwordx4 v[112:115], v1, s[8:11], s56 offen offset:2048 sc1
  s_waitcnt lgkmcnt(5)
  v_mfma_f32_32x32x16_bf16 v[152:167], v[68:71], v[204:207], v[152:167]
  ds_read_b128 v[204:207], v1 offset:44032
  s_waitcnt vmcnt(12)
  s_waitcnt lgkmcnt(5)
  v_mfma_f32_32x32x16_bf16 v[136:151], v[72:75], v[184:187], v[136:151]
  ds_read_b128 v[184:187], v1 offset:15360
  buffer_load_dwordx4 v[116:119], v1, s[8:11], s56 offen offset:3072 sc1
  s_waitcnt lgkmcnt(5)
  v_mfma_f32_32x32x16_bf16 v[152:167], v[72:75], v[196:199], v[152:167]
  ds_read_b128 v[196:199], v1 offset:45056
  s_waitcnt vmcnt(12)
  s_waitcnt lgkmcnt(5)
  v_mfma_f32_32x32x16_bf16 v[136:151], v[76:79], v[188:191], v[136:151]
  ds_read_b128 v[188:191], v1 offset:16384
  s_add_u32 s56, s24, 24576
  buffer_load_dwordx4 v[120:123], v1, s[8:11], s56 offen offset:0 sc1
  s_waitcnt lgkmcnt(5)
  v_mfma_f32_32x32x16_bf16 v[152:167], v[76:79], v[200:203], v[152:167]
  ds_read_b128 v[200:203], v1 offset:46080
  s_waitcnt vmcnt(11)
  s_waitcnt lgkmcnt(5)
  v_mfma_f32_32x32x16_bf16 v[136:151], v[80:83], v[192:195], v[136:151]
  ds_read_b128 v[192:195], v1 offset:17408
  buffer_load_dwordx4 v[124:127], v1, s[8:11], s56 offen offset:1024 sc1
  s_waitcnt lgkmcnt(5)
  v_mfma_f32_32x32x16_bf16 v[152:167], v[80:83], v[204:207], v[152:167]
  ds_read_b128 v[204:207], v1 offset:47104
  s_waitcnt vmcnt(10)
  s_waitcnt lgkmcnt(5)
  v_mfma_f32_32x32x16_bf16 v[136:151], v[84:87], v[184:187], v[136:151]
  ds_read_b128 v[184:187], v1 offset:18432
  buffer_load_dwordx4 v[128:131], v1, s[8:11], s56 offen offset:2048 sc1
  s_waitcnt lgkmcnt(5)
  v_mfma_f32_32x32x16_bf16 v[152:167], v[84:87], v[196:199], v[152:167]
  ds_read_b128 v[196:199], v1 offset:48128
  s_waitcnt vmcnt(10)
  s_waitcnt lgkmcnt(5)
  v_mfma_f32_32x32x16_bf16 v[136:151], v[88:91], v[188:191], v[136:151]
  ds_read_b128 v[188:191], v1 offset:19456
  buffer_load_dwordx4 v[132:135], v1, s[8:11], s56 offen offset:3072 sc1
  s_waitcnt lgkmcnt(5)
  v_mfma_f32_32x32x16_bf16 v[152:167], v[88:91], v[200:203], v[152:167]
  ds_read_b128 v[200:203], v1 offset:49152
  s_waitcnt vmcnt(10)
  s_waitcnt lgkmcnt(5)
  v_mfma_f32_32x32x16_bf16 v[136:151], v[92:95], v[192:195], v[136:151]
  ds_read_b128 v[192:195], v1 offset:20480
  s_add_u32 m0, s20, 74752
  s_add_u32 s57, s5, 59392
  buffer_load_dwordx4 v1, s[8:11], s57 offen offset:0 sc1 lds
  s_waitcnt lgkmcnt(5)
  v_mfma_f32_32x32x16_bf16 v[152:167], v[92:95], v[204:207], v[152:167]
  ds_read_b128 v[204:207], v1 offset:50176
  buffer_load_dwordx4 v1, s[8:11], s57 offen offset:1024 sc1 lds
  s_waitcnt vmcnt(11)
  s_waitcnt lgkmcnt(5)
  v_mfma_f32_32x32x16_bf16 v[136:151], v[96:99], v[184:187], v[136:151]
  ds_read_b128 v[184:187], v1 offset:21504
  s_waitcnt lgkmcnt(5)
  v_mfma_f32_32x32x16_bf16 v[152:167], v[96:99], v[196:199], v[152:167]
  ds_read_b128 v[196:199], v1 offset:51200
  s_barrier
  buffer_load_dwordx4 v1, s[8:11], s57 offen offset:2048 sc1 lds
  s_waitcnt vmcnt(11)
  s_waitcnt lgkmcnt(5)
  v_mfma_f32_32x32x16_bf16 v[136:151], v[100:103], v[188:191], v[136:151]
  ds_read_b128 v[188:191], v1 offset:22528
  buffer_load_dwordx4 v1, s[8:11], s57 offen offset:3072 sc1 lds
  s_waitcnt lgkmcnt(5)
  v_mfma_f32_32x32x16_bf16 v[152:167], v[100:103], v[200:203], v[152:167]
  ds_read_b128 v[200:203], v1 offset:52224
  s_waitcnt vmcnt(11)
  s_waitcnt lgkmcnt(5)
  v_mfma_f32_32x32x16_bf16 v[136:151], v[104:107], v[192:195], v[136:151]
  ds_read_b128 v[192:195], v1 offset:23552
  s_add_u32 m0, s20, 78848
  s_add_u32 s57, s5, 63488
  buffer_load_dwordx4 v1, s[8:11], s57 offen offset:0 sc1 lds
  s_waitcnt lgkmcnt(5)
  v_mfma_f32_32x32x16_bf16 v[152:167], v[104:107], v[204:207], v[152:167]
  ds_read_b128 v[204:207], v1 offset:53248
  buffer_load_dwordx4 v1, s[8:11], s57 offen offset:1024 sc1 lds
  s_waitcnt vmcnt(12)
  s_waitcnt lgkmcnt(5)
  v_mfma_f32_32x32x16_bf16 v[136:151], v[108:111], v[184:187], v[136:151]
  ds_read_b128 v[184:187], v1 offset:24576
  s_waitcnt lgkmcnt(5)
  v_mfma_f32_32x32x16_bf16 v[152:167], v[108:111], v[196:199], v[152:167]
  ds_read_b128 v[196:199], v1 offset:54272
  buffer_load_dwordx4 v1, s[8:11], s57 offen offset:2048 sc1 lds
  s_waitcnt vmcnt(12)
  s_waitcnt lgkmcnt(5)
  v_mfma_f32_32x32x16_bf16 v[136:151], v[112:115], v[188:191], v[136:151]
  ds_read_b128 v[188:191], v1 offset:25600
  buffer_load_dwordx4 v1, s[8:11], s57 offen offset:3072 sc1 lds
  s_waitcnt lgkmcnt(5)
  v_mfma_f32_32x32x16_bf16 v[152:167], v[112:115], v[200:203], v[152:167]
  ds_read_b128 v[200:203], v1 offset:55296
  s_waitcnt vmcnt(12)
  s_waitcnt lgkmcnt(5)
  v_mfma_f32_32x32x16_bf16 v[136:151], v[116:119], v[192:195], v[136:151]
  ds_read_b128 v[192:195], v1 offset:26624
  s_waitcnt lgkmcnt(5)
  v_mfma_f32_32x32x16_bf16 v[152:167], v[116:119], v[204:207], v[152:167]
  ds_read_b128 v[204:207], v1 offset:56320
  s_waitcnt vmcnt(11)
  s_waitcnt lgkmcnt(5)
  v_mfma_f32_32x32x16_bf16 v[136:151], v[120:123], v[184:187], v[136:151]
  ds_read_b128 v[184:187], v1 offset:27648
  s_waitcnt lgkmcnt(5)
  v_mfma_f32_32x32x16_bf16 v[152:167], v[120:123], v[196:199], v[152:167]
  ds_read_b128 v[196:199], v1 offset:57344
  s_waitcnt vmcnt(10)
  s_waitcnt lgkmcnt(5)
  v_mfma_f32_32x32x16_bf16 v[136:151], v[124:127], v[188:191], v[136:151]
  ds_read_b128 v[188:191], v1 offset:28672
  s_waitcnt lgkmcnt(5)
  v_mfma_f32_32x32x16_bf16 v[152:167], v[124:127], v[200:203], v[152:167]
  ds_read_b128 v[200:203], v1 offset:58368
  s_waitcnt vmcnt(9)
  s_waitcnt lgkmcnt(5)
  v_mfma_f32_32x32x16_bf16 v[136:151], v[128:131], v[192:195], v[136:151]
  s_waitcnt lgkmcnt(4)
  v_mfma_f32_32x32x16_bf16 v[152:167], v[128:131], v[204:207], v[152:167]
  s_and_b32 s6, s17, 3
  s_lshl_b32 s6, s6, 2
  s_add_u32 s6, s6, s16
  s_lshl_b32 s6, s6, 10
  s_add_u32 s6, s6, M_wo1-M_start
  s_min_u32 s6, s6, M_last-M_start-1024
  buffer_load_dword v11, v1, s[96:99], s6 offen
  s_waitcnt vmcnt(9)
  s_waitcnt lgkmcnt(3)
  v_mfma_f32_32x32x16_bf16 v[136:151], v[132:135], v[184:187], v[136:151]
  s_waitcnt lgkmcnt(1)
  v_mfma_f32_32x32x16_bf16 v[136:151], v[208:211], v[188:191], v[136:151]
  v_mfma_f32_32x32x16_bf16 v[152:167], v[132:135], v[196:199], v[152:167]
  s_waitcnt lgkmcnt(0)
  v_mfma_f32_32x32x16_bf16 v[152:167], v[208:211], v[200:203], v[152:167]
  s_waitcnt vmcnt(1)
  s_barrier
  s_barrier
  ds_read_b128 v[192:195], v12 offset:9216
  ds_read_b128 v[204:207], v12 offset:10240
  ds_read_b128 v[184:187], v12 offset:11264
  ds_read_b128 v[196:199], v12 offset:12288
  ds_read_b128 v[188:191], v12 offset:13312
  ds_read_b128 v[200:203], v12 offset:14336
  s_nop 0
  v_mul_f32 v136, v136, v240
  v_mul_f32 v137, v137, v241
  v_mul_f32 v138, v138, v242
  v_mul_f32 v139, v139, v243
  v_exp_f32 v212, v136 clamp
  v_max_f32 v213, 0, v136
  v_exp_f32 v214, v137 clamp
  v_max_f32 v215, 0, v137
  v_exp_f32 v216, v138 clamp
  v_max_f32 v217, 0, v138
  v_exp_f32 v218, v139 clamp
  v_max_f32 v219, 0, v139
  v_fma_f32 v213, v213, s23, v14
  v_fma_f32 v215, v215, s23, v14
  v_fma_f32 v217, v217, s23, v14
  v_fma_f32 v219, v219, s23, v14
  v_mul_f32 v140, v140, v244
  v_mul_f32 v141, v141, v245
  v_mul_f32 v142, v142, v246
  s_waitcnt lgkmcnt(5)
  v_mfma_f32_32x32x16_bf16 v[168:183], v[192:195], v[24:27], 0
  ds_read_b128 v[192:195], v12 offset:15360
  v_mul_f32 v143, v143, v247
  v_add_f32 v136, v213, v212
  v_add_f32 v137, v215, v214
  v_add_f32 v138, v217, v216
  v_add_f32 v139, v219, v218
  v_exp_f32 v212, v140 clamp
  v_max_f32 v213, 0, v140
  v_exp_f32 v214, v141 clamp
  v_max_f32 v215, 0, v141
  v_exp_f32 v216, v142 clamp
  v_max_f32 v217, 0, v142
  v_exp_f32 v218, v143 clamp
  v_max_f32 v219, 0, v143
  v_fma_f32 v213, v213, s23, v14
  v_fma_f32 v215, v215, s23, v14
  v_fma_f32 v217, v217, s23, v14
  v_fma_f32 v219, v219, s23, v14
  s_waitcnt lgkmcnt(5)
  v_mfma_f32_32x32x16_bf16 v[168:183], v[204:207], v[28:31], v[168:183]
  ds_read_b128 v[204:207], v12 offset:16384
  v_mul_f32 v144, v144, v248
  v_mul_f32 v145, v145, v249
  v_mul_f32 v146, v146, v250
  v_mul_f32 v147, v147, v251
  v_add_f32 v140, v213, v212
  v_add_f32 v141, v215, v214
  v_add_f32 v142, v217, v216
  v_add_f32 v143, v219, v218
  v_mul_f32 v152, v152, v224
  v_mul_f32 v153, v153, v225
  v_exp_f32 v212, v144 clamp
  v_max_f32 v213, 0, v144
  v_exp_f32 v214, v145 clamp
  v_max_f32 v215, 0, v145
  v_exp_f32 v216, v146 clamp
  v_max_f32 v217, 0, v146
  v_exp_f32 v218, v147 clamp
  s_waitcnt lgkmcnt(5)
  v_mfma_f32_32x32x16_bf16 v[168:183], v[184:187], v[32:35], v[168:183]
  ds_read_b128 v[184:187], v12 offset:17408
  v_max_f32 v219, 0, v147
  v_mul_f32 v154, v154, v226
  v_mul_f32 v155, v155, v227
  v_cvt_pk_bf16_f32 v136, v136, v137
  v_mul_f32 v156, v156, v228
  v_mul_f32 v157, v157, v229
  v_mul_f32 v158, v158, v230
  v_mul_f32 v159, v159, v231
  v_cvt_pk_bf16_f32 v152, v152, v153
  v_fma_f32 v213, v213, s23, v14
  v_fma_f32 v215, v215, s23, v14
  v_fma_f32 v217, v217, s23, v14
  v_fma_f32 v219, v219, s23, v14
  v_cvt_pk_bf16_f32 v137, v138, v139
  v_cvt_pk_bf16_f32 v153, v154, v155
  v_mul_f32 v148, v148, v252
  v_mul_f32 v149, v149, v253
  v_mul_f32 v150, v150, v254
  v_mul_f32 v151, v151, v255
  v_cvt_pk_bf16_f32 v138, v140, v141
  v_cvt_pk_bf16_f32 v139, v142, v143
  s_waitcnt lgkmcnt(5)
  v_mfma_f32_32x32x16_bf16 v[168:183], v[196:199], v[36:39], v[168:183]
  ds_read_b128 v[196:199], v12 offset:18432
  s_xor_b32 s7, s30, 0
  buffer_load_dwordx4 v[24:27], v1, s[8:11], s7 offen offset:0 sc1
  v_cvt_pk_bf16_f32 v154, v156, v157
  v_cvt_pk_bf16_f32 v155, v158, v159
  v_add_f32 v144, v213, v212
  v_add_f32 v145, v215, v214
  v_add_f32 v146, v217, v216
  v_add_f32 v147, v219, v218
  v_exp_f32 v212, v148 clamp
  v_max_f32 v213, 0, v148
  v_exp_f32 v214, v149 clamp
  v_max_f32 v215, 0, v149
  v_exp_f32 v216, v150 clamp
  v_max_f32 v217, 0, v150
  v_exp_f32 v218, v151 clamp
  s_waitcnt lgkmcnt(5)
  v_mfma_f32_32x32x16_bf16 v[168:183], v[188:191], v[40:43], v[168:183]
  ds_read_b128 v[188:191], v12 offset:19456
  v_max_f32 v219, 0, v151
  v_cndmask_b32 v136, 0, v136, s[48:49]
  v_cndmask_b32 v137, 0, v137, s[48:49]
  v_cndmask_b32 v138, 0, v138, s[48:49]
  v_cndmask_b32 v139, 0, v139, s[48:49]
  v_cndmask_b32 v152, v152, v15, s[50:51]
  v_cndmask_b32 v153, v153, v15, s[50:51]
  v_cndmask_b32 v154, v154, v15, s[50:51]
  v_cndmask_b32 v155, v155, v15, s[50:51]
  v_fma_f32 v213, v213, s23, v14
  v_fma_f32 v215, v215, s23, v14
  v_mfma_f32_32x32x16_bf16 v[240:255], v[136:139], v[152:155], 0
  s_xor_b32 s7, s30, 0
  buffer_load_dwordx4 v[28:31], v1, s[8:11], s7 offen offset:1024 sc1
  v_fma_f32 v217, v217, s23, v14
  v_fma_f32 v219, v219, s23, v14
  v_add_f32 v148, v213, v212
  v_add_f32 v149, v215, v214
  v_add_f32 v150, v217, v216
  v_add_f32 v151, v219, v218
  v_mul_f32 v160, v160, v232
  v_mul_f32 v161, v161, v233
  v_mul_f32 v162, v162, v234
  v_mul_f32 v163, v163, v235
  v_mul_f32 v164, v164, v236
  v_mul_f32 v165, v165, v237
  v_mul_f32 v166, v166, v238
  v_mul_f32 v167, v167, v239
  v_cvt_pk_bf16_f32 v140, v144, v145
  v_cvt_pk_bf16_f32 v141, v146, v147
  v_cvt_pk_bf16_f32 v142, v148, v149
  v_cvt_pk_bf16_f32 v143, v150, v151
  s_waitcnt lgkmcnt(5)
  v_mfma_f32_32x32x16_bf16 v[168:183], v[200:203], v[44:47], v[168:183]
  ds_read_b128 v[200:203], v12 offset:20480
  v_cvt_pk_bf16_f32 v156, v160, v161
  v_cvt_pk_bf16_f32 v157, v162, v163
  v_cvt_pk_bf16_f32 v158, v164, v165
  v_cvt_pk_bf16_f32 v159, v166, v167
  v_cndmask_b32 v140, 0, v140, s[48:49]
  v_cndmask_b32 v141, 0, v141, s[48:49]
  v_cndmask_b32 v142, 0, v142, s[48:49]
  v_cndmask_b32 v143, 0, v143, s[48:49]
  v_cndmask_b32 v156, v156, v15, s[50:51]
  v_cndmask_b32 v157, v157, v15, s[50:51]
  v_cndmask_b32 v158, v158, v15, s[50:51]
  v_cndmask_b32 v159, v159, v15, s[50:51]
  s_waitcnt lgkmcnt(5)
  v_mfma_f32_32x32x16_bf16 v[168:183], v[192:195], v[48:51], v[168:183]
  ds_read_b128 v[192:195], v12 offset:21504
  s_xor_b32 s7, s30, 0
  buffer_load_dwordx4 v[32:35], v1, s[8:11], s7 offen offset:2048 sc1
  v_mfma_f32_32x32x16_bf16 v[240:255], v[140:143], v[156:159], v[240:255]
  s_waitcnt lgkmcnt(5)
  v_mfma_f32_32x32x16_bf16 v[168:183], v[204:207], v[52:55], v[168:183]
  ds_read_b128 v[204:207], v12 offset:22528
  s_xor_b32 s7, s30, 0
  buffer_load_dwordx4 v[36:39], v1, s[8:11], s7 offen offset:3072 sc1
  s_waitcnt lgkmcnt(5)
  v_mfma_f32_32x32x16_bf16 v[168:183], v[184:187], v[56:59], v[168:183]
  s_nop 5
  ds_write_b128 v7, v[240:243] offset:0
  ds_read_b128 v[184:187], v12 offset:23552
  s_waitcnt lgkmcnt(6)
  v_mfma_f32_32x32x16_bf16 v[168:183], v[196:199], v[60:63], v[168:183]
  ds_read_b128 v[196:199], v12 offset:24576
  s_xor_b32 s7, s30, 4096
  buffer_load_dwordx4 v[40:43], v1, s[8:11], s7 offen offset:0 sc1
  ds_write_b128 v7, v[244:247] offset:1024
  s_waitcnt lgkmcnt(7)
  v_mfma_f32_32x32x16_bf16 v[168:183], v[188:191], v[64:67], v[168:183]
  ds_read_b128 v[188:191], v12 offset:25600
  s_waitcnt lgkmcnt(7)
  v_mfma_f32_32x32x16_bf16 v[168:183], v[200:203], v[68:71], v[168:183]
  ds_read_b128 v[200:203], v12 offset:26624
  s_xor_b32 s7, s30, 4096
  buffer_load_dwordx4 v[44:47], v1, s[8:11], s7 offen offset:1024 sc1
  ds_write_b128 v7, v[248:251] offset:2048
  s_waitcnt lgkmcnt(8)
  v_mfma_f32_32x32x16_bf16 v[168:183], v[192:195], v[72:75], v[168:183]
  ds_read_b128 v[192:195], v12 offset:27648
  s_waitcnt lgkmcnt(8)
  v_mfma_f32_32x32x16_bf16 v[168:183], v[204:207], v[76:79], v[168:183]
  ds_read_b128 v[204:207], v12 offset:28672
  s_xor_b32 s7, s30, 4096
  buffer_load_dwordx4 v[48:51], v1, s[8:11], s7 offen offset:2048 sc1
  ds_write_b128 v7, v[252:255] offset:3072
  s_waitcnt lgkmcnt(8)
  v_mfma_f32_32x32x16_bf16 v[168:183], v[184:187], v[80:83], v[168:183]
  ds_read_b128 v[184:187], v12 offset:29696
  s_waitcnt lgkmcnt(8)
  v_mfma_f32_32x32x16_bf16 v[168:183], v[196:199], v[84:87], v[168:183]
  ds_read_b128 v[196:199], v12 offset:30720
  s_xor_b32 s7, s30, 4096
  buffer_load_dwordx4 v[52:55], v1, s[8:11], s7 offen offset:3072 sc1
  s_waitcnt lgkmcnt(7)
  v_mfma_f32_32x32x16_bf16 v[168:183], v[188:191], v[88:91], v[168:183]
  s_waitcnt lgkmcnt(2)
  s_barrier
  ds_read_b32 v224, v8 offset:0
  ds_read_b32 v225, v8 offset:4096
  ds_read_b32 v226, v8 offset:8192
  ds_read_b32 v227, v8 offset:12288
  ds_read_b32 v228, v8 offset:256
  v_mfma_f32_32x32x16_bf16 v[168:183], v[200:203], v[92:95], v[168:183]
  ds_read_b32 v229, v8 offset:4352
  ds_read_b32 v230, v8 offset:8448
  ds_read_b32 v231, v8 offset:12544
  ds_read_b32 v232, v8 offset:512
  ds_read_b32 v233, v8 offset:4608
  ds_read_b32 v234, v8 offset:8704
  v_mfma_f32_32x32x16_bf16 v[168:183], v[192:195], v[96:99], v[168:183]
  ds_read_b32 v235, v8 offset:12800
  ds_read_b32 v236, v8 offset:768
  ds_read_b32 v237, v8 offset:4864
  ds_read_b32 v238, v8 offset:8960
  ds_read_b32 v239, v8 offset:13056
  ds_read_b128 v[188:191], v12 offset:31744
  v_mfma_f32_32x32x16_bf16 v[168:183], v[204:207], v[100:103], v[168:183]
  ds_read_b128 v[200:203], v12 offset:32768
  ds_read_b128 v[192:195], v12 offset:33792
  ds_read_b128 v[204:207], v12 offset:34816
  s_waitcnt lgkmcnt(15)
  v_mfma_f32_32x32x16_bf16 v[168:183], v[184:187], v[104:107], v[168:183]
  ds_read_b128 v[184:187], v12 offset:35840
  v_add_f32 v224, v224, v225
  v_add_f32 v226, v226, v227
  v_add_f32 v224, v224, v226
  s_waitcnt lgkmcnt(15)
  v_add_f32 v228, v228, v229
  v_mfma_f32_32x32x16_bf16 v[168:183], v[196:199], v[108:111], v[168:183]
  buffer_atomic_add_f32 v224, v2, s[8:11], s59 offen offset:0
  ds_read_b128 v[196:199], v12 offset:36864
  s_waitcnt lgkmcnt(14)
  v_add_f32 v230, v230, v231
  s_waitcnt lgkmcnt(12)
  v_add_f32 v232, v232, v233
  s_waitcnt lgkmcnt(10)
  v_add_f32 v234, v234, v235
  v_add_f32 v228, v228, v230
  s_waitcnt lgkmcnt(8)
  v_add_f32 v236, v236, v237
  v_add_f32 v232, v232, v234
  s_waitcnt lgkmcnt(6)
  v_add_f32 v238, v238, v239
  s_waitcnt lgkmcnt(5)
  v_mfma_f32_32x32x16_bf16 v[168:183], v[188:191], v[112:115], v[168:183]
  buffer_atomic_add_f32 v228, v2, s[8:11], s59 offen offset:256
  buffer_atomic_add_f32 v232, v2, s[8:11], s59 offen offset:512
  ds_read_b128 v[188:191], v12 offset:37888
  v_add_f32 v236, v236, v238
  s_waitcnt lgkmcnt(5)
  v_mfma_f32_32x32x16_bf16 v[168:183], v[200:203], v[116:119], v[168:183]
  buffer_atomic_add_f32 v236, v2, s[8:11], s59 offen offset:768
  s_waitcnt lgkmcnt(4)
  v_mfma_f32_32x32x16_bf16 v[168:183], v[192:195], v[120:123], v[168:183]
  s_waitcnt lgkmcnt(3)
  v_mfma_f32_32x32x16_bf16 v[168:183], v[204:207], v[124:127], v[168:183]
  s_waitcnt lgkmcnt(2)
  v_mfma_f32_32x32x16_bf16 v[168:183], v[184:187], v[128:131], v[168:183]
  s_waitcnt lgkmcnt(1)
  v_mfma_f32_32x32x16_bf16 v[168:183], v[196:199], v[132:135], v[168:183]
  s_waitcnt lgkmcnt(0)
  v_mfma_f32_32x32x16_bf16 v[168:183], v[188:191], v[208:211], v[168:183]
  s_nop 7
  s_nop 4
  v_mul_f32 v168, v168, v223
  v_mul_f32 v169, v169, v223
  v_mul_f32 v170, v170, v223
  v_mul_f32 v171, v171, v223
  v_exp_f32 v212, v168 clamp
  v_max_f32 v213, 0, v168
  v_exp_f32 v214, v169 clamp
  v_max_f32 v215, 0, v169
  v_exp_f32 v216, v170 clamp
  v_max_f32 v217, 0, v170
  v_exp_f32 v218, v171 clamp
  v_max_f32 v219, 0, v171
  v_fma_f32 v213, v213, s23, v14
  v_fma_f32 v215, v215, s23, v14
  v_fma_f32 v217, v217, s23, v14
  v_fma_f32 v219, v219, s23, v14
  v_mul_f32 v172, v172, v223
  v_mul_f32 v173, v173, v223
  v_mul_f32 v174, v174, v223
  v_mul_f32 v175, v175, v223
  v_add_f32 v168, v213, v212
  v_add_f32 v169, v215, v214
  v_add_f32 v170, v217, v216
  v_add_f32 v171, v219, v218
  v_exp_f32 v212, v172 clamp
  v_max_f32 v213, 0, v172
  v_exp_f32 v214, v173 clamp
  v_max_f32 v215, 0, v173
  v_exp_f32 v216, v174 clamp
  v_max_f32 v217, 0, v174
  v_exp_f32 v218, v175 clamp
  v_max_f32 v219, 0, v175
  v_fma_f32 v213, v213, s23, v14
  v_fma_f32 v215, v215, s23, v14
  v_fma_f32 v217, v217, s23, v14
  v_fma_f32 v219, v219, s23, v14
  v_mul_f32 v176, v176, v223
  v_mul_f32 v177, v177, v223
  v_mul_f32 v178, v178, v223
  v_mul_f32 v179, v179, v223
  v_add_f32 v172, v213, v212
  v_add_f32 v173, v215, v214
  v_add_f32 v174, v217, v216
  v_add_f32 v175, v219, v218
  v_exp_f32 v212, v176 clamp
  v_max_f32 v213, 0, v176
  v_exp_f32 v214, v177 clamp
  v_max_f32 v215, 0, v177
  v_exp_f32 v216, v178 clamp
  v_max_f32 v217, 0, v178
  v_exp_f32 v218, v179 clamp
  v_max_f32 v219, 0, v179
  v_fma_f32 v213, v213, s23, v14
  v_fma_f32 v215, v215, s23, v14
  v_fma_f32 v217, v217, s23, v14
  v_fma_f32 v219, v219, s23, v14
  v_mul_f32 v180, v180, v223
  v_mul_f32 v181, v181, v223
  v_mul_f32 v182, v182, v223
  v_mul_f32 v183, v183, v223
  v_add_f32 v176, v213, v212
  v_add_f32 v177, v215, v214
  v_add_f32 v178, v217, v216
  v_add_f32 v179, v219, v218
  v_exp_f32 v212, v180 clamp
  v_max_f32 v213, 0, v180
  v_exp_f32 v214, v181 clamp
  v_max_f32 v215, 0, v181
  v_exp_f32 v216, v182 clamp
  v_max_f32 v217, 0, v182
  v_exp_f32 v218, v183 clamp
  v_max_f32 v219, 0, v183
  v_fma_f32 v213, v213, s23, v14
  v_fma_f32 v215, v215, s23, v14
  v_fma_f32 v217, v217, s23, v14
  v_fma_f32 v219, v219, s23, v14
  v_cvt_pk_bf16_f32 v168, v168, v169
  v_add_f32 v180, v213, v212
  v_add_f32 v181, v215, v214
  v_add_f32 v182, v217, v216
  v_add_f32 v183, v219, v218
  v_cvt_pk_bf16_f32 v169, v170, v171
  v_cvt_pk_bf16_f32 v170, v172, v173
  v_cvt_pk_bf16_f32 v171, v174, v175
  v_cvt_pk_bf16_f32 v172, v176, v177
  v_cvt_pk_bf16_f32 v173, v178, v179
  v_cvt_pk_bf16_f32 v174, v180, v181
  v_cvt_pk_bf16_f32 v175, v182, v183
  buffer_store_dwordx4 v[168:171], v1, s[8:11], s26 offen offset:0 sc1
  buffer_store_dwordx4 v[172:175], v1, s[8:11], s26 offen offset:1024 sc1
  s_waitcnt vmcnt(2)
  s_barrier
  s_lshr_b32 s6, s17, 3
  s_mul_i32 s6, s6, 14336
  s_and_b32 s3, s17, 7
  s_lshl_b32 s3, s3, 7
  s_add_u32 s6, s6, s3
  s_lshl_b32 s3, s45, 2
  s_add_u32 s6, s6, s3
  s_add_u32 s6, s6, 19131392
  buffer_store_dword v9, v6, s[8:11], s6 offen sc1
  s_waitcnt vmcnt(1)
  s_barrier
  s_cmp_lg_u32 s16, 0
  s_cbranch_scc1 M_nofl1
  s_cbranch_vccz Lpub_41
  s_mov_b64 exec, 1
  buffer_store_dword v15, v2, s[8:11], s28 offen offset:384
  s_mov_b64 exec, -1
Lpubr_42:
M_nofl1:
  v_mov_b32 v10, 1
  s_cmp_ge_u32 s17, 28
  s_cbranch_scc1 M_sp1
M_wo1:
  s_cmp_ge_u32 s17, 14
  s_cselect_b32 s58, 16, 0
  buffer_load_dword v6, v0, s[8:11], s29 offen offset:384 sc1
  s_xor_b32 s6, s16, 1
  s_mul_i32 s6, s6, 12288
  s_add_u32 s6, s6, 25600
  v_add_u32 v249, s6, v1
  s_xor_b32 s6, s16, 2
  s_mul_i32 s6, s6, 12288
  s_add_u32 s6, s6, 29696
  v_add_u32 v250, s6, v1
  s_xor_b32 s6, s16, 3
  s_mul_i32 s6, s6, 12288
  s_add_u32 s6, s6, 33792
  v_add_u32 v251, s6, v1
  s_mul_i32 s6, s16, 12288
  s_add_u32 s6, s6, 25600
  v_add_u32 v248, s6, v1
  v_and_b32 v11, 0x1c, v2
  s_mov_b32 s7, 18902144
  v_lshrrev_b32 v11, 5, v0
  v_mul_u32_u24 v11, 14336, v11
  v_and_b32 v7, 0x1c, v0
  v_lshl_add_u32 v11, v7, 5, v11
  v_lshrrev_b32 v7, 3, v2
  v_and_or_b32 v11, v7, 16, v11
  s_min_u32 s7, s16, 1
  s_lshl_b32 s7, s7, 30
  v_or_b32 v11, s7, v11
  s_mov_b32 s7, 19131392
  s_waitcnt vmcnt(0)
  v_cmp_ne_u32 s[54:55], 0, v6
  s_nop 0
  s_lshr_b32 s56, s54, s58
  s_and_b32 s56, s56, 0xffff
  s_cmp_eq_u32 s56, 0xffff
  s_cbranch_scc1 M_pqok1
  s_mov_b32 s46, 0
Lpoll_43:
  buffer_load_dword v6, v0, s[8:11], s29 offen offset:384 sc1
  s_add_u32 s46, s46, 1
  s_waitcnt vmcnt(0)
  v_cmp_ne_u32 s[54:55], 0, v6
  s_cmp_gt_u32 s46, 300000
  s_cbranch_scc1 Lpd_44
  s_lshr_b32 s56, s54, s58
  s_and_b32 s56, s56, 0xffff
  s_cmp_eq_u32 s56, 0xffff
  s_cbranch_scc0 Lpoll_43
Lpd_44:
M_pqok1:
  s_cbranch_vccz Lacq_45
Lacqr_46:
  s_xor_b32 s59, s32, 32768
  buffer_load_dwordx4 v[120:123], v1, s[8:11], s59 offen offset:0 sc1
  buffer_load_dwordx4 v[124:127], v1, s[8:11], s59 offen offset:1024 sc1
  buffer_load_dwordx4 v[128:131], v1, s[8:11], s59 offen offset:2048 sc1
  buffer_load_dwordx4 v[132:135], v1, s[8:11], s59 offen offset:3072 sc1
  buffer_load_dwordx4 v[6:9], v11, s[8:11], s7 offen sc1
  s_xor_b32 s59, s32, 36864
  buffer_load_dwordx4 v[136:139], v1, s[8:11], s59 offen offset:0 sc1
  buffer_load_dwordx4 v[140:143], v1, s[8:11], s59 offen offset:1024 sc1
  buffer_load_dwordx4 v[144:147], v1, s[8:11], s59 offen offset:2048 sc1
  buffer_load_dwordx4 v[148:151], v1, s[8:11], s59 offen offset:3072 sc1
  s_xor_b32 s59, s32, 0
  buffer_load_dwordx4 v[152:155], v1, s[8:11], s59 offen offset:0 sc1
  buffer_load_dwordx4 v[156:159], v1, s[8:11], s59 offen offset:1024 sc1
  buffer_load_dwordx4 v[160:163], v1, s[8:11], s59 offen offset:2048 sc1
  buffer_load_dwordx4 v[164:167], v1, s[8:11], s59 offen offset:3072 sc1
  s_cmp_lg_u32 s16, 0
  s_cbranch_scc1 M_kvok1
  s_waitcnt vmcnt(8)
  v_min3_u32 v6, v6, v7, v8
  v_min_u32 v6, v6, v9
  v_cmp_ne_u32 s[54:55], 0, v6
  s_nop 0
  s_cmp_eq_u64 s[54:55], exec
  s_cbranch_scc1 M_kvok1
  s_mov_b32 s46, 0
Lpoll_47:
  buffer_load_dwordx4 v[6:9], v11, s[8:11], s7 offen sc1
  s_add_u32 s46, s46, 1
  s_waitcnt vmcnt(0)
  v_min3_u32 v6, v6, v7, v8
  v_min_u32 v6, v6, v9
  v_cmp_ne_u32 s[54:55], 0, v6
  s_cmp_gt_u32 s46, 300000
  s_cbranch_scc1 Lpd_48
  s_cmp_eq_u64 s[54:55], exec
  s_cbranch_scc0 Lpoll_47
Lpd_48:
M_kvok1:
  s_barrier
  s_add_u32 s58, s31, 65536
  buffer_load_dwordx4 v[56:59], v1, s[8:11], s58 offen offset:0 sc1
  buffer_load_dwordx4 v[60:63], v1, s[8:11], s58 offen offset:1024 sc1
  buffer_load_dwordx4 v[64:67], v1, s[8:11], s58 offen offset:2048 sc1
  buffer_load_dwordx4 v[68:71], v1, s[8:11], s58 offen offset:3072 sc1
  s_add_u32 s58, s31, 69632
  buffer_load_dwordx4 v[72:75], v1, s[8:11], s58 offen offset:0 sc1
  buffer_load_dwordx4 v[76:79], v1, s[8:11], s58 offen offset:1024 sc1
  buffer_load_dwordx4 v[80:83], v1, s[8:11], s58 offen offset:2048 sc1
  buffer_load_dwordx4 v[84:87], v1, s[8:11], s58 offen offset:3072 sc1
  s_add_u32 s58, s31, 73728
  buffer_load_dwordx4 v[88:91], v1, s[8:11], s58 offen offset:0 sc1
  buffer_load_dwordx4 v[92:95], v1, s[8:11], s58 offen offset:1024 sc1
  buffer_load_dwordx4 v[96:99], v1, s[8:11], s58 offen offset:2048 sc1
  buffer_load_dwordx4 v[100:103], v1, s[8:11], s58 offen offset:3072 sc1
  s_add_u32 s58, s31, 77824
  buffer_load_dwordx4 v[104:107], v1, s[8:11], s58 offen offset:0 sc1
  s_waitcnt vmcnt(12)
  v_cvt_pk_bf16_f32 v56, v56, v57
  v_cvt_pk_bf16_f32 v57, v58, v59
  buffer_load_dwordx4 v[108:111], v1, s[8:11], s58 offen offset:1024 sc1
  s_waitcnt vmcnt(12)
  v_cvt_pk_bf16_f32 v58, v60, v61
  v_cvt_pk_bf16_f32 v59, v62, v63
  s_nop 1
  v_mfma_f32_32x32x16_bf16 v[184:199], v[56:59], v[120:123], 0
  buffer_load_dwordx4 v[112:115], v1, s[8:11], s58 offen offset:2048 sc1
  s_waitcnt vmcnt(12)
  v_cvt_pk_bf16_f32 v60, v64, v65
  v_cvt_pk_bf16_f32 v61, v66, v67
  buffer_load_dwordx4 v[116:119], v1, s[8:11], s58 offen offset:3072 sc1
  s_waitcnt vmcnt(12)
  v_cvt_pk_bf16_f32 v62, v68, v69
  v_cvt_pk_bf16_f32 v63, v70, v71
  s_nop 1
  v_mfma_f32_32x32x16_bf16 v[184:199], v[60:63], v[124:127], v[184:199]
  s_xor_b32 s59, s32, 4096
  buffer_load_dwordx4 v[168:171], v1, s[8:11], s59 offen offset:0 sc1
  s_waitcnt vmcnt(12)
  v_cvt_pk_bf16_f32 v64, v72, v73
  v_cvt_pk_bf16_f32 v65, v74, v75
  s_nop 7
  v_add_f32 v252, v14, v196
  v_rcp_f32 v252, v252
  buffer_load_dwordx4 v[172:175], v1, s[8:11], s59 offen offset:1024 sc1
  s_waitcnt vmcnt(12)
  v_cvt_pk_bf16_f32 v66, v76, v77
  v_cvt_pk_bf16_f32 v67, v78, v79
  v_mov_b32 v253, v252
  s_nop 0
  v_mfma_f32_32x32x16_bf16 v[200:215], v[64:67], v[128:131], 0
  v_permlane32_swap_b32 v252, v253
  v_mul_f32 v184, v184, v253
  v_mul_f32 v185, v185, v253
  v_mul_f32 v186, v186, v253
  buffer_load_dwordx4 v[176:179], v1, s[8:11], s59 offen offset:2048 sc1
  s_waitcnt vmcnt(12)
  v_cvt_pk_bf16_f32 v68, v80, v81
  v_cvt_pk_bf16_f32 v69, v82, v83
  v_mul_f32 v187, v187, v253
  v_mul_f32 v188, v188, v253
  v_mul_f32 v189, v189, v253
  v_mul_f32 v190, v190, v253
  v_mul_f32 v191, v191, v253
  v_mul_f32 v192, v192, v253
  v_mul_f32 v193, v193, v253
  v_mul_f32 v194, v194, v253
  v_mul_f32 v195, v195, v253
  buffer_load_dwordx4 v[180:183], v1, s[8:11], s59 offen offset:3072 sc1
  s_waitcnt vmcnt(12)
  v_cvt_pk_bf16_f32 v70, v84, v85
  v_cvt_pk_bf16_f32 v71, v86, v87
  v_mul_f32 v196, v196, v253
  v_mul_f32 v197, v197, v253
  v_mfma_f32_32x32x16_bf16 v[200:215], v[68:71], v[132:135], v[200:215]
  v_mul_f32 v198, v198, v253
  v_mul_f32 v199, v199, v253
  v_cvt_pk_bf16_f32 v120, v184, v185
  v_cvt_pk_bf16_f32 v121, v186, v187
  v_cvt_pk_bf16_f32 v122, v188, v189
  s_waitcnt vmcnt(11)
  v_cvt_pk_bf16_f32 v72, v88, v89
  v_cvt_pk_bf16_f32 v73, v90, v91
  v_cvt_pk_bf16_f32 v123, v190, v191
  v_cvt_pk_bf16_f32 v124, v192, v193
  v_cvt_pk_bf16_f32 v125, v194, v195
  v_mfma_f32_32x32x16_bf16 v[216:231], v[24:27], v[120:123], 0
  v_cvt_pk_bf16_f32 v126, v196, v197
  v_cvt_pk_bf16_f32 v127, v198, v199
  v_lshlrev_b32 v88, 16, v16
  v_add_f32 v254, v14, v212
  v_and_b32 v89, 0xffff0000, v16
  v_rcp_f32 v254, v254
  v_mfma_f32_32x32x16_bf16 v[232:247], a[224:227], v[120:123], 0
  s_add_u32 m0, s20, 74752
  s_add_u32 s57, s4, 118784
  buffer_load_dwordx4 v1, s[8:11], s57 offen offset:0 sc1 lds
  s_waitcnt vmcnt(11)
  v_cvt_pk_bf16_f32 v74, v92, v93
  v_cvt_pk_bf16_f32 v75, v94, v95
  v_mov_b32 v255, v254
  v_mfma_f32_32x32x16_bf16 v[216:231], v[28:31], v[124:127], v[216:231]
  v_lshlrev_b32 v90, 16, v17
  v_permlane32_swap_b32 v254, v255
  v_and_b32 v91, 0xffff0000, v17
  v_mul_f32 v200, v200, v255
  v_mul_f32 v201, v201, v255
  v_mul_f32 v202, v202, v255
  v_mfma_f32_32x32x16_bf16 v[184:199], v[72:75], v[136:139], 0
  buffer_load_dwordx4 v1, s[8:11], s57 offen offset:1024 sc1 lds
  s_waitcnt vmcnt(11)
  v_cvt_pk_bf16_f32 v76, v96, v97
  v_cvt_pk_bf16_f32 v77, v98, v99
  v_mul_f32 v203, v203, v255
  v_mul_f32 v204, v204, v255
  v_mul_f32 v205, v205, v255
  v_mul_f32 v206, v206, v255
  v_mul_f32 v207, v207, v255
  v_mul_f32 v208, v208, v255
  v_mfma_f32_32x32x16_bf16 v[232:247], a[228:231], v[124:127], v[232:247]
  v_mul_f32 v209, v209, v255
  v_mul_f32 v210, v210, v255
  v_mul_f32 v211, v211, v255
  s_waitcnt vmcnt(10)
  v_cvt_pk_bf16_f32 v78, v100, v101
  v_cvt_pk_bf16_f32 v79, v102, v103
  v_mul_f32 v212, v212, v255
  v_mul_f32 v213, v213, v255
  v_mfma_f32_32x32x16_bf16 v[184:199], v[76:79], v[140:143], v[184:199]
  buffer_load_dwordx4 v1, s[8:11], s57 offen offset:2048 sc1 lds
  v_mul_f32 v214, v214, v255
  v_mul_f32 v215, v215, v255
  v_cvt_pk_bf16_f32 v128, v200, v201
  v_cvt_pk_bf16_f32 v129, v202, v203
  v_cvt_pk_bf16_f32 v130, v204, v205
  v_cvt_pk_bf16_f32 v131, v206, v207
  v_cvt_pk_bf16_f32 v132, v208, v209
  v_cvt_pk_bf16_f32 v133, v210, v211
  v_mfma_f32_32x32x16_bf16 v[216:231], v[32:35], v[128:131], v[216:231]
  s_waitcnt vmcnt(10)
  v_cvt_pk_bf16_f32 v80, v104, v105
  v_cvt_pk_bf16_f32 v81, v106, v107
  v_cvt_pk_bf16_f32 v134, v212, v213
  v_cvt_pk_bf16_f32 v135, v214, v215
  v_add_f32 v252, v14, v196
  v_lshlrev_b32 v92, 16, v18
  v_rcp_f32 v252, v252
  v_mfma_f32_32x32x16_bf16 v[232:247], a[232:235], v[128:131], v[232:247]
  buffer_load_dwordx4 v1, s[8:11], s57 offen offset:3072 sc1 lds
  s_waitcnt vmcnt(10)
  v_cvt_pk_bf16_f32 v82, v108, v109
  v_cvt_pk_bf16_f32 v83, v110, v111
  v_mov_b32 v253, v252
  v_and_b32 v93, 0xffff0000, v18
  v_mfma_f32_32x32x16_bf16 v[200:215], v[80:83], v[144:147], 0
  v_permlane32_swap_b32 v252, v253
  v_lshlrev_b32 v94, 16, v19
  v_mul_f32 v184, v184, v253
  v_mul_f32 v185, v185, v253
  v_mul_f32 v186, v186, v253
  v_mul_f32 v187, v187, v253
  v_mfma_f32_32x32x16_bf16 v[216:231], v[36:39], v[132:135], v[216:231]
  s_add_u32 m0, s20, 78848
  s_add_u32 s57, s4, 122880
  buffer_load_dwordx4 v1, s[8:11], s57 offen offset:0 sc1 lds
  s_waitcnt vmcnt(10)
  v_cvt_pk_bf16_f32 v84, v112, v113
  v_cvt_pk_bf16_f32 v85, v114, v115
  v_mul_f32 v188, v188, v253
  v_mul_f32 v189, v189, v253
  v_mul_f32 v190, v190, v253
  v_mul_f32 v191, v191, v253
  v_mfma_f32_32x32x16_bf16 v[232:247], a[236:239], v[132:135], v[232:247]
  v_mul_f32 v192, v192, v253
  v_mul_f32 v193, v193, v253
  v_mul_f32 v194, v194, v253
  v_mul_f32 v195, v195, v253
  v_mul_f32 v196, v196, v253
  v_mul_f32 v197, v197, v253
  s_waitcnt vmcnt(9)
  v_cvt_pk_bf16_f32 v86, v116, v117
  v_cvt_pk_bf16_f32 v87, v118, v119
  v_mul_f32 v198, v198, v253
  v_mul_f32 v199, v199, v253
  v_mfma_f32_32x32x16_bf16 v[200:215], v[84:87], v[148:151], v[200:215]
  buffer_load_dwordx4 v1, s[8:11], s57 offen offset:1024 sc1 lds
  v_cvt_pk_bf16_f32 v136, v184, v185
  v_cvt_pk_bf16_f32 v137, v186, v187
  v_cvt_pk_bf16_f32 v138, v188, v189
  v_cvt_pk_bf16_f32 v139, v190, v191
  v_cvt_pk_bf16_f32 v140, v192, v193
  v_cvt_pk_bf16_f32 v141, v194, v195
  v_cvt_pk_bf16_f32 v142, v196, v197
  v_cvt_pk_bf16_f32 v143, v198, v199
  v_mfma_f32_32x32x16_bf16 v[184:199], v[56:59], v[152:155], 0
  v_and_b32 v95, 0xffff0000, v19
  v_lshlrev_b32 v96, 16, v20
  v_and_b32 v97, 0xffff0000, v20
  v_add_f32 v254, v14, v212
  v_lshlrev_b32 v98, 16, v21
  v_and_b32 v99, 0xffff0000, v21
  v_mfma_f32_32x32x16_bf16 v[184:199], v[60:63], v[156:159], v[184:199]
  buffer_load_dwordx4 v1, s[8:11], s57 offen offset:2048 sc1 lds
  v_rcp_f32 v254, v254
  v_lshlrev_b32 v100, 16, v22
  v_and_b32 v101, 0xffff0000, v22
  v_mfma_f32_32x32x16_bf16 v[216:231], v[40:43], v[136:139], v[216:231]
  v_mov_b32 v255, v254
  v_lshlrev_b32 v102, 16, v23
  v_and_b32 v103, 0xffff0000, v23
  v_permlane32_swap_b32 v254, v255
  v_mul_f32 v200, v200, v255
  v_mfma_f32_32x32x16_bf16 v[232:247], a[240:243], v[136:139], v[232:247]
  buffer_load_dwordx4 v1, s[8:11], s57 offen offset:3072 sc1 lds
  v_mul_f32 v201, v201, v255
  v_mul_f32 v202, v202, v255
  v_mul_f32 v203, v203, v255
  v_mul_f32 v204, v204, v255
  v_mfma_f32_32x32x16_bf16 v[216:231], v[44:47], v[140:143], v[216:231]
  v_mul_f32 v205, v205, v255
  v_mul_f32 v206, v206, v255
  v_mul_f32 v207, v207, v255
  v_mul_f32 v208, v208, v255
  v_mul_f32 v209, v209, v255
  v_mul_f32 v210, v210, v255
  v_mul_f32 v211, v211, v255
  v_mul_f32 v212, v212, v255
  v_mul_f32 v213, v213, v255
  v_mul_f32 v214, v214, v255
  v_mfma_f32_32x32x16_bf16 v[232:247], a[244:247], v[140:143], v[232:247]
  s_add_u32 m0, s44, 0
  s_add_u32 s57, s41, s44
  s_add_u32 s57, s57, 89088
  buffer_load_dwordx4 v1, s[8:11], s57 offen offset:0 sc1 lds
  v_mul_f32 v215, v215, v255
  v_cvt_pk_bf16_f32 v144, v200, v201
  v_cvt_pk_bf16_f32 v145, v202, v203
  v_cvt_pk_bf16_f32 v146, v204, v205
  v_cvt_pk_bf16_f32 v147, v206, v207
  v_cvt_pk_bf16_f32 v148, v208, v209
  v_cvt_pk_bf16_f32 v149, v210, v211
  v_mfma_f32_32x32x16_bf16 v[216:231], v[48:51], v[144:147], v[216:231]
  v_cvt_pk_bf16_f32 v150, v212, v213
  v_cvt_pk_bf16_f32 v151, v214, v215
  v_add_f32 v252, v14, v196
  v_rcp_f32 v252, v252
  v_mfma_f32_32x32x16_bf16 v[200:215], v[64:67], v[160:163], 0
  buffer_load_dwordx4 v1, s[8:11], s57 offen offset:1024 sc1 lds
  v_mov_b32 v253, v252
  s_nop 1
  v_permlane32_swap_b32 v252, v253
  v_mfma_f32_32x32x16_bf16 v[200:215], v[68:71], v[164:167], v[200:215]
  v_mul_f32 v184, v184, v253
  v_mul_f32 v185, v185, v253
  v_mul_f32 v186, v186, v253
  v_mul_f32 v187, v187, v253
  v_mul_f32 v188, v188, v253
  v_mul_f32 v189, v189, v253
  v_mfma_f32_32x32x16_bf16 v[232:247], a[248:251], v[144:147], v[232:247]
  buffer_load_dwordx4 v1, s[8:11], s57 offen offset:2048 sc1 lds
  v_mul_f32 v190, v190, v253
  v_mul_f32 v191, v191, v253
  v_mul_f32 v192, v192, v253
  v_mul_f32 v193, v193, v253
  v_mfma_f32_32x32x16_bf16 v[216:231], v[52:55], v[148:151], v[216:231]
  v_mul_f32 v194, v194, v253
  v_mul_f32 v195, v195, v253
  v_mul_f32 v196, v196, v253
  v_mul_f32 v197, v197, v253
  v_mul_f32 v198, v198, v253
  v_mul_f32 v199, v199, v253
  v_mfma_f32_32x32x16_bf16 v[232:247], a[252:255], v[148:151], v[232:247]
  buffer_load_dwordx4 v1, s[8:11], s57 offen offset:3072 sc1 lds
  v_cvt_pk_bf16_f32 v152, v184, v185
  v_cvt_pk_bf16_f32 v153, v186, v187
  v_cvt_pk_bf16_f32 v154, v188, v189
  v_cvt_pk_bf16_f32 v155, v190, v191
  v_cvt_pk_bf16_f32 v156, v192, v193
  v_cvt_pk_bf16_f32 v157, v194, v195
  v_mfma_f32_32x32x16_bf16 v[104:119], a[224:227], v[152:155], 0
  ds_write_b128 v250, v[216:219] offset:0
  v_cvt_pk_bf16_f32 v158, v196, v197
  v_cvt_pk_bf16_f32 v159, v198, v199
  v_add_f32 v254, v14, v212
  s_waitcnt vmcnt(15)
  v_mfma_f32_32x32x16_bf16 v[184:199], v[72:75], v[168:171], 0
  s_add_u32 m0, s44, 4096
  s_add_u32 s57, s41, s44
  s_add_u32 s57, s57, 93184
  buffer_load_dwordx4 v1, s[8:11], s57 offen offset:0 sc1 lds
  s_waitcnt vmcnt(15)
  v_mfma_f32_32x32x16_bf16 v[184:199], v[76:79], v[172:175], v[184:199]
  ds_write_b128 v250, v[220:223] offset:1024
  v_rcp_f32 v254, v254
  v_mfma_f32_32x32x16_bf16 v[104:119], a[228:231], v[156:159], v[104:119]
  buffer_load_dwordx4 v1, s[8:11], s57 offen offset:1024 sc1 lds
  v_mov_b32 v255, v254
  s_nop 1
  v_permlane32_swap_b32 v254, v255
  v_mfma_f32_32x32x16_bf16 v[88:103], v[24:27], v[152:155], v[88:103]
  ds_write_b128 v250, v[224:227] offset:2048
  v_mul_f32 v200, v200, v255
  v_mul_f32 v201, v201, v255
  v_mul_f32 v202, v202, v255
  v_mul_f32 v203, v203, v255
  v_mul_f32 v204, v204, v255
  v_mul_f32 v205, v205, v255
  v_mul_f32 v206, v206, v255
  v_mul_f32 v207, v207, v255
  v_mfma_f32_32x32x16_bf16 v[88:103], v[28:31], v[156:159], v[88:103]
  v_mul_f32 v208, v208, v255
  v_mul_f32 v209, v209, v255
  v_mul_f32 v210, v210, v255
  v_mul_f32 v211, v211, v255
  v_mul_f32 v212, v212, v255
  v_mul_f32 v213, v213, v255
  v_mul_f32 v214, v214, v255
  v_mul_f32 v215, v215, v255
  v_cvt_pk_bf16_f32 v160, v200, v201
  v_cvt_pk_bf16_f32 v161, v202, v203
  v_cvt_pk_bf16_f32 v162, v204, v205
  v_cvt_pk_bf16_f32 v163, v206, v207
  v_cvt_pk_bf16_f32 v164, v208, v209
  v_cvt_pk_bf16_f32 v165, v210, v211
  v_mfma_f32_32x32x16_bf16 v[104:119], a[232:235], v[160:163], v[104:119]
  ds_write_b128 v250, v[228:231] offset:3072
  v_cvt_pk_bf16_f32 v166, v212, v213
  v_cvt_pk_bf16_f32 v167, v214, v215
  v_add_f32 v252, v14, v196
  s_waitcnt vmcnt(15)
  v_mfma_f32_32x32x16_bf16 v[200:215], v[80:83], v[176:179], 0
  v_rcp_f32 v252, v252
  s_nop 0
  v_mov_b32 v253, v252
  s_waitcnt vmcnt(14)
  v_mfma_f32_32x32x16_bf16 v[200:215], v[84:87], v[180:183], v[200:215]
  ds_write_b128 v251, v[232:235] offset:0
  v_permlane32_swap_b32 v252, v253
  v_mul_f32 v184, v184, v253
  v_mul_f32 v185, v185, v253
  v_mfma_f32_32x32x16_bf16 v[104:119], a[236:239], v[164:167], v[104:119]
  v_mul_f32 v186, v186, v253
  v_mul_f32 v187, v187, v253
  v_mul_f32 v188, v188, v253
  v_mul_f32 v189, v189, v253
  v_mul_f32 v190, v190, v253
  v_mul_f32 v191, v191, v253
  v_cvt_pk_bf16_f32 v168, v184, v185
  v_cvt_pk_bf16_f32 v169, v186, v187
  v_cvt_pk_bf16_f32 v170, v188, v189
  v_cvt_pk_bf16_f32 v171, v190, v191
  v_mfma_f32_32x32x16_bf16 v[88:103], v[32:35], v[160:163], v[88:103]
  ds_write_b128 v251, v[236:239] offset:1024
  v_add_f32 v254, v14, v212
  v_mul_f32 v192, v192, v253
  v_rcp_f32 v254, v254
  v_mfma_f32_32x32x16_bf16 v[104:119], a[240:243], v[168:171], v[104:119]
  v_mul_f32 v193, v193, v253
  v_mul_f32 v194, v194, v253
  v_mul_f32 v195, v195, v253
  v_mul_f32 v196, v196, v253
  v_mul_f32 v197, v197, v253
  v_mul_f32 v198, v198, v253
  v_mul_f32 v199, v199, v253
  v_cvt_pk_bf16_f32 v172, v192, v193
  v_cvt_pk_bf16_f32 v173, v194, v195
  v_cvt_pk_bf16_f32 v174, v196, v197
  v_mfma_f32_32x32x16_bf16 v[88:103], v[36:39], v[164:167], v[88:103]
  ds_write_b128 v251, v[240:243] offset:2048
  v_cvt_pk_bf16_f32 v175, v198, v199
  v_mov_b32 v255, v254
  s_nop 0
  v_mfma_f32_32x32x16_bf16 v[104:119], a[244:247], v[172:175], v[104:119]
  v_permlane32_swap_b32 v254, v255
  v_mul_f32 v200, v200, v255
  v_mul_f32 v201, v201, v255
  v_mul_f32 v202, v202, v255
  v_mul_f32 v203, v203, v255
  v_mul_f32 v204, v204, v255
  v_mul_f32 v205, v205, v255
  v_mul_f32 v206, v206, v255
  v_mul_f32 v207, v207, v255
  v_mfma_f32_32x32x16_bf16 v[88:103], v[40:43], v[168:171], v[88:103]
  ds_write_b128 v251, v[244:247] offset:3072
  v_cvt_pk_bf16_f32 v176, v200, v201
  v_cvt_pk_bf16_f32 v177, v202, v203
  v_cvt_pk_bf16_f32 v178, v204, v205
  v_cvt_pk_bf16_f32 v179, v206, v207
  v_mul_f32 v208, v208, v255
  v_mul_f32 v209, v209, v255
  v_mfma_f32_32x32x16_bf16 v[104:119], a[248:251], v[176:179], v[104:119]
  v_mul_f32 v210, v210, v255
  v_mul_f32 v211, v211, v255
  v_mul_f32 v212, v212, v255
  v_mul_f32 v213, v213, v255
  v_mul_f32 v214, v214, v255
  v_mul_f32 v215, v215, v255
  v_cvt_pk_bf16_f32 v180, v208, v209
  v_cvt_pk_bf16_f32 v181, v210, v211
  v_cvt_pk_bf16_f32 v182, v212, v213
  v_cvt_pk_bf16_f32 v183, v214, v215
  v_mfma_f32_32x32x16_bf16 v[88:103], v[44:47], v[172:175], v[88:103]
  s_nop 0
  v_mfma_f32_32x32x16_bf16 v[104:119], a[252:255], v[180:183], v[104:119]
  s_waitcnt lgkmcnt(0)
  s_barrier
  ds_read_b128 v[120:123], v248 offset:4096
  ds_read_b128 v[124:127], v248 offset:5120
  ds_read_b128 v[128:131], v248 offset:6144
  ds_read_b128 v[132:135], v248 offset:7168
  ds_read_b128 v[136:139], v248 offset:8192
  ds_read_b128 v[140:143], v248 offset:9216
  v_mfma_f32_32x32x16_bf16 v[88:103], v[48:51], v[176:179], v[88:103]
  ds_read_b128 v[144:147], v248 offset:10240
  ds_read_b128 v[148:151], v248 offset:11264
  v_mfma_f32_32x32x16_bf16 v[88:103], v[52:55], v[180:183], v[88:103]
  s_nop 0
  ds_write_b128 v249, v[104:107] offset:0
  ds_write_b128 v249, v[108:111] offset:1024
  s_waitcnt lgkmcnt(5)
  v_add_f32 v120, v120, v136
  v_add_f32 v121, v121, v137
  v_add_f32 v122, v122, v138
  v_add_f32 v123, v123, v139
  s_waitcnt lgkmcnt(4)
  v_add_f32 v124, v124, v140
  v_add_f32 v125, v125, v141
  v_add_f32 v126, v126, v142
  ds_write_b128 v249, v[112:115] offset:2048
  v_add_f32 v127, v127, v143
  s_waitcnt lgkmcnt(4)
  v_add_f32 v128, v128, v144
  v_add_f32 v129, v129, v145
  v_add_f32 v130, v130, v146
  v_add_f32 v131, v131, v147
  s_waitcnt lgkmcnt(3)
  v_add_f32 v132, v132, v148
  v_add_f32 v133, v133, v149
  v_add_f32 v134, v134, v150
  ds_write_b128 v249, v[116:119] offset:3072
  v_add_f32 v135, v135, v151
  v_pk_add_f32 v[88:89], v[88:89], v[120:121]
  v_pk_add_f32 v[90:91], v[90:91], v[122:123]
  v_pk_add_f32 v[92:93], v[92:93], v[124:125]
  v_pk_add_f32 v[94:95], v[94:95], v[126:127]
  v_pk_add_f32 v[96:97], v[96:97], v[128:129]
  v_pk_add_f32 v[98:99], v[98:99], v[130:131]
  v_pk_add_f32 v[100:101], v[100:101], v[132:133]
  v_pk_add_f32 v[102:103], v[102:103], v[134:135]
  s_waitcnt lgkmcnt(0)
  s_barrier
  ds_read_b128 v[136:139], v248 offset:0
  ds_read_b128 v[140:143], v248 offset:1024
  ds_read_b128 v[144:147], v248 offset:2048
  ds_read_b128 v[148:151], v248 offset:3072
  s_waitcnt lgkmcnt(3)
  v_pk_add_f32 v[88:89], v[88:89], v[136:137]
  v_pk_add_f32 v[90:91], v[90:91], v[138:139]
  s_waitcnt lgkmcnt(2)
  v_pk_add_f32 v[92:93], v[92:93], v[140:141]
  v_pk_add_f32 v[94:95], v[94:95], v[142:143]
  s_waitcnt lgkmcnt(1)
  v_pk_add_f32 v[96:97], v[96:97], v[144:145]
  v_pk_add_f32 v[98:99], v[98:99], v[146:147]
  s_waitcnt lgkmcnt(0)
  v_pk_add_f32 v[100:101], v[100:101], v[148:149]
  v_pk_add_f32 v[102:103], v[102:103], v[150:151]
  v_cvt_pk_bf16_f32 v16, v88, v89
  v_cvt_pk_bf16_f32 v17, v90, v91
  v_cvt_pk_bf16_f32 v18, v92, v93
  v_cvt_pk_bf16_f32 v19, v94, v95
  buffer_store_dwordx4 v[16:19], v1, s[8:11], s33 offen
  v_cvt_pk_bf16_f32 v20, v96, v97
  v_cvt_pk_bf16_f32 v21, v98, v99
  v_cvt_pk_bf16_f32 v22, v100, v101
  v_cvt_pk_bf16_f32 v23, v102, v103
  buffer_store_dwordx4 v[20:23], v1, s[8:11], s33 offen offset:1024
  v_mov_b32 v10, 0
  v_mov_b32 v11, 0
  v_dot2c_f32_bf16 v10, s22, v16
  v_dot2c_f32_bf16 v10, s22, v17
  v_dot2c_f32_bf16 v10, s22, v18
  v_dot2c_f32_bf16 v10, s22, v19
  v_dot2c_f32_bf16 v10, s22, v20
  v_dot2c_f32_bf16 v10, s22, v21
  v_dot2c_f32_bf16 v10, s22, v22
  v_dot2c_f32_bf16 v10, s22, v23
  v_dot2c_f32_bf16 v11, v16, v16
  v_dot2c_f32_bf16 v11, v17, v17
  v_dot2c_f32_bf16 v11, v18, v18
  v_dot2c_f32_bf16 v11, v19, v19
  v_dot2c_f32_bf16 v11, v20, v20
  v_dot2c_f32_bf16 v11, v21, v21
  v_dot2c_f32_bf16 v11, v22, v22
  v_dot2c_f32_bf16 v11, v23, v23
  s_add_u32 s56, s34, 8192
  s_nop 1
  v_permlane32_swap_b32 v10, v11
  v_add_f32 v10, v10, v11
  v_or_b32 v10, 1, v10
  s_waitcnt vmcnt(0)
  s_cbranch_vccz Lpub_49
  buffer_store_dword v10, v1, s[8:11], s56 offen
Lpubr_50:
  s_waitcnt lgkmcnt(0)
  s_barrier
M_up1:
  s_nop 7
  s_nop 5
  s_add_u32 s59, s25, 8192
  s_mov_b32 s46, 0
Lpoll_51:
  buffer_load_dwordx4 v[208:211], v1, s[8:11], s59 offen offset:0 sc1
  buffer_load_dwordx4 v[212:215], v1, s[8:11], s59 offen offset:1024 sc1
  buffer_load_dwordx4 v[216:219], v1, s[8:11], s59 offen offset:2048 sc1
  buffer_load_dwordx4 v[220:223], v1, s[8:11], s59 offen offset:3072 sc1
  s_add_u32 s46, s46, 1
  s_waitcnt vmcnt(0)
  v_min3_u32 v6, v208, v209, v210
  v_min3_u32 v7, v211, v212, v213
  v_min3_u32 v8, v214, v215, v216
  v_min3_u32 v9, v217, v218, v219
  v_min3_u32 v6, v6, v220, v221
  v_min3_u32 v7, v7, v8, v9
  v_min_u32 v6, v6, v7
  v_cmp_ne_u32 s[54:55], 0, v6
  s_cmp_gt_u32 s46, 300000
  s_cbranch_scc1 Lpd_52
  s_cmp_eq_u64 s[54:55], exec
  s_cbranch_scc0 Lpoll_51
Lpd_52:
  s_cbranch_vccz Lacq_53
Lacqr_54:
  s_add_u32 s59, s35, 4096
  buffer_load_dwordx4 v[24:27], v1, s[8:11], s24 offen offset:0 sc1
  buffer_load_dwordx4 v[28:31], v1, s[8:11], s24 offen offset:1024 sc1
  buffer_load_dwordx4 v[32:35], v1, s[8:11], s24 offen offset:2048 sc1
  buffer_load_dwordx4 v[36:39], v1, s[8:11], s24 offen offset:3072 sc1
  s_add_u32 s56, s24, 4096
  buffer_load_dwordx4 v[40:43], v1, s[8:11], s56 offen offset:0 sc1
  buffer_load_dwordx4 v[44:47], v1, s[8:11], s56 offen offset:1024 sc1
  buffer_load_dwordx4 v[48:51], v1, s[8:11], s56 offen offset:2048 sc1
  buffer_load_dwordx4 v[52:55], v1, s[8:11], s56 offen offset:3072 sc1
  s_add_u32 s56, s24, 8192
  buffer_load_dwordx4 v[56:59], v1, s[8:11], s56 offen offset:0 sc1
  buffer_load_dwordx4 v[60:63], v1, s[8:11], s56 offen offset:1024 sc1
  buffer_load_dwordx4 v[64:67], v1, s[8:11], s56 offen offset:2048 sc1
  ds_read_b128 v[224:227], v12 offset:38912
  ds_read_b128 v[228:231], v13 offset:3072
  ds_read_b128 v[232:235], v12 offset:39936
  ds_read_b128 v[236:239], v13 offset:4096
  ds_read_b128 v[240:243], v12 offset:40960
  ds_read_b128 v[244:247], v13 offset:5120
  ds_read_b128 v[200:203], v12 offset:41984
  ds_read_b128 v[204:207], v13 offset:6144
  v_add_f32 v208, v208, v209
  v_add_f32 v215, v215, v216
  v_add_f32 v208, v208, v210
  v_add_f32 v215, v215, v217
  v_add_f32 v208, v208, v211
  v_add_f32 v215, v215, v218
  v_add_f32 v208, v208, v212
  v_add_f32 v215, v215, v219
  v_add_f32 v208, v208, v213
  v_add_f32 v215, v215, v220
  v_add_f32 v208, v208, v214
  v_add_f32 v215, v215, v221
  v_mov_b32 v210, 0
  v_add_f32 v220, v208, v215
  v_mov_b32 v221, v220
  s_nop 1
  v_permlane32_swap_b32 v220, v221
  v_mul_f32 v220, 0xbb124925, v220
  v_mul_f32 v221, 0x3b124925, v221
  v_cvt_pk_bf16_f32 v208, v220, v220
  v_fma_f32 v221, -v220, v220, v221
  v_and_b32 v209, 0xffff0000, v208
  v_max_f32 v221, 0, v221
  s_waitcnt vmcnt(10)
  s_waitcnt lgkmcnt(4)
  v_mfma_f32_32x32x16_bf16 v[136:151], v[224:227], v[24:27], 0
  ds_read_b128 v[224:227], v12 offset:43008
  buffer_load_dwordx4 v[68:71], v1, s[8:11], s56 offen offset:3072 sc1
  v_sub_f32 v209, v220, v209
  v_add_f32 v221, 0x3727c5ac, v221
  v_mfma_f32_32x32x16_bf16 v[152:167], v[228:231], v[24:27], 0
  ds_read_b128 v[228:231], v13 offset:7168
  v_cvt_pk_bf16_f32 v209, v209, v210
  v_mov_b32 v210, v208
  v_mov_b32 v211, v209
  v_rsq_f32 v222, v221
  s_waitcnt vmcnt(10)
  v_mfma_f32_32x32x16_bf16 v[136:151], v[232:235], v[28:31], v[136:151]
  ds_read_b128 v[232:235], v12 offset:44032
  s_add_u32 s56, s24, 12288
  buffer_load_dwordx4 v[72:75], v1, s[8:11], s56 offen offset:0 sc1
  v_mul_f32 v223, 0xbfb8aa3b, v222
  v_mfma_f32_32x32x16_bf16 v[152:167], v[236:239], v[28:31], v[152:167]
  ds_read_b128 v[236:239], v13 offset:8192
  s_waitcnt vmcnt(10)
  s_waitcnt lgkmcnt(4)
  v_mfma_f32_32x32x16_bf16 v[136:151], v[240:243], v[32:35], v[136:151]
  ds_read_b128 v[240:243], v12 offset:45056
  buffer_load_dwordx4 v[76:79], v1, s[8:11], s56 offen offset:1024 sc1
  v_mfma_f32_32x32x16_bf16 v[152:167], v[244:247], v[32:35], v[152:167]
  ds_read_b128 v[244:247], v13 offset:9216
  s_waitcnt vmcnt(10)
  v_mfma_f32_32x32x16_bf16 v[136:151], v[200:203], v[36:39], v[136:151]
  ds_read_b128 v[200:203], v12 offset:46080
  buffer_load_dwordx4 v[80:83], v1, s[8:11], s56 offen offset:2048 sc1
  v_mfma_f32_32x32x16_bf16 v[152:167], v[204:207], v[36:39], v[152:167]
  ds_read_b128 v[204:207], v13 offset:10240
  s_waitcnt vmcnt(10)
  s_waitcnt lgkmcnt(4)
  v_mfma_f32_32x32x16_bf16 v[136:151], v[224:227], v[40:43], v[136:151]
  ds_read_b128 v[224:227], v12 offset:47104
  buffer_load_dwordx4 v[84:87], v1, s[8:11], s56 offen offset:3072 sc1
  v_mfma_f32_32x32x16_bf16 v[152:167], v[228:231], v[40:43], v[152:167]
  ds_read_b128 v[228:231], v13 offset:11264
  s_waitcnt vmcnt(10)
  v_mfma_f32_32x32x16_bf16 v[136:151], v[232:235], v[44:47], v[136:151]
  ds_read_b128 v[232:235], v12 offset:48128
  s_add_u32 s56, s24, 16384
  buffer_load_dwordx4 v[88:91], v1, s[8:11], s56 offen offset:0 sc1
  v_mfma_f32_32x32x16_bf16 v[152:167], v[236:239], v[44:47], v[152:167]
  ds_read_b128 v[236:239], v13 offset:12288
  s_waitcnt vmcnt(10)
  s_waitcnt lgkmcnt(4)
  v_mfma_f32_32x32x16_bf16 v[136:151], v[240:243], v[48:51], v[136:151]
  ds_read_b128 v[240:243], v12 offset:49152
  buffer_load_dwordx4 v[92:95], v1, s[8:11], s56 offen offset:1024 sc1
  v_mfma_f32_32x32x16_bf16 v[152:167], v[244:247], v[48:51], v[152:167]
  ds_read_b128 v[244:247], v13 offset:13312
  s_waitcnt vmcnt(10)
  v_mfma_f32_32x32x16_bf16 v[136:151], v[200:203], v[52:55], v[136:151]
  ds_read_b128 v[200:203], v12 offset:50176
  buffer_load_dwordx4 v[96:99], v1, s[8:11], s56 offen offset:2048 sc1
  v_mfma_f32_32x32x16_bf16 v[152:167], v[204:207], v[52:55], v[152:167]
  ds_read_b128 v[204:207], v13 offset:14336
  s_waitcnt vmcnt(10)
  s_waitcnt lgkmcnt(4)
  v_mfma_f32_32x32x16_bf16 v[136:151], v[224:227], v[56:59], v[136:151]
  ds_read_b128 v[224:227], v12 offset:51200
  buffer_load_dwordx4 v[100:103], v1, s[8:11], s56 offen offset:3072 sc1
  v_mfma_f32_32x32x16_bf16 v[152:167], v[228:231], v[56:59], v[152:167]
  ds_read_b128 v[228:231], v13 offset:15360
  s_waitcnt vmcnt(10)
  v_mfma_f32_32x32x16_bf16 v[136:151], v[232:235], v[60:63], v[136:151]
  ds_read_b128 v[232:235], v12 offset:52224
  s_add_u32 s56, s24, 20480
  buffer_load_dwordx4 v[104:107], v1, s[8:11], s56 offen offset:0 sc1
  v_mfma_f32_32x32x16_bf16 v[152:167], v[236:239], v[60:63], v[152:167]
  ds_read_b128 v[236:239], v13 offset:16384
  s_waitcnt vmcnt(10)
  s_waitcnt lgkmcnt(4)
  v_mfma_f32_32x32x16_bf16 v[136:151], v[240:243], v[64:67], v[136:151]
  ds_read_b128 v[240:243], v12 offset:53248
  buffer_load_dwordx4 v[108:111], v1, s[8:11], s56 offen offset:1024 sc1
  v_mfma_f32_32x32x16_bf16 v[152:167], v[244:247], v[64:67], v[152:167]
  ds_read_b128 v[244:247], v13 offset:17408
  s_waitcnt vmcnt(10)
  v_mfma_f32_32x32x16_bf16 v[136:151], v[200:203], v[68:71], v[136:151]
  ds_read_b128 v[200:203], v12 offset:54272
  buffer_load_dwordx4 v[112:115], v1, s[8:11], s56 offen offset:2048 sc1
  v_mfma_f32_32x32x16_bf16 v[152:167], v[204:207], v[68:71], v[152:167]
  ds_read_b128 v[204:207], v13 offset:18432
  s_waitcnt vmcnt(10)
  s_waitcnt lgkmcnt(4)
  v_mfma_f32_32x32x16_bf16 v[136:151], v[224:227], v[72:75], v[136:151]
  ds_read_b128 v[224:227], v12 offset:55296
  buffer_load_dwordx4 v[116:119], v1, s[8:11], s56 offen offset:3072 sc1
  v_mfma_f32_32x32x16_bf16 v[152:167], v[228:231], v[72:75], v[152:167]
  ds_read_b128 v[228:231], v13 offset:19456
  s_waitcnt vmcnt(10)
  v_mfma_f32_32x32x16_bf16 v[136:151], v[232:235], v[76:79], v[136:151]
  ds_read_b128 v[232:235], v12 offset:56320
  s_add_u32 s56, s24, 24576
  buffer_load_dwordx4 v[120:123], v1, s[8:11], s56 offen offset:0 sc1
  v_mfma_f32_32x32x16_bf16 v[152:167], v[236:239], v[76:79], v[152:167]
  ds_read_b128 v[236:239], v13 offset:20480
  s_waitcnt vmcnt(10)
  s_waitcnt lgkmcnt(4)
  v_mfma_f32_32x32x16_bf16 v[136:151], v[240:243], v[80:83], v[136:151]
  ds_read_b128 v[240:243], v12 offset:57344
  buffer_load_dwordx4 v[124:127], v1, s[8:11], s56 offen offset:1024 sc1
  v_mfma_f32_32x32x16_bf16 v[152:167], v[244:247], v[80:83], v[152:167]
  ds_read_b128 v[244:247], v13 offset:21504
  s_waitcnt vmcnt(10)
  v_mfma_f32_32x32x16_bf16 v[136:151], v[200:203], v[84:87], v[136:151]
  ds_read_b128 v[200:203], v12 offset:58368
  buffer_load_dwordx4 v[128:131], v1, s[8:11], s56 offen offset:2048 sc1
  v_mfma_f32_32x32x16_bf16 v[152:167], v[204:207], v[84:87], v[152:167]
  ds_read_b128 v[204:207], v13 offset:22528
  s_waitcnt vmcnt(10)
  s_waitcnt lgkmcnt(4)
  v_mfma_f32_32x32x16_bf16 v[136:151], v[224:227], v[88:91], v[136:151]
  ds_read_b128 v[224:227], v12 offset:59392
  buffer_load_dwordx4 v[132:135], v1, s[8:11], s56 offen offset:3072 sc1
  v_mfma_f32_32x32x16_bf16 v[152:167], v[228:231], v[88:91], v[152:167]
  ds_read_b128 v[228:231], v13 offset:23552
  s_waitcnt vmcnt(10)
  v_mfma_f32_32x32x16_bf16 v[136:151], v[232:235], v[92:95], v[136:151]
  ds_read_b128 v[232:235], v12 offset:60416
  v_mfma_f32_32x32x16_bf16 v[152:167], v[236:239], v[92:95], v[152:167]
  ds_read_b128 v[236:239], v13 offset:24576
  s_waitcnt vmcnt(9)
  s_waitcnt lgkmcnt(4)
  v_mfma_f32_32x32x16_bf16 v[136:151], v[240:243], v[96:99], v[136:151]
  ds_read_b128 v[240:243], v12 offset:61440
  v_mfma_f32_32x32x16_bf16 v[152:167], v[244:247], v[96:99], v[152:167]
  ds_read_b128 v[244:247], v13 offset:25600
  s_add_u32 m0, s19, 24576
  s_add_u32 s57, s41, s19
  s_add_u32 s57, s57, 113664
  buffer_load_dwordx4 v1, s[8:11], s57 offen offset:0 sc1 lds
  s_waitcnt vmcnt(9)
  v_mfma_f32_32x32x16_bf16 v[136:151], v[200:203], v[100:103], v[136:151]
  ds_read_b128 v[200:203], v12 offset:62464
  v_mfma_f32_32x32x16_bf16 v[152:167], v[204:207], v[100:103], v[152:167]
  ds_read_b128 v[204:207], v13 offset:26624
  buffer_load_dwordx4 v1, s[8:11], s57 offen offset:1024 sc1 lds
  s_waitcnt vmcnt(9)
  s_waitcnt lgkmcnt(4)
  v_mfma_f32_32x32x16_bf16 v[136:151], v[224:227], v[104:107], v[136:151]
  ds_read_b128 v[224:227], v12 offset:63488
  v_mfma_f32_32x32x16_bf16 v[152:167], v[228:231], v[104:107], v[152:167]
  ds_read_b128 v[228:231], v13 offset:27648
  s_waitcnt vmcnt(8)
  v_mfma_f32_32x32x16_bf16 v[136:151], v[232:235], v[108:111], v[136:151]
  ds_read_b128 v[232:235], v12 offset:64512
  s_add_u32 m0, s20, 29696
  s_add_u32 s57, s4, 59392
  buffer_load_dwordx4 v1, s[8:11], s57 offen offset:0 sc1 lds
  v_mfma_f32_32x32x16_bf16 v[152:167], v[236:239], v[108:111], v[152:167]
  ds_read_b128 v[236:239], v13 offset:28672
  s_waitcnt vmcnt(8)
  s_waitcnt lgkmcnt(4)
  v_mfma_f32_32x32x16_bf16 v[136:151], v[240:243], v[112:115], v[136:151]
  ds_read_b128 v[240:243], v13 offset:0
  v_mfma_f32_32x32x16_bf16 v[152:167], v[244:247], v[112:115], v[152:167]
  ds_read_b128 v[244:247], v13 offset:29696
  buffer_load_dwordx4 v1, s[8:11], s57 offen offset:1024 sc1 lds
  s_waitcnt vmcnt(8)
  v_mfma_f32_32x32x16_bf16 v[136:151], v[200:203], v[116:119], v[136:151]
  ds_read_b128 v[200:203], v13 offset:1024
  v_mfma_f32_32x32x16_bf16 v[152:167], v[204:207], v[116:119], v[152:167]
  ds_read_b128 v[204:207], v13 offset:30720
  s_waitcnt vmcnt(7)
  s_waitcnt lgkmcnt(4)
  v_mfma_f32_32x32x16_bf16 v[136:151], v[224:227], v[120:123], v[136:151]
  ds_read_b128 v[224:227], v13 offset:2048
  buffer_load_dwordx4 v1, s[8:11], s57 offen offset:2048 sc1 lds
  v_mfma_f32_32x32x16_bf16 v[152:167], v[228:231], v[120:123], v[152:167]
  ds_read_b128 v[228:231], v13 offset:31744
  s_waitcnt vmcnt(7)
  v_mfma_f32_32x32x16_bf16 v[136:151], v[232:235], v[124:127], v[136:151]
  ds_read_b128 v[232:235], v12 offset:9216
  v_mfma_f32_32x32x16_bf16 v[152:167], v[236:239], v[124:127], v[152:167]
  ds_read_b128 v[236:239], v12 offset:10240
  buffer_load_dwordx4 v1, s[8:11], s57 offen offset:3072 sc1 lds
  s_waitcnt vmcnt(7)
  s_waitcnt lgkmcnt(4)
  v_mfma_f32_32x32x16_bf16 v[136:151], v[240:243], v[128:131], v[136:151]
  ds_read_b128 v[240:243], v12 offset:11264
  v_mfma_f32_32x32x16_bf16 v[152:167], v[244:247], v[128:131], v[152:167]
  ds_read_b128 v[244:247], v12 offset:12288
  s_waitcnt vmcnt(6)
  v_mfma_f32_32x32x16_bf16 v[136:151], v[200:203], v[132:135], v[136:151]
  ds_read_b128 v[200:203], v12 offset:13312
  s_add_u32 m0, s20, 33792
  s_add_u32 s57, s4, 63488
  buffer_load_dwordx4 v1, s[8:11], s57 offen offset:0 sc1 lds
  v_mfma_f32_32x32x16_bf16 v[152:167], v[204:207], v[132:135], v[152:167]
  ds_read_b128 v[204:207], v12 offset:14336
  s_waitcnt lgkmcnt(4)
  v_mfma_f32_32x32x16_bf16 v[136:151], v[224:227], v[208:211], v[136:151]
  ds_read_b128 v[224:227], v12 offset:15360
  v_mfma_f32_32x32x16_bf16 v[152:167], v[228:231], v[208:211], v[152:167]
  ds_read_b128 v[228:231], v12 offset:16384
  buffer_load_dwordx4 v1, s[8:11], s57 offen offset:1024 sc1 lds
  v_mfma_f32_32x32x16_bf16 v[168:183], v[232:235], v[24:27], 0
  ds_read_b128 v[232:235], v12 offset:17408
  v_mfma_f32_32x32x16_bf16 v[168:183], v[236:239], v[28:31], v[168:183]
  ds_read_b128 v[236:239], v12 offset:18432
  s_waitcnt lgkmcnt(4)
  v_mfma_f32_32x32x16_bf16 v[168:183], v[240:243], v[32:35], v[168:183]
  ds_read_b128 v[240:243], v12 offset:19456
  buffer_load_dwordx4 v1, s[8:11], s57 offen offset:2048 sc1 lds
  s_nop 0
  v_mul_f32 v212, v136, v223
  v_mul_f32 v214, v137, v223
  v_mfma_f32_32x32x16_bf16 v[168:183], v[244:247], v[36:39], v[168:183]
  ds_read_b128 v[244:247], v12 offset:20480
  v_mul_f32 v216, v138, v223
  v_mul_f32 v218, v139, v223
  v_exp_f32 v212, v212
  v_mul_f32 v213, v136, v144
  v_mfma_f32_32x32x16_bf16 v[168:183], v[200:203], v[40:43], v[168:183]
  ds_read_b128 v[200:203], v12 offset:21504
  v_exp_f32 v214, v214
  v_exp_f32 v216, v216
  v_fma_f32 v212, v212, v221, v221
  v_mfma_f32_32x32x16_bf16 v[168:183], v[204:207], v[44:47], v[168:183]
  ds_read_b128 v[204:207], v12 offset:22528
  buffer_load_dwordx4 v1, s[8:11], s57 offen offset:3072 sc1 lds
  v_exp_f32 v218, v218
  s_waitcnt lgkmcnt(4)
  v_mfma_f32_32x32x16_bf16 v[168:183], v[224:227], v[48:51], v[168:183]
  ds_read_b128 v[224:227], v12 offset:23552
  v_fma_f32 v214, v214, v221, v221
  v_fma_f32 v216, v216, v221, v221
  v_fma_f32 v218, v218, v221, v221
  v_rcp_f32 v212, v212
  v_mfma_f32_32x32x16_bf16 v[168:183], v[228:231], v[52:55], v[168:183]
  ds_read_b128 v[228:231], v12 offset:24576
  s_waitcnt vmcnt(8)
  s_barrier
  v_rcp_f32 v214, v214
  v_rcp_f32 v216, v216
  v_mfma_f32_32x32x16_bf16 v[168:183], v[232:235], v[56:59], v[168:183]
  ds_read_b128 v[232:235], v12 offset:25600
  v_rcp_f32 v218, v218
  v_mul_f32 v215, v137, v145
  v_mul_f32 v217, v138, v146
  v_mul_f32 v219, v139, v147
  v_mfma_f32_32x32x16_bf16 v[168:183], v[236:239], v[60:63], v[168:183]
  ds_read_b128 v[236:239], v12 offset:26624
  s_add_u32 m0, s20, 104448
  s_add_u32 s57, s4, 29696
  buffer_load_dwordx4 v1, s[8:11], s57 offen offset:0 sc1 lds
  s_waitcnt lgkmcnt(4)
  v_mfma_f32_32x32x16_bf16 v[168:183], v[240:243], v[64:67], v[168:183]
  ds_read_b128 v[240:243], v12 offset:27648
  v_mul_f32 v136, v213, v212
  v_mul_f32 v137, v215, v214
  v_mul_f32 v138, v217, v216
  v_mul_f32 v139, v219, v218
  v_mul_f32 v212, v140, v223
  v_mfma_f32_32x32x16_bf16 v[168:183], v[244:247], v[68:71], v[168:183]
  ds_read_b128 v[244:247], v12 offset:28672
  v_mul_f32 v214, v141, v223
  v_mul_f32 v216, v142, v223
  v_mul_f32 v218, v143, v223
  v_exp_f32 v212, v212
  v_mfma_f32_32x32x16_bf16 v[168:183], v[200:203], v[72:75], v[168:183]
  ds_read_b128 v[200:203], v12 offset:29696
  v_exp_f32 v214, v214
  v_exp_f32 v216, v216
  v_fma_f32 v212, v212, v221, v221
  v_mfma_f32_32x32x16_bf16 v[168:183], v[204:207], v[76:79], v[168:183]
  ds_read_b128 v[204:207], v12 offset:30720
  buffer_load_dwordx4 v1, s[8:11], s57 offen offset:1024 sc1 lds
  v_exp_f32 v218, v218
  s_waitcnt lgkmcnt(4)
  v_mfma_f32_32x32x16_bf16 v[168:183], v[224:227], v[80:83], v[168:183]
  ds_read_b128 v[224:227], v12 offset:31744
  v_fma_f32 v214, v214, v221, v221
  v_fma_f32 v216, v216, v221, v221
  v_fma_f32 v218, v218, v221, v221
  v_rcp_f32 v212, v212
  v_mfma_f32_32x32x16_bf16 v[168:183], v[228:231], v[84:87], v[168:183]
  ds_read_b128 v[228:231], v12 offset:32768
  v_rcp_f32 v214, v214
  v_rcp_f32 v216, v216
  v_mul_f32 v213, v140, v148
  v_mfma_f32_32x32x16_bf16 v[168:183], v[232:235], v[88:91], v[168:183]
  ds_read_b128 v[232:235], v12 offset:33792
  v_rcp_f32 v218, v218
  v_mul_f32 v215, v141, v149
  v_mul_f32 v217, v142, v150
  v_mul_f32 v219, v143, v151
  v_mfma_f32_32x32x16_bf16 v[168:183], v[236:239], v[92:95], v[168:183]
  ds_read_b128 v[236:239], v12 offset:34816
  buffer_load_dwordx4 v1, s[8:11], s57 offen offset:2048 sc1 lds
  v_mul_f32 v140, v213, v212
  v_mul_f32 v141, v215, v214
  s_waitcnt lgkmcnt(4)
  v_mfma_f32_32x32x16_bf16 v[168:183], v[240:243], v[96:99], v[168:183]
  ds_read_b128 v[240:243], v12 offset:35840
  v_mul_f32 v142, v217, v216
  v_mul_f32 v143, v219, v218
  v_cvt_pk_bf16_f32 v248, v136, v137
  v_cvt_pk_bf16_f32 v249, v138, v139
  v_cvt_pk_bf16_f32 v250, v140, v141
  v_mfma_f32_32x32x16_bf16 v[168:183], v[244:247], v[100:103], v[168:183]
  ds_read_b128 v[244:247], v12 offset:36864
  v_cvt_pk_bf16_f32 v251, v142, v143
  v_mul_f32 v212, v152, v223
  v_mul_f32 v214, v153, v223
  v_mul_f32 v216, v154, v223
  v_mul_f32 v218, v155, v223
  v_mfma_f32_32x32x16_bf16 v[168:183], v[200:203], v[104:107], v[168:183]
  ds_read_b128 v[200:203], v12 offset:37888
  buffer_store_dwordx4 v[248:251], v1, s[8:11], s59 offen offset:1024 sc1
  v_exp_f32 v212, v212
  v_mfma_f32_32x32x16_bf16 v[168:183], v[204:207], v[108:111], v[168:183]
  ds_read_b128 v[204:207], v1 offset:0
  buffer_load_dwordx4 v1, s[8:11], s57 offen offset:3072 sc1 lds
  v_exp_f32 v214, v214
  s_waitcnt lgkmcnt(4)
  v_mfma_f32_32x32x16_bf16 v[168:183], v[224:227], v[112:115], v[168:183]
  ds_read_b128 v[224:227], v1 offset:1024
  v_exp_f32 v216, v216
  v_exp_f32 v218, v218
  v_fma_f32 v212, v212, v221, v221
  v_mfma_f32_32x32x16_bf16 v[168:183], v[228:231], v[116:119], v[168:183]
  ds_read_b128 v[228:231], v1 offset:2048
  v_fma_f32 v214, v214, v221, v221
  v_fma_f32 v216, v216, v221, v221
  v_fma_f32 v218, v218, v221, v221
  v_rcp_f32 v212, v212
  v_mfma_f32_32x32x16_bf16 v[168:183], v[232:235], v[120:123], v[168:183]
  ds_read_b128 v[232:235], v1 offset:3072
  v_rcp_f32 v214, v214
  v_rcp_f32 v216, v216
  v_mul_f32 v213, v152, v160
  v_mfma_f32_32x32x16_bf16 v[168:183], v[236:239], v[124:127], v[168:183]
  ds_read_b128 v[236:239], v1 offset:4096
  s_add_u32 m0, s20, 108544
  s_add_u32 s57, s4, 33792
  buffer_load_dwordx4 v1, s[8:11], s57 offen offset:0 sc1 lds
  s_waitcnt lgkmcnt(4)
  v_mfma_f32_32x32x16_bf16 v[168:183], v[240:243], v[128:131], v[168:183]
  ds_read_b128 v[240:243], v1 offset:5120
  v_rcp_f32 v218, v218
  v_mul_f32 v215, v153, v161
  v_mul_f32 v217, v154, v162
  v_mul_f32 v219, v155, v163
  v_mfma_f32_32x32x16_bf16 v[168:183], v[244:247], v[132:135], v[168:183]
  ds_read_b128 v[244:247], v1 offset:6144
  v_mul_f32 v152, v213, v212
  v_mul_f32 v153, v215, v214
  v_mul_f32 v154, v217, v216
  v_mul_f32 v155, v219, v218
  v_mul_f32 v212, v156, v223
  v_mfma_f32_32x32x16_bf16 v[168:183], v[200:203], v[208:211], v[168:183]
  ds_read_b128 v[200:203], v1 offset:7168
  v_mul_f32 v214, v157, v223
  v_mul_f32 v216, v158, v223
  v_mul_f32 v218, v159, v223
  v_exp_f32 v212, v212
  v_mfma_f32_32x32x16_bf16 v[184:199], v[204:207], v[24:27], 0
  ds_read_b128 v[204:207], v1 offset:8192
  buffer_load_dwordx4 v1, s[8:11], s57 offen offset:1024 sc1 lds
  v_exp_f32 v214, v214
  s_waitcnt lgkmcnt(4)
  v_mfma_f32_32x32x16_bf16 v[184:199], v[224:227], v[28:31], v[184:199]
  ds_read_b128 v[224:227], v1 offset:9216
  v_exp_f32 v216, v216
  v_exp_f32 v218, v218
  v_fma_f32 v212, v212, v221, v221
  v_mfma_f32_32x32x16_bf16 v[184:199], v[228:231], v[32:35], v[184:199]
  ds_read_b128 v[228:231], v1 offset:10240
  s_and_b32 s6, s17, 3
  s_lshl_b32 s6, s6, 2
  s_add_u32 s6, s6, s16
  s_lshl_b32 s6, s6, 10
  s_add_u32 s6, s6, M_down1-M_start
  s_min_u32 s6, s6, M_last-M_start-1024
  buffer_load_dword v7, v1, s[96:99], s6 offen
  v_mfma_f32_32x32x16_bf16 v[184:199], v[232:235], v[36:39], v[184:199]
  ds_read_b128 v[232:235], v1 offset:11264
  v_fma_f32 v214, v214, v221, v221
  v_fma_f32 v216, v216, v221, v221
  v_fma_f32 v218, v218, v221, v221
  v_rcp_f32 v212, v212
  v_mfma_f32_32x32x16_bf16 v[184:199], v[236:239], v[40:43], v[184:199]
  ds_read_b128 v[236:239], v1 offset:12288
  buffer_load_dwordx4 v1, s[8:11], s57 offen offset:2048 sc1 lds
  v_rcp_f32 v214, v214
  s_waitcnt lgkmcnt(4)
  v_mfma_f32_32x32x16_bf16 v[184:199], v[240:243], v[44:47], v[184:199]
  ds_read_b128 v[240:243], v1 offset:13312
  v_rcp_f32 v216, v216
  v_rcp_f32 v218, v218
  v_mul_f32 v213, v156, v164
  v_mfma_f32_32x32x16_bf16 v[184:199], v[244:247], v[48:51], v[184:199]
  ds_read_b128 v[244:247], v1 offset:14336
  v_mul_f32 v215, v157, v165
  v_mul_f32 v217, v158, v166
  v_mul_f32 v219, v159, v167
  v_mul_f32 v156, v213, v212
  v_mul_f32 v157, v215, v214
  v_mfma_f32_32x32x16_bf16 v[184:199], v[200:203], v[52:55], v[184:199]
  ds_read_b128 v[200:203], v1 offset:15360
  v_mul_f32 v158, v217, v216
  v_mul_f32 v159, v219, v218
  v_cvt_pk_bf16_f32 v252, v152, v153
  v_cvt_pk_bf16_f32 v253, v154, v155
  v_cvt_pk_bf16_f32 v254, v156, v157
  v_mfma_f32_32x32x16_bf16 v[184:199], v[204:207], v[56:59], v[184:199]
  ds_read_b128 v[204:207], v1 offset:16384
  buffer_load_dwordx4 v1, s[8:11], s57 offen offset:3072 sc1 lds
  v_cvt_pk_bf16_f32 v255, v158, v159
  v_mul_f32 v212, v168, v223
  s_waitcnt lgkmcnt(4)
  v_mfma_f32_32x32x16_bf16 v[184:199], v[224:227], v[60:63], v[184:199]
  ds_read_b128 v[224:227], v1 offset:17408
  buffer_store_dwordx4 v[252:255], v1, s[8:11], s59 offen offset:2048 sc1
  v_mul_f32 v214, v169, v223
  v_mul_f32 v216, v170, v223
  v_mfma_f32_32x32x16_bf16 v[184:199], v[228:231], v[64:67], v[184:199]
  ds_read_b128 v[228:231], v1 offset:18432
  v_mul_f32 v218, v171, v223
  v_exp_f32 v212, v212
  v_exp_f32 v214, v214
  v_mfma_f32_32x32x16_bf16 v[184:199], v[232:235], v[68:71], v[184:199]
  ds_read_b128 v[232:235], v1 offset:19456
  v_exp_f32 v216, v216
  v_exp_f32 v218, v218
  v_fma_f32 v212, v212, v221, v221
  v_mfma_f32_32x32x16_bf16 v[184:199], v[236:239], v[72:75], v[184:199]
  ds_read_b128 v[236:239], v1 offset:20480
  v_fma_f32 v214, v214, v221, v221
  v_fma_f32 v216, v216, v221, v221
  v_fma_f32 v218, v218, v221, v221
  v_rcp_f32 v212, v212
  s_waitcnt lgkmcnt(4)
  v_mfma_f32_32x32x16_bf16 v[184:199], v[240:243], v[76:79], v[184:199]
  ds_read_b128 v[240:243], v1 offset:21504
  v_rcp_f32 v214, v214
  v_rcp_f32 v216, v216
  v_mul_f32 v213, v168, v176
  v_mfma_f32_32x32x16_bf16 v[184:199], v[244:247], v[80:83], v[184:199]
  ds_read_b128 v[244:247], v1 offset:22528
  s_waitcnt vmcnt(11)
  s_barrier
  v_rcp_f32 v218, v218
  v_mul_f32 v215, v169, v177
  v_mul_f32 v217, v170, v178
  v_mfma_f32_32x32x16_bf16 v[184:199], v[200:203], v[84:87], v[184:199]
  ds_read_b128 v[200:203], v1 offset:23552
  s_add_u32 m0, s20, 134144
  s_add_u32 s57, s4, 0
  buffer_load_dwordx4 v1, s[8:11], s57 offen offset:0 sc1 lds
  v_mfma_f32_32x32x16_bf16 v[184:199], v[204:207], v[88:91], v[184:199]
  ds_read_b128 v[204:207], v1 offset:24576
  v_mul_f32 v219, v171, v179
  v_mul_f32 v168, v213, v212
  v_mul_f32 v169, v215, v214
  v_mul_f32 v170, v217, v216
  v_mul_f32 v171, v219, v218
  s_waitcnt lgkmcnt(4)
  v_mfma_f32_32x32x16_bf16 v[184:199], v[224:227], v[92:95], v[184:199]
  ds_read_b128 v[224:227], v1 offset:25600
  v_mul_f32 v212, v172, v223
  v_mul_f32 v214, v173, v223
  v_mul_f32 v216, v174, v223
  v_mul_f32 v218, v175, v223
  v_mul_f32 v213, v172, v180
  v_mfma_f32_32x32x16_bf16 v[184:199], v[228:231], v[96:99], v[184:199]
  ds_read_b128 v[228:231], v1 offset:26624
  v_exp_f32 v212, v212
  v_exp_f32 v214, v214
  v_fma_f32 v212, v212, v221, v221
  v_mfma_f32_32x32x16_bf16 v[184:199], v[232:235], v[100:103], v[184:199]
  ds_read_b128 v[232:235], v1 offset:27648
  buffer_load_dwordx4 v1, s[8:11], s57 offen offset:1024 sc1 lds
  v_exp_f32 v216, v216
  v_mfma_f32_32x32x16_bf16 v[184:199], v[236:239], v[104:107], v[184:199]
  ds_read_b128 v[236:239], v1 offset:28672
  v_exp_f32 v218, v218
  v_fma_f32 v214, v214, v221, v221
  v_fma_f32 v216, v216, v221, v221
  v_fma_f32 v218, v218, v221, v221
  s_waitcnt lgkmcnt(4)
  v_mfma_f32_32x32x16_bf16 v[184:199], v[240:243], v[108:111], v[184:199]
  ds_read_b128 v[240:243], v1 offset:29696
  v_rcp_f32 v212, v212
  v_rcp_f32 v214, v214
  v_mul_f32 v215, v173, v181
  v_mfma_f32_32x32x16_bf16 v[184:199], v[244:247], v[112:115], v[184:199]
  ds_read_b128 v[244:247], v1 offset:30720
  v_rcp_f32 v216, v216
  v_rcp_f32 v218, v218
  v_mul_f32 v217, v174, v182
  v_mfma_f32_32x32x16_bf16 v[184:199], v[200:203], v[116:119], v[184:199]
  ds_read_b128 v[200:203], v1 offset:31744
  buffer_load_dwordx4 v1, s[8:11], s57 offen offset:2048 sc1 lds
  v_mul_f32 v219, v175, v183
  v_mul_f32 v172, v213, v212
  v_mfma_f32_32x32x16_bf16 v[184:199], v[204:207], v[120:123], v[184:199]
  ds_read_b128 v[204:207], v1 offset:32768
  v_mul_f32 v173, v215, v214
  v_mul_f32 v174, v217, v216
  v_mul_f32 v175, v219, v218
  v_cvt_pk_bf16_f32 v248, v168, v169
  v_cvt_pk_bf16_f32 v249, v170, v171
  s_waitcnt lgkmcnt(4)
  v_mfma_f32_32x32x16_bf16 v[184:199], v[224:227], v[124:127], v[184:199]
  ds_read_b128 v[224:227], v1 offset:33792
  v_cvt_pk_bf16_f32 v250, v172, v173
  v_cvt_pk_bf16_f32 v251, v174, v175
  v_mfma_f32_32x32x16_bf16 v[184:199], v[228:231], v[128:131], v[184:199]
  ds_read_b128 v[228:231], v1 offset:34816
  buffer_store_dwordx4 v[248:251], v1, s[8:11], s59 offen offset:0 sc1
  v_mfma_f32_32x32x16_bf16 v[184:199], v[232:235], v[132:135], v[184:199]
  ds_read_b128 v[232:235], v1 offset:35840
  buffer_load_dwordx4 v1, s[8:11], s57 offen offset:3072 sc1 lds
  v_mfma_f32_32x32x16_bf16 v[184:199], v[236:239], v[208:211], v[184:199]
  ds_read_b128 v[236:239], v1 offset:36864
  s_waitcnt lgkmcnt(4)
  v_mfma_f32_32x32x16_bf16 v[136:151], v[240:243], v[24:27], 0
  ds_read_b128 v[240:243], v1 offset:37888
  v_mfma_f32_32x32x16_bf16 v[136:151], v[244:247], v[28:31], v[136:151]
  ds_read_b128 v[244:247], v1 offset:38912
  v_mfma_f32_32x32x16_bf16 v[136:151], v[200:203], v[32:35], v[136:151]
  ds_read_b128 v[200:203], v1 offset:39936
  s_add_u32 m0, s20, 138240
  s_add_u32 s57, s4, 4096
  buffer_load_dwordx4 v1, s[8:11], s57 offen offset:0 sc1 lds
  v_mfma_f32_32x32x16_bf16 v[136:151], v[204:207], v[36:39], v[136:151]
  ds_read_b128 v[204:207], v1 offset:40960
  v_mul_f32 v212, v184, v223
  v_mul_f32 v214, v185, v223
  v_mul_f32 v216, v186, v223
  v_mul_f32 v218, v187, v223
  v_mul_f32 v213, v184, v192
  s_waitcnt lgkmcnt(4)
  v_mfma_f32_32x32x16_bf16 v[136:151], v[224:227], v[40:43], v[136:151]
  ds_read_b128 v[224:227], v1 offset:41984
  v_exp_f32 v212, v212
  v_exp_f32 v214, v214
  v_fma_f32 v212, v212, v221, v221
  v_mfma_f32_32x32x16_bf16 v[136:151], v[228:231], v[44:47], v[136:151]
  ds_read_b128 v[228:231], v1 offset:43008
  v_exp_f32 v216, v216
  v_exp_f32 v218, v218
  v_fma_f32 v214, v214, v221, v221
  v_mfma_f32_32x32x16_bf16 v[136:151], v[232:235], v[48:51], v[136:151]
  ds_read_b128 v[232:235], v1 offset:44032
  buffer_load_dwordx4 v1, s[8:11], s57 offen offset:1024 sc1 lds
  v_fma_f32 v216, v216, v221, v221
  v_fma_f32 v218, v218, v221, v221
  v_mfma_f32_32x32x16_bf16 v[136:151], v[236:239], v[52:55], v[136:151]
  ds_read_b128 v[236:239], v1 offset:45056
  v_rcp_f32 v212, v212
  v_rcp_f32 v214, v214
  v_mul_f32 v215, v185, v193
  s_waitcnt lgkmcnt(4)
  v_mfma_f32_32x32x16_bf16 v[136:151], v[240:243], v[56:59], v[136:151]
  ds_read_b128 v[240:243], v1 offset:46080
  v_rcp_f32 v216, v216
  v_rcp_f32 v218, v218
  v_mul_f32 v217, v186, v194
  v_mfma_f32_32x32x16_bf16 v[136:151], v[244:247], v[60:63], v[136:151]
  ds_read_b128 v[244:247], v1 offset:47104
  v_mul_f32 v219, v187, v195
  v_mul_f32 v184, v213, v212
  v_mul_f32 v185, v215, v214
  v_mul_f32 v186, v217, v216
  v_mul_f32 v187, v219, v218
  v_mfma_f32_32x32x16_bf16 v[136:151], v[200:203], v[64:67], v[136:151]
  ds_read_b128 v[200:203], v1 offset:48128
  buffer_load_dwordx4 v1, s[8:11], s57 offen offset:2048 sc1 lds
  v_mul_f32 v212, v188, v223
  v_mul_f32 v214, v189, v223
  v_mfma_f32_32x32x16_bf16 v[136:151], v[204:207], v[68:71], v[136:151]
  ds_read_b128 v[204:207], v1 offset:49152
  v_mul_f32 v216, v190, v223
  v_mul_f32 v218, v191, v223
  v_exp_f32 v212, v212
  v_mul_f32 v213, v188, v196
  s_waitcnt lgkmcnt(4)
  v_mfma_f32_32x32x16_bf16 v[136:151], v[224:227], v[72:75], v[136:151]
  ds_read_b128 v[224:227], v1 offset:50176
  v_exp_f32 v214, v214
  v_exp_f32 v216, v216
  v_fma_f32 v212, v212, v221, v221
  v_mfma_f32_32x32x16_bf16 v[136:151], v[228:231], v[76:79], v[136:151]
  ds_read_b128 v[228:231], v1 offset:51200
  v_exp_f32 v218, v218
  v_fma_f32 v214, v214, v221, v221
  v_fma_f32 v216, v216, v221, v221
  v_fma_f32 v218, v218, v221, v221
  v_mfma_f32_32x32x16_bf16 v[136:151], v[232:235], v[80:83], v[136:151]
  ds_read_b128 v[232:235], v1 offset:52224
  buffer_load_dwordx4 v1, s[8:11], s57 offen offset:3072 sc1 lds
  v_rcp_f32 v212, v212
  v_mfma_f32_32x32x16_bf16 v[136:151], v[236:239], v[84:87], v[136:151]
  ds_read_b128 v[236:239], v1 offset:53248
  v_rcp_f32 v214, v214
  v_rcp_f32 v216, v216
  v_mul_f32 v215, v189, v197
  s_waitcnt lgkmcnt(4)
  v_mfma_f32_32x32x16_bf16 v[136:151], v[240:243], v[88:91], v[136:151]
  ds_read_b128 v[240:243], v1 offset:54272
  s_waitcnt vmcnt(10)
  s_waitcnt vmcnt(9)
  s_barrier
  v_rcp_f32 v218, v218
  v_mul_f32 v217, v190, v198
  v_mul_f32 v219, v191, v199
  v_mfma_f32_32x32x16_bf16 v[136:151], v[244:247], v[92:95], v[136:151]
  ds_read_b128 v[244:247], v1 offset:55296
  v_mul_f32 v188, v213, v212
  v_mul_f32 v189, v215, v214
  v_mul_f32 v190, v217, v216
  v_mul_f32 v191, v219, v218
  v_cvt_pk_bf16_f32 v252, v184, v185
  v_mfma_f32_32x32x16_bf16 v[136:151], v[200:203], v[96:99], v[136:151]
  ds_read_b128 v[200:203], v1 offset:56320
  v_cvt_pk_bf16_f32 v253, v186, v187
  v_cvt_pk_bf16_f32 v254, v188, v189
  v_cvt_pk_bf16_f32 v255, v190, v191
  v_mfma_f32_32x32x16_bf16 v[136:151], v[204:207], v[100:103], v[136:151]
  ds_read_b128 v[204:207], v1 offset:57344
  buffer_store_dwordx4 v[252:255], v1, s[8:11], s35 offen offset:3072 sc1
  s_waitcnt lgkmcnt(4)
  v_mfma_f32_32x32x16_bf16 v[136:151], v[224:227], v[104:107], v[136:151]
  ds_read_b128 v[224:227], v1 offset:58368
  v_mfma_f32_32x32x16_bf16 v[136:151], v[228:231], v[108:111], v[136:151]
  ds_read_b128 v[228:231], v12 offset:38912
  v_mfma_f32_32x32x16_bf16 v[136:151], v[232:235], v[112:115], v[136:151]
  ds_read_b128 v[232:235], v12 offset:39936
  v_mfma_f32_32x32x16_bf16 v[136:151], v[236:239], v[116:119], v[136:151]
  ds_read_b128 v[236:239], v12 offset:40960
  s_waitcnt lgkmcnt(4)
  v_mfma_f32_32x32x16_bf16 v[136:151], v[240:243], v[120:123], v[136:151]
  ds_read_b128 v[240:243], v12 offset:41984
  v_mfma_f32_32x32x16_bf16 v[136:151], v[244:247], v[124:127], v[136:151]
  ds_read_b128 v[244:247], v12 offset:43008
  v_mfma_f32_32x32x16_bf16 v[136:151], v[200:203], v[128:131], v[136:151]
  ds_read_b128 v[200:203], v12 offset:44032
  v_mfma_f32_32x32x16_bf16 v[136:151], v[204:207], v[132:135], v[136:151]
  ds_read_b128 v[204:207], v12 offset:45056
  s_waitcnt lgkmcnt(4)
  v_mfma_f32_32x32x16_bf16 v[136:151], v[224:227], v[208:211], v[136:151]
  ds_read_b128 v[224:227], v12 offset:46080
  v_mfma_f32_32x32x16_bf16 v[152:167], v[228:231], v[24:27], 0
  ds_read_b128 v[228:231], v12 offset:47104
  v_mfma_f32_32x32x16_bf16 v[152:167], v[232:235], v[28:31], v[152:167]
  ds_read_b128 v[232:235], v12 offset:48128
  v_mfma_f32_32x32x16_bf16 v[152:167], v[236:239], v[32:35], v[152:167]
  ds_read_b128 v[236:239], v12 offset:49152
  s_waitcnt lgkmcnt(4)
  v_mfma_f32_32x32x16_bf16 v[152:167], v[240:243], v[36:39], v[152:167]
  ds_read_b128 v[240:243], v12 offset:50176
  s_nop 2
  v_mul_f32 v212, v136, v223
  v_mul_f32 v214, v137, v223
  v_mul_f32 v216, v138, v223
  v_mul_f32 v218, v139, v223
  v_mul_f32 v213, v136, v144
  v_mfma_f32_32x32x16_bf16 v[152:167], v[244:247], v[40:43], v[152:167]
  ds_read_b128 v[244:247], v12 offset:51200
  v_exp_f32 v212, v212
  v_exp_f32 v214, v214
  v_fma_f32 v212, v212, v221, v221
  v_mfma_f32_32x32x16_bf16 v[152:167], v[200:203], v[44:47], v[152:167]
  ds_read_b128 v[200:203], v12 offset:52224
  v_exp_f32 v216, v216
  v_exp_f32 v218, v218
  v_fma_f32 v214, v214, v221, v221
  v_mfma_f32_32x32x16_bf16 v[152:167], v[204:207], v[48:51], v[152:167]
  ds_read_b128 v[204:207], v12 offset:53248
  v_fma_f32 v216, v216, v221, v221
  v_fma_f32 v218, v218, v221, v221
  v_rcp_f32 v212, v212
  v_mul_f32 v215, v137, v145
  s_waitcnt lgkmcnt(4)
  v_mfma_f32_32x32x16_bf16 v[152:167], v[224:227], v[52:55], v[152:167]
  ds_read_b128 v[224:227], v12 offset:54272
  v_rcp_f32 v214, v214
  v_rcp_f32 v216, v216
  v_mul_f32 v217, v138, v146
  v_mfma_f32_32x32x16_bf16 v[152:167], v[228:231], v[56:59], v[152:167]
  ds_read_b128 v[228:231], v12 offset:55296
  v_rcp_f32 v218, v218
  v_mul_f32 v219, v139, v147
  v_mul_f32 v136, v213, v212
  v_mul_f32 v137, v215, v214
  v_mfma_f32_32x32x16_bf16 v[152:167], v[232:235], v[60:63], v[152:167]
  ds_read_b128 v[232:235], v12 offset:56320
  v_mul_f32 v138, v217, v216
  v_mul_f32 v139, v219, v218
  v_mul_f32 v212, v140, v223
  v_mul_f32 v214, v141, v223
  v_mul_f32 v216, v142, v223
  v_mfma_f32_32x32x16_bf16 v[152:167], v[236:239], v[64:67], v[152:167]
  ds_read_b128 v[236:239], v12 offset:57344
  v_mul_f32 v218, v143, v223
  v_exp_f32 v212, v212
  v_exp_f32 v214, v214
  s_waitcnt lgkmcnt(4)
  v_mfma_f32_32x32x16_bf16 v[152:167], v[240:243], v[68:71], v[152:167]
  ds_read_b128 v[240:243], v12 offset:58368
  v_exp_f32 v216, v216
  v_exp_f32 v218, v218
  v_fma_f32 v212, v212, v221, v221
  v_mfma_f32_32x32x16_bf16 v[152:167], v[244:247], v[72:75], v[152:167]
  ds_read_b128 v[244:247], v12 offset:59392
  s_waitcnt vmcnt(6)
  s_waitcnt vmcnt(0)
  s_cbranch_vccz Lpub_55
  s_mov_b64 exec, 1
  buffer_store_dword v15, v2, s[8:11], s36 offen offset:192
  s_mov_b64 exec, -1
Lpubr_56:
  s_nop 0
  v_fma_f32 v214, v214, v221, v221
  v_fma_f32 v216, v216, v221, v221
  v_fma_f32 v218, v218, v221, v221
  v_mul_f32 v213, v140, v148
  v_mfma_f32_32x32x16_bf16 v[152:167], v[200:203], v[76:79], v[152:167]
  ds_read_b128 v[200:203], v12 offset:60416
  v_rcp_f32 v212, v212
  v_rcp_f32 v214, v214
  v_mul_f32 v215, v141, v149
  v_mfma_f32_32x32x16_bf16 v[152:167], v[204:207], v[80:83], v[152:167]
  ds_read_b128 v[204:207], v12 offset:61440
  v_rcp_f32 v216, v216
  v_rcp_f32 v218, v218
  v_mul_f32 v217, v142, v150
  s_waitcnt lgkmcnt(4)
  v_mfma_f32_32x32x16_bf16 v[152:167], v[224:227], v[84:87], v[152:167]
  ds_read_b128 v[224:227], v12 offset:62464
  v_mul_f32 v219, v143, v151
  v_mul_f32 v140, v213, v212
  v_mul_f32 v141, v215, v214
  v_mul_f32 v142, v217, v216
  v_mul_f32 v143, v219, v218
  v_mfma_f32_32x32x16_bf16 v[152:167], v[228:231], v[88:91], v[152:167]
  ds_read_b128 v[228:231], v12 offset:63488
  s_barrier
  v_cvt_pk_bf16_f32 v248, v136, v137
  v_cvt_pk_bf16_f32 v249, v138, v139
  v_cvt_pk_bf16_f32 v250, v140, v141
  v_cvt_pk_bf16_f32 v251, v142, v143
  v_mfma_f32_32x32x16_bf16 v[152:167], v[232:235], v[92:95], v[152:167]
  ds_read_b128 v[232:235], v12 offset:64512
  buffer_store_dwordx4 v[248:251], v1, s[8:11], s35 offen offset:2048 sc1
  v_mfma_f32_32x32x16_bf16 v[152:167], v[236:239], v[96:99], v[152:167]
  ds_read_b128 v[236:239], v13 offset:0
  s_waitcnt lgkmcnt(4)
  v_mfma_f32_32x32x16_bf16 v[152:167], v[240:243], v[100:103], v[152:167]
  ds_read_b128 v[240:243], v13 offset:1024
  v_mfma_f32_32x32x16_bf16 v[152:167], v[244:247], v[104:107], v[152:167]
  ds_read_b128 v[244:247], v13 offset:2048
  v_mfma_f32_32x32x16_bf16 v[152:167], v[200:203], v[108:111], v[152:167]
  ds_read_b128 v[200:203], v13 offset:3072
  v_mfma_f32_32x32x16_bf16 v[152:167], v[204:207], v[112:115], v[152:167]
  ds_read_b128 v[204:207], v13 offset:4096
  s_waitcnt lgkmcnt(4)
  v_mfma_f32_32x32x16_bf16 v[152:167], v[224:227], v[116:119], v[152:167]
  ds_read_b128 v[224:227], v13 offset:5120
  v_mfma_f32_32x32x16_bf16 v[152:167], v[228:231], v[120:123], v[152:167]
  ds_read_b128 v[228:231], v13 offset:6144
  v_mfma_f32_32x32x16_bf16 v[152:167], v[232:235], v[124:127], v[152:167]
  ds_read_b128 v[232:235], v13 offset:7168
  v_mfma_f32_32x32x16_bf16 v[152:167], v[236:239], v[128:131], v[152:167]
  ds_read_b128 v[236:239], v13 offset:8192
  s_waitcnt lgkmcnt(4)
  v_mfma_f32_32x32x16_bf16 v[152:167], v[240:243], v[132:135], v[152:167]
  ds_read_b128 v[240:243], v13 offset:9216
  v_mfma_f32_32x32x16_bf16 v[152:167], v[244:247], v[208:211], v[152:167]
  ds_read_b128 v[244:247], v13 offset:10240
  v_mfma_f32_32x32x16_bf16 v[168:183], v[200:203], v[24:27], 0
  ds_read_b128 v[200:203], v13 offset:11264
  v_mfma_f32_32x32x16_bf16 v[168:183], v[204:207], v[28:31], v[168:183]
  ds_read_b128 v[204:207], v13 offset:12288
  s_waitcnt lgkmcnt(4)
  v_mfma_f32_32x32x16_bf16 v[168:183], v[224:227], v[32:35], v[168:183]
  ds_read_b128 v[224:227], v13 offset:13312
  v_mfma_f32_32x32x16_bf16 v[168:183], v[228:231], v[36:39], v[168:183]
  ds_read_b128 v[228:231], v13 offset:14336
  v_mfma_f32_32x32x16_bf16 v[168:183], v[232:235], v[40:43], v[168:183]
  ds_read_b128 v[232:235], v13 offset:15360
  s_cmp_ge_u32 s17, 28
  s_cbranch_scc1 M_ut1
M_down1:
  v_mfma_f32_32x32x16_bf16 v[168:183], v[236:239], v[44:47], v[168:183]
  ds_read_b128 v[236:239], v13 offset:16384
  buffer_load_dword v6, v3, s[8:11], s37 offen offset:192 sc1
  v_mul_f32 v212, v152, v223
  v_mul_f32 v214, v153, v223
  v_mul_f32 v216, v154, v223
  s_waitcnt lgkmcnt(4)
  v_mfma_f32_32x32x16_bf16 v[168:183], v[240:243], v[48:51], v[168:183]
  ds_read_b128 v[240:243], v13 offset:17408
  v_mul_f32 v218, v155, v223
  v_exp_f32 v212, v212
  v_exp_f32 v214, v214
  v_fma_f32 v212, v212, v221, v221
  v_mfma_f32_32x32x16_bf16 v[168:183], v[244:247], v[52:55], v[168:183]
  ds_read_b128 v[244:247], v13 offset:18432
  v_exp_f32 v216, v216
  v_exp_f32 v218, v218
  v_fma_f32 v214, v214, v221, v221
  v_fma_f32 v216, v216, v221, v221
  v_mfma_f32_32x32x16_bf16 v[168:183], v[200:203], v[56:59], v[168:183]
  ds_read_b128 v[200:203], v13 offset:19456
  v_fma_f32 v218, v218, v221, v221
  v_rcp_f32 v212, v212
  v_rcp_f32 v214, v214
  v_mul_f32 v213, v152, v160
  v_mfma_f32_32x32x16_bf16 v[168:183], v[204:207], v[60:63], v[168:183]
  ds_read_b128 v[204:207], v13 offset:20480
  v_rcp_f32 v216, v216
  v_rcp_f32 v218, v218
  v_mul_f32 v215, v153, v161
  v_mul_f32 v217, v154, v162
  s_waitcnt lgkmcnt(4)
  v_mfma_f32_32x32x16_bf16 v[168:183], v[224:227], v[64:67], v[168:183]
  ds_read_b128 v[224:227], v13 offset:21504
  v_mul_f32 v219, v155, v163
  v_mul_f32 v152, v213, v212
  v_mul_f32 v153, v215, v214
  v_mul_f32 v154, v217, v216
  v_mul_f32 v155, v219, v218
  v_mul_f32 v212, v156, v223
  v_mfma_f32_32x32x16_bf16 v[168:183], v[228:231], v[68:71], v[168:183]
  ds_read_b128 v[228:231], v13 offset:22528
  v_mul_f32 v214, v157, v223
  v_mul_f32 v216, v158, v223
  v_mul_f32 v218, v159, v223
  v_exp_f32 v212, v212
  v_mul_f32 v213, v156, v164
  v_mfma_f32_32x32x16_bf16 v[168:183], v[232:235], v[72:75], v[168:183]
  ds_read_b128 v[232:235], v13 offset:23552
  v_exp_f32 v214, v214
  v_exp_f32 v216, v216
  v_fma_f32 v212, v212, v221, v221
  v_mfma_f32_32x32x16_bf16 v[168:183], v[236:239], v[76:79], v[168:183]
  ds_read_b128 v[236:239], v13 offset:24576
  s_waitcnt vmcnt(0)
  v_cmp_ne_u32 s[54:55], 0, v6
  s_nop 0
  s_cmp_eq_u64 s[54:55], exec
  s_cbranch_scc0 M_hE1_s
M_hE1:
  s_cbranch_vccz Lacq_61
Lacqr_62:
  s_nop 0
  s_add_u32 s56, s39, 4096
  buffer_load_dwordx4 v[24:27], v1, s[8:11], s56 offen offset:1024 sc1
  s_waitcnt lgkmcnt(4)
  v_mfma_f32_32x32x16_bf16 v[168:183], v[240:243], v[80:83], v[168:183]
  ds_read_b128 v[240:243], v13 offset:25600
  v_exp_f32 v218, v218
  v_fma_f32 v214, v214, v221, v221
  v_fma_f32 v216, v216, v221, v221
  v_fma_f32 v218, v218, v221, v221
  v_mfma_f32_32x32x16_bf16 v[168:183], v[244:247], v[84:87], v[168:183]
  ds_read_b128 v[244:247], v13 offset:26624
  s_add_u32 s56, s39, 4096
  buffer_load_dwordx4 v[28:31], v1, s[8:11], s56 offen offset:2048 sc1
  v_mul_f32 v215, v157, v165
  v_mfma_f32_32x32x16_bf16 v[168:183], v[200:203], v[88:91], v[168:183]
  ds_read_b128 v[200:203], v13 offset:27648
  v_rcp_f32 v212, v212
  v_rcp_f32 v214, v214
  v_mul_f32 v217, v158, v166
  v_mfma_f32_32x32x16_bf16 v[168:183], v[204:207], v[92:95], v[168:183]
  ds_read_b128 v[204:207], v13 offset:28672
  s_add_u32 s56, s39, 4096
  buffer_load_dwordx4 v[32:35], v1, s[8:11], s56 offen offset:0 sc1
  v_mul_f32 v219, v159, v167
  s_waitcnt lgkmcnt(4)
  v_mfma_f32_32x32x16_bf16 v[168:183], v[224:227], v[96:99], v[168:183]
  ds_read_b128 v[224:227], v13 offset:29696
  v_rcp_f32 v216, v216
  v_rcp_f32 v218, v218
  v_mul_f32 v156, v213, v212
  v_mfma_f32_32x32x16_bf16 v[168:183], v[228:231], v[100:103], v[168:183]
  ds_read_b128 v[228:231], v13 offset:30720
  s_add_u32 s56, s39, 0
  buffer_load_dwordx4 v[36:39], v1, s[8:11], s56 offen offset:3072 sc1
  v_mul_f32 v157, v215, v214
  v_mfma_f32_32x32x16_bf16 v[168:183], v[232:235], v[104:107], v[168:183]
  ds_read_b128 v[232:235], v13 offset:31744
  v_mul_f32 v158, v217, v216
  v_mul_f32 v159, v219, v218
  v_lshlrev_b32 v88, 16, v16
  v_and_b32 v89, 0xffff0000, v16
  v_lshlrev_b32 v90, 16, v17
  v_mfma_f32_32x32x16_bf16 v[168:183], v[236:239], v[108:111], v[168:183]
  s_add_u32 s56, s39, 12288
  buffer_load_dwordx4 v[40:43], v1, s[8:11], s56 offen offset:0 sc1
  v_and_b32 v91, 0xffff0000, v17
  v_lshlrev_b32 v92, 16, v18
  s_waitcnt lgkmcnt(4)
  v_mfma_f32_32x32x16_bf16 v[168:183], v[240:243], v[112:115], v[168:183]
  v_and_b32 v93, 0xffff0000, v18
  v_lshlrev_b32 v94, 16, v19
  v_and_b32 v95, 0xffff0000, v19
  v_lshlrev_b32 v96, 16, v20
  v_and_b32 v97, 0xffff0000, v20
  v_mfma_f32_32x32x16_bf16 v[168:183], v[244:247], v[116:119], v[168:183]
  s_add_u32 s56, s39, 12288
  buffer_load_dwordx4 v[44:47], v1, s[8:11], s56 offen offset:1024 sc1
  v_lshlrev_b32 v98, 16, v21
  v_and_b32 v99, 0xffff0000, v21
  v_mfma_f32_32x32x16_bf16 v[168:183], v[200:203], v[120:123], v[168:183]
  v_lshlrev_b32 v100, 16, v22
  v_and_b32 v101, 0xffff0000, v22
  v_lshlrev_b32 v102, 16, v23
  v_and_b32 v103, 0xffff0000, v23
  v_cvt_pk_bf16_f32 v252, v152, v153
  s_waitcnt lgkmcnt(3)
  v_mfma_f32_32x32x16_bf16 v[168:183], v[204:207], v[124:127], v[168:183]
  s_add_u32 s56, s39, 8192
  buffer_load_dwordx4 v[48:51], v1, s[8:11], s56 offen offset:3072 sc1
  v_cvt_pk_bf16_f32 v253, v154, v155
  v_cvt_pk_bf16_f32 v254, v156, v157
  s_waitcnt lgkmcnt(2)
  v_mfma_f32_32x32x16_bf16 v[168:183], v[224:227], v[128:131], v[168:183]
  v_cvt_pk_bf16_f32 v255, v158, v159
  s_xor_b32 s6, s16, 1
  s_mul_i32 s6, s6, 12288
  s_add_u32 s6, s6, 55296
  v_add_u32 v201, s6, v1
  s_waitcnt lgkmcnt(1)
  v_mfma_f32_32x32x16_bf16 v[168:183], v[228:231], v[132:135], v[168:183]
  buffer_store_dwordx4 v[252:255], v1, s[8:11], s35 offen offset:1024 sc1
  s_add_u32 s56, s39, 8192
  buffer_load_dwordx4 v[52:55], v1, s[8:11], s56 offen offset:2048 sc1
  s_waitcnt lgkmcnt(0)
  v_mfma_f32_32x32x16_bf16 v[168:183], v[232:235], v[208:211], v[168:183]
  s_barrier
  s_add_u32 s56, s39, 16384
  buffer_load_dwordx4 v[56:59], v1, s[8:11], s56 offen offset:3072 sc1
  s_xor_b32 s6, s16, 2
  s_mul_i32 s6, s6, 12288
  s_add_u32 s6, s6, 59392
  v_add_u32 v202, s6, v1
  s_xor_b32 s6, s16, 3
  s_mul_i32 s6, s6, 12288
  s_add_u32 s6, s6, 63488
  v_add_u32 v203, s6, v1
  s_mul_i32 s6, s16, 12288
  s_add_u32 s6, s6, 55296
  v_add_u32 v200, s6, v1
  v_mul_u32_u24 v10, 224, v0
  v_lshrrev_b32 v11, 7, v2
  v_mul_f32 v212, v168, v223
  v_mul_f32 v214, v169, v223
  v_mul_f32 v216, v170, v223
  s_waitcnt vmcnt(9)
  v_mfma_f32_32x32x16_bf16 v[184:199], a[132:135], v[24:27], 0
  s_add_u32 s56, s39, 20480
  buffer_load_dwordx4 v[60:63], v1, s[8:11], s56 offen offset:0 sc1
  v_mul_f32 v218, v171, v223
  v_exp_f32 v212, v212
  v_exp_f32 v214, v214
  v_exp_f32 v216, v216
  v_fma_f32 v212, v212, v221, v221
  v_mfma_f32_32x32x16_bf16 v[136:151], a[20:23], v[24:27], 0
  v_exp_f32 v218, v218
  v_fma_f32 v214, v214, v221, v221
  v_fma_f32 v216, v216, v221, v221
  v_fma_f32 v218, v218, v221, v221
  v_rcp_f32 v212, v212
  v_rcp_f32 v214, v214
  v_rcp_f32 v216, v216
  s_waitcnt vmcnt(9)
  v_mfma_f32_32x32x16_bf16 v[184:199], a[136:139], v[28:31], v[184:199]
  s_add_u32 s56, s39, 16384
  buffer_load_dwordx4 v[64:67], v1, s[8:11], s56 offen offset:2048 sc1
  v_rcp_f32 v218, v218
  v_mul_f32 v213, v168, v176
  v_mul_f32 v215, v169, v177
  v_mul_f32 v217, v170, v178
  v_mul_f32 v219, v171, v179
  v_mul_f32 v168, v213, v212
  v_mul_f32 v169, v215, v214
  v_mfma_f32_32x32x16_bf16 v[136:151], a[24:27], v[28:31], v[136:151]
  v_mul_f32 v170, v217, v216
  v_mul_f32 v171, v219, v218
  v_mul_f32 v212, v172, v223
  v_mul_f32 v214, v173, v223
  v_mul_f32 v216, v174, v223
  v_mul_f32 v218, v175, v223
  v_exp_f32 v212, v212
  v_exp_f32 v214, v214
  v_fma_f32 v212, v212, v221, v221
  s_waitcnt vmcnt(9)
  v_mfma_f32_32x32x16_bf16 v[184:199], a[128:131], v[32:35], v[184:199]
  s_add_u32 s56, s39, 16384
  buffer_load_dwordx4 v[68:71], v1, s[8:11], s56 offen offset:1024 sc1
  v_exp_f32 v216, v216
  v_exp_f32 v218, v218
  v_fma_f32 v214, v214, v221, v221
  v_fma_f32 v216, v216, v221, v221
  v_fma_f32 v218, v218, v221, v221
  v_mul_f32 v213, v172, v180
  v_mfma_f32_32x32x16_bf16 v[136:151], a[16:19], v[32:35], v[136:151]
  v_rcp_f32 v212, v212
  v_rcp_f32 v214, v214
  v_rcp_f32 v216, v216
  v_rcp_f32 v218, v218
  v_mul_f32 v215, v173, v181
  v_mul_f32 v217, v174, v182
  v_mul_f32 v219, v175, v183
  s_waitcnt vmcnt(9)
  v_mfma_f32_32x32x16_bf16 v[184:199], a[124:127], v[36:39], v[184:199]
  s_add_u32 s56, s39, 24576
  buffer_load_dwordx4 v[72:75], v1, s[8:11], s56 offen offset:2048 sc1
  v_mul_f32 v172, v213, v212
  v_mul_f32 v173, v215, v214
  v_mul_f32 v174, v217, v216
  v_mul_f32 v175, v219, v218
  v_cvt_pk_bf16_f32 v248, v168, v169
  v_cvt_pk_bf16_f32 v249, v170, v171
  v_cvt_pk_bf16_f32 v250, v172, v173
  v_cvt_pk_bf16_f32 v251, v174, v175
  v_mfma_f32_32x32x16_bf16 v[136:151], a[12:15], v[36:39], v[136:151]
  buffer_store_dwordx4 v[248:251], v1, s[8:11], s35 offen offset:0 sc1
  v_lshl_add_u32 v10, v11, 4, v10
  s_waitcnt vmcnt(10)
  v_mfma_f32_32x32x16_bf16 v[184:199], a[160:163], v[40:43], v[184:199]
  s_add_u32 s56, s39, 24576
  buffer_load_dwordx4 v[76:79], v1, s[8:11], s56 offen offset:3072 sc1
  v_mfma_f32_32x32x16_bf16 v[136:151], a[48:51], v[40:43], v[136:151]
  s_waitcnt vmcnt(10)
  v_mfma_f32_32x32x16_bf16 v[184:199], a[164:167], v[44:47], v[184:199]
  s_add_u32 s56, s39, 24576
  buffer_load_dwordx4 v[80:83], v1, s[8:11], s56 offen offset:1024 sc1
  v_mfma_f32_32x32x16_bf16 v[136:151], a[52:55], v[44:47], v[136:151]
  s_waitcnt vmcnt(10)
  v_mfma_f32_32x32x16_bf16 v[184:199], a[156:159], v[48:51], v[184:199]
  s_add_u32 s56, s39, 24576
  buffer_load_dwordx4 v[84:87], v1, s[8:11], s56 offen offset:0 sc1
  v_mfma_f32_32x32x16_bf16 v[136:151], a[44:47], v[48:51], v[136:151]
  s_waitcnt vmcnt(9)
  v_mfma_f32_32x32x16_bf16 v[184:199], a[152:155], v[52:55], v[184:199]
  s_add_u32 s56, s38, 4096
  buffer_load_dwordx4 v[24:27], v1, s[8:11], s56 offen offset:1024 sc1
  v_mfma_f32_32x32x16_bf16 v[136:151], a[40:43], v[52:55], v[136:151]
  s_waitcnt vmcnt(9)
  v_mfma_f32_32x32x16_bf16 v[184:199], a[188:191], v[56:59], v[184:199]
  s_add_u32 s56, s38, 4096
  buffer_load_dwordx4 v[28:31], v1, s[8:11], s56 offen offset:2048 sc1
  v_mfma_f32_32x32x16_bf16 v[136:151], a[76:79], v[56:59], v[136:151]
  s_waitcnt vmcnt(9)
  v_mfma_f32_32x32x16_bf16 v[184:199], a[192:195], v[60:63], v[184:199]
  s_add_u32 s56, s38, 4096
  buffer_load_dwordx4 v[32:35], v1, s[8:11], s56 offen offset:0 sc1
  v_mfma_f32_32x32x16_bf16 v[136:151], a[80:83], v[60:63], v[136:151]
  s_waitcnt vmcnt(6)
  s_cbranch_vccz Lpub_63
  s_mov_b64 exec, 1
  buffer_store_dword v15, v2, s[8:11], s36 offen offset:128
  s_mov_b64 exec, -1
Lpubr_64:
  s_nop 0
  v_mfma_f32_32x32x16_bf16 v[184:199], a[184:187], v[64:67], v[184:199]
  s_add_u32 s56, s38, 0
  buffer_load_dwordx4 v[36:39], v1, s[8:11], s56 offen offset:3072 sc1
  v_mfma_f32_32x32x16_bf16 v[136:151], a[72:75], v[64:67], v[136:151]
  v_mfma_f32_32x32x16_bf16 v[184:199], a[180:183], v[68:71], v[184:199]
  s_add_u32 s56, s38, 12288
  buffer_load_dwordx4 v[40:43], v1, s[8:11], s56 offen offset:0 sc1
  v_mfma_f32_32x32x16_bf16 v[136:151], a[68:71], v[68:71], v[136:151]
  v_mfma_f32_32x32x16_bf16 v[184:199], a[216:219], v[72:75], v[184:199]
  s_add_u32 s56, s38, 12288
  buffer_load_dwordx4 v[44:47], v1, s[8:11], s56 offen offset:1024 sc1
  v_mfma_f32_32x32x16_bf16 v[136:151], a[104:107], v[72:75], v[136:151]
  s_waitcnt vmcnt(9)
  v_mfma_f32_32x32x16_bf16 v[184:199], a[220:223], v[76:79], v[184:199]
  s_add_u32 s56, s38, 8192
  buffer_load_dwordx4 v[48:51], v1, s[8:11], s56 offen offset:3072 sc1
  v_mfma_f32_32x32x16_bf16 v[136:151], a[108:111], v[76:79], v[136:151]
  s_waitcnt vmcnt(9)
  v_mfma_f32_32x32x16_bf16 v[184:199], a[212:215], v[80:83], v[184:199]
  s_add_u32 s56, s38, 8192
  buffer_load_dwordx4 v[52:55], v1, s[8:11], s56 offen offset:2048 sc1
  v_mfma_f32_32x32x16_bf16 v[136:151], a[100:103], v[80:83], v[136:151]
  s_waitcnt vmcnt(9)
  v_mfma_f32_32x32x16_bf16 v[184:199], a[208:211], v[84:87], v[184:199]
  s_add_u32 s56, s38, 16384
  buffer_load_dwordx4 v[56:59], v1, s[8:11], s56 offen offset:3072 sc1
  v_mfma_f32_32x32x16_bf16 v[136:151], a[96:99], v[84:87], v[136:151]
  s_waitcnt vmcnt(9)
  v_mfma_f32_32x32x16_bf16 v[104:119], a[132:135], v[24:27], 0
  s_add_u32 s56, s38, 20480
  buffer_load_dwordx4 v[60:63], v1, s[8:11], s56 offen offset:0 sc1
  v_mfma_f32_32x32x16_bf16 v[88:103], a[20:23], v[24:27], v[88:103]
  s_waitcnt vmcnt(9)
  v_mfma_f32_32x32x16_bf16 v[104:119], a[136:139], v[28:31], v[104:119]
  s_add_u32 s56, s38, 16384
  buffer_load_dwordx4 v[64:67], v1, s[8:11], s56 offen offset:2048 sc1
  v_mfma_f32_32x32x16_bf16 v[88:103], a[24:27], v[28:31], v[88:103]
  s_waitcnt vmcnt(9)
  v_mfma_f32_32x32x16_bf16 v[104:119], a[128:131], v[32:35], v[104:119]
  s_add_u32 s56, s38, 16384
  buffer_load_dwordx4 v[68:71], v1, s[8:11], s56 offen offset:1024 sc1
  v_mfma_f32_32x32x16_bf16 v[88:103], a[16:19], v[32:35], v[88:103]
  s_waitcnt vmcnt(8)
  v_mfma_f32_32x32x16_bf16 v[104:119], a[124:127], v[36:39], v[104:119]
  s_add_u32 s56, s38, 24576
  buffer_load_dwordx4 v[72:75], v1, s[8:11], s56 offen offset:2048 sc1
  buffer_load_dword v6, v3, s[8:11], s37 offen offset:128 sc1
  v_mfma_f32_32x32x16_bf16 v[88:103], a[12:15], v[36:39], v[88:103]
  s_waitcnt vmcnt(9)
  v_mfma_f32_32x32x16_bf16 v[104:119], a[160:163], v[40:43], v[104:119]
  s_add_u32 s56, s38, 24576
  buffer_load_dwordx4 v[76:79], v1, s[8:11], s56 offen offset:3072 sc1
  v_mfma_f32_32x32x16_bf16 v[88:103], a[48:51], v[40:43], v[88:103]
  s_waitcnt vmcnt(9)
  v_mfma_f32_32x32x16_bf16 v[104:119], a[164:167], v[44:47], v[104:119]
  s_add_u32 s56, s38, 24576
  buffer_load_dwordx4 v[80:83], v1, s[8:11], s56 offen offset:1024 sc1
  v_mfma_f32_32x32x16_bf16 v[88:103], a[52:55], v[44:47], v[88:103]
  s_waitcnt vmcnt(9)
  v_mfma_f32_32x32x16_bf16 v[104:119], a[156:159], v[48:51], v[104:119]
  s_add_u32 s56, s38, 24576
  buffer_load_dwordx4 v[84:87], v1, s[8:11], s56 offen offset:0 sc1
  v_mfma_f32_32x32x16_bf16 v[88:103], a[44:47], v[48:51], v[88:103]
  s_waitcnt vmcnt(9)
  v_mfma_f32_32x32x16_bf16 v[104:119], a[152:155], v[52:55], v[104:119]
  v_mfma_f32_32x32x16_bf16 v[88:103], a[40:43], v[52:55], v[88:103]
  s_waitcnt vmcnt(8)
  v_mfma_f32_32x32x16_bf16 v[104:119], a[188:191], v[56:59], v[104:119]
  s_waitcnt vmcnt(3)
  v_cmp_ne_u32 s[54:55], 0, v6
  s_nop 0
  s_cmp_eq_u64 s[54:55], exec
  s_cbranch_scc0 M_hL1_s
M_hL1:
  s_cbranch_vccz Lacq_67
Lacqr_68:
  s_nop 0
  v_mfma_f32_32x32x16_bf16 v[88:103], a[76:79], v[56:59], v[88:103]
  s_add_u32 s56, s39, 0
  buffer_load_dwordx4 v[24:27], v1, s[8:11], s56 offen offset:2048 sc1
  v_mfma_f32_32x32x16_bf16 v[104:119], a[192:195], v[60:63], v[104:119]
  s_add_u32 s56, s39, 0
  buffer_load_dwordx4 v[28:31], v1, s[8:11], s56 offen offset:1024 sc1
  v_mfma_f32_32x32x16_bf16 v[88:103], a[80:83], v[60:63], v[88:103]
  s_add_u32 s56, s39, 0
  buffer_load_dwordx4 v[32:35], v1, s[8:11], s56 offen offset:0 sc1
  v_mfma_f32_32x32x16_bf16 v[104:119], a[184:187], v[64:67], v[104:119]
  s_add_u32 s56, s39, 8192
  buffer_load_dwordx4 v[36:39], v1, s[8:11], s56 offen offset:1024 sc1
  v_mfma_f32_32x32x16_bf16 v[88:103], a[72:75], v[64:67], v[88:103]
  v_mfma_f32_32x32x16_bf16 v[104:119], a[180:183], v[68:71], v[104:119]
  s_add_u32 s56, s39, 8192
  buffer_load_dwordx4 v[40:43], v1, s[8:11], s56 offen offset:0 sc1
  v_mfma_f32_32x32x16_bf16 v[88:103], a[68:71], v[68:71], v[88:103]
  v_mfma_f32_32x32x16_bf16 v[104:119], a[216:219], v[72:75], v[104:119]
  s_add_u32 s56, s39, 4096
  buffer_load_dwordx4 v[44:47], v1, s[8:11], s56 offen offset:3072 sc1
  v_mfma_f32_32x32x16_bf16 v[88:103], a[104:107], v[72:75], v[88:103]
  s_waitcnt vmcnt(8)
  v_mfma_f32_32x32x16_bf16 v[104:119], a[220:223], v[76:79], v[104:119]
  s_add_u32 s56, s39, 16384
  buffer_load_dwordx4 v[48:51], v1, s[8:11], s56 offen offset:0 sc1
  v_mfma_f32_32x32x16_bf16 v[88:103], a[108:111], v[76:79], v[88:103]
  s_waitcnt vmcnt(8)
  v_mfma_f32_32x32x16_bf16 v[104:119], a[212:215], v[80:83], v[104:119]
  s_add_u32 s56, s39, 12288
  buffer_load_dwordx4 v[52:55], v1, s[8:11], s56 offen offset:3072 sc1
  v_mfma_f32_32x32x16_bf16 v[88:103], a[100:103], v[80:83], v[88:103]
  s_waitcnt vmcnt(8)
  v_mfma_f32_32x32x16_bf16 v[104:119], a[208:211], v[84:87], v[104:119]
  s_add_u32 s56, s39, 12288
  buffer_load_dwordx4 v[56:59], v1, s[8:11], s56 offen offset:2048 sc1
  v_mfma_f32_32x32x16_bf16 v[88:103], a[96:99], v[84:87], v[88:103]
  s_waitcnt vmcnt(8)
  v_mfma_f32_32x32x16_bf16 v[184:199], a[120:123], v[24:27], v[184:199]
  s_add_u32 s56, s39, 20480
  buffer_load_dwordx4 v[60:63], v1, s[8:11], s56 offen offset:3072 sc1
  v_mfma_f32_32x32x16_bf16 v[136:151], a[8:11], v[24:27], v[136:151]
  s_waitcnt vmcnt(8)
  v_mfma_f32_32x32x16_bf16 v[184:199], a[116:119], v[28:31], v[184:199]
  s_add_u32 s56, s39, 20480
  buffer_load_dwordx4 v[64:67], v1, s[8:11], s56 offen offset:2048 sc1
  v_mfma_f32_32x32x16_bf16 v[136:151], a[4:7], v[28:31], v[136:151]
  s_waitcnt vmcnt(8)
  v_mfma_f32_32x32x16_bf16 v[184:199], a[112:115], v[32:35], v[184:199]
  s_add_u32 s56, s39, 20480
  buffer_load_dwordx4 v[68:71], v1, s[8:11], s56 offen offset:1024 sc1
  v_mfma_f32_32x32x16_bf16 v[136:151], a[0:3], v[32:35], v[136:151]
  s_waitcnt vmcnt(8)
  v_mfma_f32_32x32x16_bf16 v[184:199], a[148:151], v[36:39], v[184:199]
  s_add_u32 s56, s38, 0
  buffer_load_dwordx4 v[72:75], v1, s[8:11], s56 offen offset:2048 sc1
  v_mfma_f32_32x32x16_bf16 v[136:151], a[36:39], v[36:39], v[136:151]
  s_waitcnt vmcnt(8)
  v_mfma_f32_32x32x16_bf16 v[184:199], a[144:147], v[40:43], v[184:199]
  s_add_u32 s56, s38, 0
  buffer_load_dwordx4 v[76:79], v1, s[8:11], s56 offen offset:1024 sc1
  v_mfma_f32_32x32x16_bf16 v[136:151], a[32:35], v[40:43], v[136:151]
  s_waitcnt vmcnt(8)
  v_mfma_f32_32x32x16_bf16 v[184:199], a[140:143], v[44:47], v[184:199]
  s_add_u32 s56, s38, 0
  buffer_load_dwordx4 v[80:83], v1, s[8:11], s56 offen offset:0 sc1
  v_mfma_f32_32x32x16_bf16 v[136:151], a[28:31], v[44:47], v[136:151]
  s_waitcnt vmcnt(8)
  v_mfma_f32_32x32x16_bf16 v[184:199], a[176:179], v[48:51], v[184:199]
  s_add_u32 s56, s38, 8192
  buffer_load_dwordx4 v[84:87], v1, s[8:11], s56 offen offset:1024 sc1
  v_mfma_f32_32x32x16_bf16 v[136:151], a[64:67], v[48:51], v[136:151]
  s_waitcnt vmcnt(8)
  v_mfma_f32_32x32x16_bf16 v[184:199], a[172:175], v[52:55], v[184:199]
  s_add_u32 s56, s38, 8192
  buffer_load_dwordx4 v[24:27], v1, s[8:11], s56 offen offset:0 sc1
  v_mfma_f32_32x32x16_bf16 v[136:151], a[60:63], v[52:55], v[136:151]
  s_waitcnt vmcnt(8)
  v_mfma_f32_32x32x16_bf16 v[184:199], a[168:171], v[56:59], v[184:199]
  s_add_u32 s56, s38, 4096
  buffer_load_dwordx4 v[28:31], v1, s[8:11], s56 offen offset:3072 sc1
  v_mfma_f32_32x32x16_bf16 v[136:151], a[56:59], v[56:59], v[136:151]
  s_waitcnt vmcnt(8)
  v_mfma_f32_32x32x16_bf16 v[184:199], a[204:207], v[60:63], v[184:199]
  s_add_u32 s56, s38, 16384
  buffer_load_dwordx4 v[32:35], v1, s[8:11], s56 offen offset:0 sc1
  v_mfma_f32_32x32x16_bf16 v[136:151], a[92:95], v[60:63], v[136:151]
  s_waitcnt vmcnt(8)
  v_mfma_f32_32x32x16_bf16 v[184:199], a[200:203], v[64:67], v[184:199]
  s_add_u32 s56, s38, 12288
  buffer_load_dwordx4 v[36:39], v1, s[8:11], s56 offen offset:3072 sc1
  v_mfma_f32_32x32x16_bf16 v[136:151], a[88:91], v[64:67], v[136:151]
  s_waitcnt vmcnt(8)
  v_mfma_f32_32x32x16_bf16 v[184:199], a[196:199], v[68:71], v[184:199]
  s_add_u32 s56, s38, 12288
  buffer_load_dwordx4 v[40:43], v1, s[8:11], s56 offen offset:2048 sc1
  v_mfma_f32_32x32x16_bf16 v[136:151], a[84:87], v[68:71], v[136:151]
  s_waitcnt vmcnt(8)
  v_mfma_f32_32x32x16_bf16 v[104:119], a[120:123], v[72:75], v[104:119]
  s_add_u32 s56, s38, 20480
  buffer_load_dwordx4 v[44:47], v1, s[8:11], s56 offen offset:3072 sc1
  v_mfma_f32_32x32x16_bf16 v[88:103], a[8:11], v[72:75], v[88:103]
  s_nop 7
  ds_write_b128 v202, v[136:139] offset:0
  s_waitcnt vmcnt(8)
  v_mfma_f32_32x32x16_bf16 v[104:119], a[116:119], v[76:79], v[104:119]
  s_add_u32 s56, s38, 20480
  buffer_load_dwordx4 v[48:51], v1, s[8:11], s56 offen offset:2048 sc1
  v_mfma_f32_32x32x16_bf16 v[88:103], a[4:7], v[76:79], v[88:103]
  ds_write_b128 v202, v[140:143] offset:1024
  s_waitcnt vmcnt(8)
  v_mfma_f32_32x32x16_bf16 v[104:119], a[112:115], v[80:83], v[104:119]
  s_add_u32 s56, s38, 20480
  buffer_load_dwordx4 v[52:55], v1, s[8:11], s56 offen offset:1024 sc1
  ds_write_b128 v202, v[144:147] offset:2048
  v_mfma_f32_32x32x16_bf16 v[88:103], a[0:3], v[80:83], v[88:103]
  s_waitcnt vmcnt(8)
  v_mfma_f32_32x32x16_bf16 v[104:119], a[148:151], v[84:87], v[104:119]
  ds_write_b128 v202, v[148:151] offset:3072
  v_mfma_f32_32x32x16_bf16 v[88:103], a[36:39], v[84:87], v[88:103]
  s_waitcnt vmcnt(7)
  v_mfma_f32_32x32x16_bf16 v[104:119], a[144:147], v[24:27], v[104:119]
  ds_write_b128 v203, v[184:187] offset:0
  v_mfma_f32_32x32x16_bf16 v[88:103], a[32:35], v[24:27], v[88:103]
  ds_write_b128 v203, v[188:191] offset:1024
  s_waitcnt vmcnt(6)
  v_mfma_f32_32x32x16_bf16 v[104:119], a[140:143], v[28:31], v[104:119]
  v_mfma_f32_32x32x16_bf16 v[88:103], a[28:31], v[28:31], v[88:103]
  ds_write_b128 v203, v[192:195] offset:2048
  s_waitcnt vmcnt(5)
  v_mfma_f32_32x32x16_bf16 v[104:119], a[176:179], v[32:35], v[104:119]
  v_mfma_f32_32x32x16_bf16 v[88:103], a[64:67], v[32:35], v[88:103]
  ds_write_b128 v203, v[196:199] offset:3072
  s_waitcnt vmcnt(4)
  v_mfma_f32_32x32x16_bf16 v[104:119], a[172:175], v[36:39], v[104:119]
  v_mfma_f32_32x32x16_bf16 v[88:103], a[60:63], v[36:39], v[88:103]
  s_waitcnt vmcnt(3)
  v_mfma_f32_32x32x16_bf16 v[104:119], a[168:171], v[40:43], v[104:119]
  v_mfma_f32_32x32x16_bf16 v[88:103], a[56:59], v[40:43], v[88:103]
  s_waitcnt lgkmcnt(0)
  s_barrier
  ds_read_b128 v[208:211], v200 offset:4096
  ds_read_b128 v[212:215], v200 offset:5120
  ds_read_b128 v[216:219], v200 offset:6144
  ds_read_b128 v[220:223], v200 offset:7168
  ds_read_b128 v[224:227], v200 offset:8192
  s_waitcnt vmcnt(2)
  v_mfma_f32_32x32x16_bf16 v[104:119], a[204:207], v[44:47], v[104:119]
  ds_read_b128 v[228:231], v200 offset:9216
  ds_read_b128 v[232:235], v200 offset:10240
  ds_read_b128 v[236:239], v200 offset:11264
  v_mfma_f32_32x32x16_bf16 v[88:103], a[92:95], v[44:47], v[88:103]
  s_waitcnt vmcnt(1)
  v_mfma_f32_32x32x16_bf16 v[104:119], a[200:203], v[48:51], v[104:119]
  v_mfma_f32_32x32x16_bf16 v[88:103], a[88:91], v[48:51], v[88:103]
  s_waitcnt lgkmcnt(3)
  v_add_f32 v208, v208, v224
  v_add_f32 v209, v209, v225
  s_waitcnt vmcnt(0)
  v_mfma_f32_32x32x16_bf16 v[104:119], a[196:199], v[52:55], v[104:119]
  v_add_f32 v210, v210, v226
  v_add_f32 v211, v211, v227
  s_waitcnt lgkmcnt(2)
  v_add_f32 v212, v212, v228
  v_add_f32 v213, v213, v229
  v_add_f32 v214, v214, v230
  v_mfma_f32_32x32x16_bf16 v[88:103], a[84:87], v[52:55], v[88:103]
  v_add_f32 v215, v215, v231
  s_waitcnt lgkmcnt(1)
  v_add_f32 v216, v216, v232
  v_add_f32 v217, v217, v233
  v_add_f32 v218, v218, v234
  v_add_f32 v219, v219, v235
  s_waitcnt lgkmcnt(0)
  v_add_f32 v220, v220, v236
  v_add_f32 v221, v221, v237
  v_add_f32 v222, v222, v238
  v_add_f32 v223, v223, v239
  ds_write_b128 v201, v[104:107] offset:0
  s_nop 0
  v_pk_add_f32 v[88:89], v[88:89], v[208:209]
  v_pk_add_f32 v[90:91], v[90:91], v[210:211]
  v_pk_add_f32 v[92:93], v[92:93], v[212:213]
  v_pk_add_f32 v[94:95], v[94:95], v[214:215]
  v_pk_add_f32 v[96:97], v[96:97], v[216:217]
  ds_write_b128 v201, v[108:111] offset:1024
  v_pk_add_f32 v[98:99], v[98:99], v[218:219]
  v_pk_add_f32 v[100:101], v[100:101], v[220:221]
  v_pk_add_f32 v[102:103], v[102:103], v[222:223]
  ds_write_b128 v201, v[112:115] offset:2048
  ds_write_b128 v201, v[116:119] offset:3072
  s_waitcnt lgkmcnt(0)
  s_barrier
  ds_read_b128 v[240:243], v200 offset:0
  ds_read_b128 v[244:247], v200 offset:1024
  ds_read_b128 v[248:251], v200 offset:2048
  ds_read_b128 v[252:255], v200 offset:3072
  s_waitcnt lgkmcnt(3)
  v_pk_add_f32 v[88:89], v[88:89], v[240:241]
  v_pk_add_f32 v[90:91], v[90:91], v[242:243]
  s_waitcnt lgkmcnt(2)
  v_pk_add_f32 v[92:93], v[92:93], v[244:245]
  v_pk_add_f32 v[94:95], v[94:95], v[246:247]
  s_waitcnt lgkmcnt(1)
  v_pk_add_f32 v[96:97], v[96:97], v[248:249]
  v_pk_add_f32 v[98:99], v[98:99], v[250:251]
  s_waitcnt lgkmcnt(0)
  v_pk_add_f32 v[100:101], v[100:101], v[252:253]
  v_pk_add_f32 v[102:103], v[102:103], v[254:255]
  v_cvt_pk_bf16_f32 v16, v88, v89
  v_cvt_pk_bf16_f32 v17, v90, v91
  v_cvt_pk_bf16_f32 v18, v92, v93
  v_cvt_pk_bf16_f32 v19, v94, v95
  v_cvt_pk_bf16_f32 v20, v96, v97
  v_cvt_pk_bf16_f32 v21, v98, v99
  v_cvt_pk_bf16_f32 v22, v100, v101
  v_cvt_pk_bf16_f32 v23, v102, v103
  v_permlane32_swap_b32 v16, v18
  v_permlane32_swap_b32 v17, v19
  buffer_store_dwordx4 v[16:19], v10, s[12:15], s47 offen offset:0
  v_permlane32_swap_b32 v20, v22
  v_permlane32_swap_b32 v21, v23
  buffer_store_dwordx4 v[20:23], v10, s[12:15], s47 offen offset:32
M_next1:
  s_nop 7
  s_nop 5
M_end:
  s_endpgm
M_pdok_s:
  s_mov_b32 s46, 0
Lpoll_5:
  buffer_load_dwordx4 v[168:171], v11, s[8:11], s58 offen sc1
  s_add_u32 s46, s46, 1
  s_waitcnt vmcnt(0)
  v_min3_u32 v172, v168, v169, v170
  v_min_u32 v172, v172, v171
  v_cmp_ne_u32 s[54:55], 0, v172
  s_cmp_gt_u32 s46, 300000
  s_cbranch_scc1 Lpd_6
  s_cmp_eq_u64 s[54:55], exec
  s_cbranch_scc0 Lpoll_5
Lpd_6:
  s_nop 7
  s_nop 7
  s_branch M_pdok
Lpub_7:
  s_mov_b64 exec, 1
  buffer_store_dword v15, v2, s[8:11], s28 offen offset:256 sc1
  s_mov_b64 exec, -1
  s_branch Lpubr_8
M_sp0:
  s_add_u32 s57, s41, s20
  s_add_u32 s57, s57, 59392
  s_add_u32 m0, s20, 74752
  s_nop 0
  buffer_load_dwordx4 v1, s[8:11], s57 offen offset:0 sc1 lds
  buffer_load_dwordx4 v1, s[8:11], s57 offen offset:1024 sc1 lds
  buffer_load_dwordx4 v1, s[8:11], s57 offen offset:2048 sc1 lds
  buffer_load_dwordx4 v1, s[8:11], s57 offen offset:3072 sc1 lds
  s_add_u32 s57, s41, s20
  s_add_u32 s57, s57, 63488
  s_add_u32 m0, s20, 78848
  s_nop 0
  buffer_load_dwordx4 v1, s[8:11], s57 offen offset:0 sc1 lds
  buffer_load_dwordx4 v1, s[8:11], s57 offen offset:1024 sc1 lds
  buffer_load_dwordx4 v1, s[8:11], s57 offen offset:2048 sc1 lds
  buffer_load_dwordx4 v1, s[8:11], s57 offen offset:3072 sc1 lds
  s_add_u32 s57, s41, s44
  s_add_u32 s57, s57, 89088
  s_add_u32 m0, s44, 0
  s_nop 0
  buffer_load_dwordx4 v1, s[8:11], s57 offen offset:0 sc1 lds
  buffer_load_dwordx4 v1, s[8:11], s57 offen offset:1024 sc1 lds
  buffer_load_dwordx4 v1, s[8:11], s57 offen offset:2048 sc1 lds
  buffer_load_dwordx4 v1, s[8:11], s57 offen offset:3072 sc1 lds
  s_add_u32 s57, s41, s44
  s_add_u32 s57, s57, 93184
  s_add_u32 m0, s44, 4096
  s_nop 0
  buffer_load_dwordx4 v1, s[8:11], s57 offen offset:0 sc1 lds
  buffer_load_dwordx4 v1, s[8:11], s57 offen offset:1024 sc1 lds
  s_waitcnt vmcnt(0)
  s_barrier
  s_branch M_up0
Lacq_11:
  buffer_inv sc1
  s_waitcnt vmcnt(0)
  s_branch Lacqr_12
Lpub_15:
  buffer_wbl2 sc1
  s_waitcnt vmcnt(0)
  buffer_store_dword v10, v1, s[8:11], s56 offen sc1
  s_branch Lpubr_16
Lacq_19:
  buffer_inv sc1
  s_waitcnt vmcnt(0)
  s_branch Lacqr_20
Lpub_21:
  buffer_wbl2 sc1
  s_waitcnt vmcnt(0)
  s_mov_b64 exec, 1
  buffer_store_dword v15, v2, s[8:11], s36 offen offset:64 sc1
  s_mov_b64 exec, -1
  s_branch Lpubr_22
Lpub_23:
  buffer_wbl2 sc1
  s_waitcnt vmcnt(0)
  s_mov_b64 exec, 1
  buffer_store_dword v15, v2, s[8:11], s36 offen offset:0 sc1
  s_mov_b64 exec, -1
  s_branch Lpubr_24
M_ut0:
  v_mfma_f32_32x32x16_bf16 v[168:183], v[236:239], v[44:47], v[168:183]
  ds_read_b128 v[236:239], v13 offset:16384
  v_mul_f32 v212, v152, v223
  v_mul_f32 v214, v153, v223
  v_mul_f32 v216, v154, v223
  v_mul_f32 v218, v155, v223
  v_exp_f32 v212, v212
  s_waitcnt lgkmcnt(4)
  v_mfma_f32_32x32x16_bf16 v[168:183], v[240:243], v[48:51], v[168:183]
  ds_read_b128 v[240:243], v13 offset:17408
  v_exp_f32 v214, v214
  v_exp_f32 v216, v216
  v_exp_f32 v218, v218
  v_mfma_f32_32x32x16_bf16 v[168:183], v[244:247], v[52:55], v[168:183]
  ds_read_b128 v[244:247], v13 offset:18432
  v_fma_f32 v212, v212, v221, v221
  v_fma_f32 v214, v214, v221, v221
  v_fma_f32 v216, v216, v221, v221
  v_fma_f32 v218, v218, v221, v221
  v_rcp_f32 v212, v212
  v_mfma_f32_32x32x16_bf16 v[168:183], v[200:203], v[56:59], v[168:183]
  ds_read_b128 v[200:203], v13 offset:19456
  v_rcp_f32 v214, v214
  v_rcp_f32 v216, v216
  v_rcp_f32 v218, v218
  v_mfma_f32_32x32x16_bf16 v[168:183], v[204:207], v[60:63], v[168:183]
  ds_read_b128 v[204:207], v13 offset:20480
  v_mul_f32 v213, v152, v160
  v_mul_f32 v215, v153, v161
  v_mul_f32 v217, v154, v162
  v_mul_f32 v219, v155, v163
  v_mul_f32 v152, v213, v212
  v_mul_f32 v153, v215, v214
  s_waitcnt lgkmcnt(4)
  v_mfma_f32_32x32x16_bf16 v[168:183], v[224:227], v[64:67], v[168:183]
  ds_read_b128 v[224:227], v13 offset:21504
  v_mul_f32 v154, v217, v216
  v_mul_f32 v155, v219, v218
  v_mul_f32 v212, v156, v223
  v_mul_f32 v214, v157, v223
  v_mul_f32 v216, v158, v223
  v_mul_f32 v218, v159, v223
  v_mfma_f32_32x32x16_bf16 v[168:183], v[228:231], v[68:71], v[168:183]
  ds_read_b128 v[228:231], v13 offset:22528
  v_exp_f32 v212, v212
  v_exp_f32 v214, v214
  v_exp_f32 v216, v216
  v_mfma_f32_32x32x16_bf16 v[168:183], v[232:235], v[72:75], v[168:183]
  ds_read_b128 v[232:235], v13 offset:23552
  v_exp_f32 v218, v218
  v_fma_f32 v212, v212, v221, v221
  v_fma_f32 v214, v214, v221, v221
  v_fma_f32 v216, v216, v221, v221
  v_mfma_f32_32x32x16_bf16 v[168:183], v[236:239], v[76:79], v[168:183]
  ds_read_b128 v[236:239], v13 offset:24576
  v_fma_f32 v218, v218, v221, v221
  v_rcp_f32 v212, v212
  v_rcp_f32 v214, v214
  s_waitcnt lgkmcnt(4)
  v_mfma_f32_32x32x16_bf16 v[168:183], v[240:243], v[80:83], v[168:183]
  ds_read_b128 v[240:243], v13 offset:25600
  v_rcp_f32 v216, v216
  v_rcp_f32 v218, v218
  v_mul_f32 v213, v156, v164
  v_mfma_f32_32x32x16_bf16 v[168:183], v[244:247], v[84:87], v[168:183]
  ds_read_b128 v[244:247], v13 offset:26624
  v_mul_f32 v215, v157, v165
  v_mul_f32 v217, v158, v166
  v_mul_f32 v219, v159, v167
  v_mul_f32 v156, v213, v212
  v_mul_f32 v157, v215, v214
  v_mfma_f32_32x32x16_bf16 v[168:183], v[200:203], v[88:91], v[168:183]
  ds_read_b128 v[200:203], v13 offset:27648
  v_mul_f32 v158, v217, v216
  v_mul_f32 v159, v219, v218
  v_cvt_pk_bf16_f32 v252, v152, v153
  v_cvt_pk_bf16_f32 v253, v154, v155
  v_cvt_pk_bf16_f32 v254, v156, v157
  v_mfma_f32_32x32x16_bf16 v[168:183], v[204:207], v[92:95], v[168:183]
  ds_read_b128 v[204:207], v13 offset:28672
  v_cvt_pk_bf16_f32 v255, v158, v159
  s_waitcnt lgkmcnt(4)
  v_mfma_f32_32x32x16_bf16 v[168:183], v[224:227], v[96:99], v[168:183]
  ds_read_b128 v[224:227], v13 offset:29696
  buffer_store_dwordx4 v[252:255], v1, s[8:11], s59 offen offset:1024 sc1
  v_mfma_f32_32x32x16_bf16 v[168:183], v[228:231], v[100:103], v[168:183]
  ds_read_b128 v[228:231], v13 offset:30720
  v_mfma_f32_32x32x16_bf16 v[168:183], v[232:235], v[104:107], v[168:183]
  ds_read_b128 v[232:235], v13 offset:31744
  v_mfma_f32_32x32x16_bf16 v[168:183], v[236:239], v[108:111], v[168:183]
  s_waitcnt lgkmcnt(4)
  v_mfma_f32_32x32x16_bf16 v[168:183], v[240:243], v[112:115], v[168:183]
  v_mfma_f32_32x32x16_bf16 v[168:183], v[244:247], v[116:119], v[168:183]
  v_mfma_f32_32x32x16_bf16 v[168:183], v[200:203], v[120:123], v[168:183]
  s_waitcnt lgkmcnt(3)
  v_mfma_f32_32x32x16_bf16 v[168:183], v[204:207], v[124:127], v[168:183]
  s_waitcnt lgkmcnt(2)
  v_mfma_f32_32x32x16_bf16 v[168:183], v[224:227], v[128:131], v[168:183]
  s_waitcnt lgkmcnt(1)
  v_mfma_f32_32x32x16_bf16 v[168:183], v[228:231], v[132:135], v[168:183]
  s_waitcnt lgkmcnt(0)
  v_mfma_f32_32x32x16_bf16 v[168:183], v[232:235], v[208:211], v[168:183]
  s_nop 7
  s_nop 4
  v_mul_f32 v212, v168, v223
  v_mul_f32 v214, v169, v223
  v_mul_f32 v216, v170, v223
  v_mul_f32 v218, v171, v223
  v_exp_f32 v212, v212
  v_exp_f32 v214, v214
  v_exp_f32 v216, v216
  v_exp_f32 v218, v218
  v_fma_f32 v212, v212, v221, v221
  v_fma_f32 v214, v214, v221, v221
  v_fma_f32 v216, v216, v221, v221
  v_fma_f32 v218, v218, v221, v221
  v_rcp_f32 v212, v212
  v_rcp_f32 v214, v214
  v_rcp_f32 v216, v216
  v_rcp_f32 v218, v218
  v_mul_f32 v213, v168, v176
  v_mul_f32 v215, v169, v177
  v_mul_f32 v217, v170, v178
  v_mul_f32 v219, v171, v179
  v_mul_f32 v168, v213, v212
  v_mul_f32 v169, v215, v214
  v_mul_f32 v170, v217, v216
  v_mul_f32 v171, v219, v218
  v_mul_f32 v212, v172, v223
  v_mul_f32 v214, v173, v223
  v_mul_f32 v216, v174, v223
  v_mul_f32 v218, v175, v223
  v_exp_f32 v212, v212
  v_exp_f32 v214, v214
  v_exp_f32 v216, v216
  v_exp_f32 v218, v218
  v_fma_f32 v212, v212, v221, v221
  v_fma_f32 v214, v214, v221, v221
  v_fma_f32 v216, v216, v221, v221
  v_fma_f32 v218, v218, v221, v221
  v_rcp_f32 v212, v212
  v_rcp_f32 v214, v214
  v_rcp_f32 v216, v216
  v_rcp_f32 v218, v218
  v_mul_f32 v213, v172, v180
  v_mul_f32 v215, v173, v181
  v_mul_f32 v217, v174, v182
  v_mul_f32 v219, v175, v183
  v_mul_f32 v172, v213, v212
  v_mul_f32 v173, v215, v214
  v_mul_f32 v174, v217, v216
  v_mul_f32 v175, v219, v218
  v_cvt_pk_bf16_f32 v248, v168, v169
  v_cvt_pk_bf16_f32 v249, v170, v171
  v_cvt_pk_bf16_f32 v250, v172, v173
  v_cvt_pk_bf16_f32 v251, v174, v175
  buffer_store_dwordx4 v[248:251], v1, s[8:11], s59 offen offset:2048 sc1
  s_waitcnt vmcnt(7)
  s_waitcnt vmcnt(1)
  s_waitcnt vmcnt(0)
  s_cbranch_vccz Lpub_23
  s_mov_b64 exec, 1
  buffer_store_dword v15, v2, s[8:11], s36 offen offset:0
  s_mov_b64 exec, -1
Lpubr_24:
  s_nop 0
  s_waitcnt vmcnt(0)
  s_waitcnt lgkmcnt(0)
  s_barrier
  s_branch M_next0
M_hE0_s:
  s_mov_b32 s46, 0
Lpoll_25:
  buffer_load_dword v6, v3, s[8:11], s37 offen offset:64 sc1
  s_add_u32 s46, s46, 1
  s_waitcnt vmcnt(0)
  v_cmp_ne_u32 s[54:55], 0, v6
  s_cmp_gt_u32 s46, 300000
  s_cbranch_scc1 Lpd_26
  s_cmp_eq_u64 s[54:55], exec
  s_cbranch_scc0 Lpoll_25
Lpd_26:
  s_nop 7
  s_nop 7
  s_branch M_hE0
Lacq_27:
  buffer_inv sc1
  s_waitcnt vmcnt(0)
  s_branch Lacqr_28
Lpub_29:
  buffer_wbl2 sc1
  s_waitcnt vmcnt(0)
  s_mov_b64 exec, 1
  buffer_store_dword v15, v2, s[8:11], s36 offen offset:0 sc1
  s_mov_b64 exec, -1
  s_branch Lpubr_30
M_hL0_s:
  s_mov_b32 s46, 0
Lpoll_31:
  buffer_load_dword v6, v3, s[8:11], s37 offen offset:0 sc1
  s_add_u32 s46, s46, 1
  s_waitcnt vmcnt(0)
  v_cmp_ne_u32 s[54:55], 0, v6
  s_cmp_gt_u32 s46, 300000
  s_cbranch_scc1 Lpd_32
  s_cmp_eq_u64 s[54:55], exec
  s_cbranch_scc0 Lpoll_31
Lpd_32:
  s_nop 7
  s_nop 7
  s_branch M_hL0
Lacq_33:
  buffer_inv sc1
  s_waitcnt vmcnt(0)
  s_branch Lacqr_34
Lpub_35:
  buffer_wbl2 sc1
  s_waitcnt vmcnt(0)
  buffer_store_dword v10, v1, s[8:11], s56 offen sc1
  s_branch Lpubr_36
Lacq_39:
  buffer_inv sc1
  s_waitcnt vmcnt(0)
  s_branch Lacqr_40
Lpub_41:
  s_mov_b64 exec, 1
  buffer_store_dword v15, v2, s[8:11], s28 offen offset:384 sc1
  s_mov_b64 exec, -1
  s_branch Lpubr_42
M_sp1:
  s_add_u32 s57, s41, s20
  s_add_u32 s57, s57, 118784
  s_add_u32 m0, s20, 74752
  s_nop 0
  buffer_load_dwordx4 v1, s[8:11], s57 offen offset:0 sc1 lds
  buffer_load_dwordx4 v1, s[8:11], s57 offen offset:1024 sc1 lds
  buffer_load_dwordx4 v1, s[8:11], s57 offen offset:2048 sc1 lds
  buffer_load_dwordx4 v1, s[8:11], s57 offen offset:3072 sc1 lds
  s_add_u32 s57, s41, s20
  s_add_u32 s57, s57, 122880
  s_add_u32 m0, s20, 78848
  s_nop 0
  buffer_load_dwordx4 v1, s[8:11], s57 offen offset:0 sc1 lds
  buffer_load_dwordx4 v1, s[8:11], s57 offen offset:1024 sc1 lds
  buffer_load_dwordx4 v1, s[8:11], s57 offen offset:2048 sc1 lds
  buffer_load_dwordx4 v1, s[8:11], s57 offen offset:3072 sc1 lds
  s_add_u32 s57, s41, s44
  s_add_u32 s57, s57, 89088
  s_add_u32 m0, s44, 0
  s_nop 0
  buffer_load_dwordx4 v1, s[8:11], s57 offen offset:0 sc1 lds
  buffer_load_dwordx4 v1, s[8:11], s57 offen offset:1024 sc1 lds
  buffer_load_dwordx4 v1, s[8:11], s57 offen offset:2048 sc1 lds
  buffer_load_dwordx4 v1, s[8:11], s57 offen offset:3072 sc1 lds
  s_add_u32 s57, s41, s44
  s_add_u32 s57, s57, 93184
  s_add_u32 m0, s44, 4096
  s_nop 0
  buffer_load_dwordx4 v1, s[8:11], s57 offen offset:0 sc1 lds
  buffer_load_dwordx4 v1, s[8:11], s57 offen offset:1024 sc1 lds
  s_waitcnt vmcnt(0)
  s_barrier
  s_branch M_up1
Lacq_45:
  buffer_inv sc1
  s_waitcnt vmcnt(0)
  s_branch Lacqr_46
Lpub_49:
  buffer_wbl2 sc1
  s_waitcnt vmcnt(0)
  buffer_store_dword v10, v1, s[8:11], s56 offen sc1
  s_branch Lpubr_50
Lacq_53:
  buffer_inv sc1
  s_waitcnt vmcnt(0)
  s_branch Lacqr_54
Lpub_55:
  buffer_wbl2 sc1
  s_waitcnt vmcnt(0)
  s_mov_b64 exec, 1
  buffer_store_dword v15, v2, s[8:11], s36 offen offset:192 sc1
  s_mov_b64 exec, -1
  s_branch Lpubr_56
Lpub_57:
  buffer_wbl2 sc1
  s_waitcnt vmcnt(0)
  s_mov_b64 exec, 1
  buffer_store_dword v15, v2, s[8:11], s36 offen offset:128 sc1
  s_mov_b64 exec, -1
  s_branch Lpubr_58
M_ut1:
  v_mfma_f32_32x32x16_bf16 v[168:183], v[236:239], v[44:47], v[168:183]
  ds_read_b128 v[236:239], v13 offset:16384
  v_mul_f32 v212, v152, v223
  v_mul_f32 v214, v153, v223
  v_mul_f32 v216, v154, v223
  v_mul_f32 v218, v155, v223
  v_exp_f32 v212, v212
  s_waitcnt lgkmcnt(4)
  v_mfma_f32_32x32x16_bf16 v[168:183], v[240:243], v[48:51], v[168:183]
  ds_read_b128 v[240:243], v13 offset:17408
  v_exp_f32 v214, v214
  v_exp_f32 v216, v216
  v_exp_f32 v218, v218
  v_mfma_f32_32x32x16_bf16 v[168:183], v[244:247], v[52:55], v[168:183]
  ds_read_b128 v[244:247], v13 offset:18432
  v_fma_f32 v212, v212, v221, v221
  v_fma_f32 v214, v214, v221, v221
  v_fma_f32 v216, v216, v221, v221
  v_fma_f32 v218, v218, v221, v221
  v_rcp_f32 v212, v212
  v_mfma_f32_32x32x16_bf16 v[168:183], v[200:203], v[56:59], v[168:183]
  ds_read_b128 v[200:203], v13 offset:19456
  v_rcp_f32 v214, v214
  v_rcp_f32 v216, v216
  v_rcp_f32 v218, v218
  v_mfma_f32_32x32x16_bf16 v[168:183], v[204:207], v[60:63], v[168:183]
  ds_read_b128 v[204:207], v13 offset:20480
  v_mul_f32 v213, v152, v160
  v_mul_f32 v215, v153, v161
  v_mul_f32 v217, v154, v162
  v_mul_f32 v219, v155, v163
  v_mul_f32 v152, v213, v212
  v_mul_f32 v153, v215, v214
  s_waitcnt lgkmcnt(4)
  v_mfma_f32_32x32x16_bf16 v[168:183], v[224:227], v[64:67], v[168:183]
  ds_read_b128 v[224:227], v13 offset:21504
  v_mul_f32 v154, v217, v216
  v_mul_f32 v155, v219, v218
  v_mul_f32 v212, v156, v223
  v_mul_f32 v214, v157, v223
  v_mul_f32 v216, v158, v223
  v_mul_f32 v218, v159, v223
  v_mfma_f32_32x32x16_bf16 v[168:183], v[228:231], v[68:71], v[168:183]
  ds_read_b128 v[228:231], v13 offset:22528
  v_exp_f32 v212, v212
  v_exp_f32 v214, v214
  v_exp_f32 v216, v216
  v_mfma_f32_32x32x16_bf16 v[168:183], v[232:235], v[72:75], v[168:183]
  ds_read_b128 v[232:235], v13 offset:23552
  v_exp_f32 v218, v218
  v_fma_f32 v212, v212, v221, v221
  v_fma_f32 v214, v214, v221, v221
  v_fma_f32 v216, v216, v221, v221
  v_mfma_f32_32x32x16_bf16 v[168:183], v[236:239], v[76:79], v[168:183]
  ds_read_b128 v[236:239], v13 offset:24576
  v_fma_f32 v218, v218, v221, v221
  v_rcp_f32 v212, v212
  v_rcp_f32 v214, v214
  s_waitcnt lgkmcnt(4)
  v_mfma_f32_32x32x16_bf16 v[168:183], v[240:243], v[80:83], v[168:183]
  ds_read_b128 v[240:243], v13 offset:25600
  v_rcp_f32 v216, v216
  v_rcp_f32 v218, v218
  v_mul_f32 v213, v156, v164
  v_mfma_f32_32x32x16_bf16 v[168:183], v[244:247], v[84:87], v[168:183]
  ds_read_b128 v[244:247], v13 offset:26624
  v_mul_f32 v215, v157, v165
  v_mul_f32 v217, v158, v166
  v_mul_f32 v219, v159, v167
  v_mul_f32 v156, v213, v212
  v_mul_f32 v157, v215, v214
  v_mfma_f32_32x32x16_bf16 v[168:183], v[200:203], v[88:91], v[168:183]
  ds_read_b128 v[200:203], v13 offset:27648
  v_mul_f32 v158, v217, v216
  v_mul_f32 v159, v219, v218
  v_cvt_pk_bf16_f32 v252, v152, v153
  v_cvt_pk_bf16_f32 v253, v154, v155
  v_cvt_pk_bf16_f32 v254, v156, v157
  v_mfma_f32_32x32x16_bf16 v[168:183], v[204:207], v[92:95], v[168:183]
  ds_read_b128 v[204:207], v13 offset:28672
  v_cvt_pk_bf16_f32 v255, v158, v159
  s_waitcnt lgkmcnt(4)
  v_mfma_f32_32x32x16_bf16 v[168:183], v[224:227], v[96:99], v[168:183]
  ds_read_b128 v[224:227], v13 offset:29696
  buffer_store_dwordx4 v[252:255], v1, s[8:11], s35 offen offset:1024 sc1
  v_mfma_f32_32x32x16_bf16 v[168:183], v[228:231], v[100:103], v[168:183]
  ds_read_b128 v[228:231], v13 offset:30720
  v_mfma_f32_32x32x16_bf16 v[168:183], v[232:235], v[104:107], v[168:183]
  ds_read_b128 v[232:235], v13 offset:31744
  v_mfma_f32_32x32x16_bf16 v[168:183], v[236:239], v[108:111], v[168:183]
  s_waitcnt lgkmcnt(4)
  v_mfma_f32_32x32x16_bf16 v[168:183], v[240:243], v[112:115], v[168:183]
  v_mfma_f32_32x32x16_bf16 v[168:183], v[244:247], v[116:119], v[168:183]
  v_mfma_f32_32x32x16_bf16 v[168:183], v[200:203], v[120:123], v[168:183]
  s_waitcnt lgkmcnt(3)
  v_mfma_f32_32x32x16_bf16 v[168:183], v[204:207], v[124:127], v[168:183]
  s_waitcnt lgkmcnt(2)
  v_mfma_f32_32x32x16_bf16 v[168:183], v[224:227], v[128:131], v[168:183]
  s_waitcnt lgkmcnt(1)
  v_mfma_f32_32x32x16_bf16 v[168:183], v[228:231], v[132:135], v[168:183]
  s_waitcnt lgkmcnt(0)
  v_mfma_f32_32x32x16_bf16 v[168:183], v[232:235], v[208:211], v[168:183]
  s_nop 7
  s_nop 4
  v_mul_f32 v212, v168, v223
  v_mul_f32 v214, v169, v223
  v_mul_f32 v216, v170, v223
  v_mul_f32 v218, v171, v223
  v_exp_f32 v212, v212
  v_exp_f32 v214, v214
  v_exp_f32 v216, v216
  v_exp_f32 v218, v218
  v_fma_f32 v212, v212, v221, v221
  v_fma_f32 v214, v214, v221, v221
  v_fma_f32 v216, v216, v221, v221
  v_fma_f32 v218, v218, v221, v221
  v_rcp_f32 v212, v212
  v_rcp_f32 v214, v214
  v_rcp_f32 v216, v216
  v_rcp_f32 v218, v218
  v_mul_f32 v213, v168, v176
  v_mul_f32 v215, v169, v177
  v_mul_f32 v217, v170, v178
  v_mul_f32 v219, v171, v179
  v_mul_f32 v168, v213, v212
  v_mul_f32 v169, v215, v214
  v_mul_f32 v170, v217, v216
  v_mul_f32 v171, v219, v218
  v_mul_f32 v212, v172, v223
  v_mul_f32 v214, v173, v223
  v_mul_f32 v216, v174, v223
  v_mul_f32 v218, v175, v223
  v_exp_f32 v212, v212
  v_exp_f32 v214, v214
  v_exp_f32 v216, v216
  v_exp_f32 v218, v218
  v_fma_f32 v212, v212, v221, v221
  v_fma_f32 v214, v214, v221, v221
  v_fma_f32 v216, v216, v221, v221
  v_fma_f32 v218, v218, v221, v221
  v_rcp_f32 v212, v212
  v_rcp_f32 v214, v214
  v_rcp_f32 v216, v216
  v_rcp_f32 v218, v218
  v_mul_f32 v213, v172, v180
  v_mul_f32 v215, v173, v181
  v_mul_f32 v217, v174, v182
  v_mul_f32 v219, v175, v183
  v_mul_f32 v172, v213, v212
  v_mul_f32 v173, v215, v214
  v_mul_f32 v174, v217, v216
  v_mul_f32 v175, v219, v218
  v_cvt_pk_bf16_f32 v248, v168, v169
  v_cvt_pk_bf16_f32 v249, v170, v171
  v_cvt_pk_bf16_f32 v250, v172, v173
  v_cvt_pk_bf16_f32 v251, v174, v175
  buffer_store_dwordx4 v[248:251], v1, s[8:11], s35 offen offset:0 sc1
  s_waitcnt vmcnt(2)
  s_waitcnt vmcnt(1)
  s_waitcnt vmcnt(0)
  s_cbranch_vccz Lpub_57
  s_mov_b64 exec, 1
  buffer_store_dword v15, v2, s[8:11], s36 offen offset:128
  s_mov_b64 exec, -1
Lpubr_58:
  s_nop 0
  s_waitcnt vmcnt(0)
  s_waitcnt lgkmcnt(0)
  s_barrier
  s_branch M_next1
M_hE1_s:
  s_mov_b32 s46, 0
Lpoll_59:
  buffer_load_dword v6, v3, s[8:11], s37 offen offset:192 sc1
  s_add_u32 s46, s46, 1
  s_waitcnt vmcnt(0)
  v_cmp_ne_u32 s[54:55], 0, v6
  s_cmp_gt_u32 s46, 300000
  s_cbranch_scc1 Lpd_60
  s_cmp_eq_u64 s[54:55], exec
  s_cbranch_scc0 Lpoll_59
Lpd_60:
  s_nop 7
  s_nop 7
  s_branch M_hE1
Lacq_61:
  buffer_inv sc1
  s_waitcnt vmcnt(0)
  s_branch Lacqr_62
Lpub_63:
  buffer_wbl2 sc1
  s_waitcnt vmcnt(0)
  s_mov_b64 exec, 1
  buffer_store_dword v15, v2, s[8:11], s36 offen offset:128 sc1
  s_mov_b64 exec, -1
  s_branch Lpubr_64
M_hL1_s:
  s_mov_b32 s46, 0
Lpoll_65:
  buffer_load_dword v6, v3, s[8:11], s37 offen offset:128 sc1
  s_add_u32 s46, s46, 1
  s_waitcnt vmcnt(0)
  v_cmp_ne_u32 s[54:55], 0, v6
  s_cmp_gt_u32 s46, 300000
  s_cbranch_scc1 Lpd_66
  s_cmp_eq_u64 s[54:55], exec
  s_cbranch_scc0 Lpoll_65
Lpd_66:
  s_nop 7
  s_nop 7
  s_branch M_hL1
Lacq_67:
  buffer_inv sc1
  s_waitcnt vmcnt(0)
  s_branch Lacqr_68
M_last:
.section .rodata,"a"
.p2align 6
.amdhsa_kernel interleave_layers__linear_attn_block__glu_gated_swiglu__prompt_kernel
  .amdhsa_next_free_vgpr 512
  .amdhsa_next_free_sgpr 102
  .amdhsa_accum_offset 256
  .amdhsa_group_segment_fixed_size 0
  .amdhsa_kernarg_size 80
  .amdhsa_user_sgpr_count 2
  .amdhsa_user_sgpr_kernarg_segment_ptr 1
  .amdhsa_system_sgpr_workgroup_id_x 1
  .amdhsa_float_denorm_mode_32 3
.end_amdhsa_kernel
```
